```python
import torch

def _softmax(x, axis=-1):
    return torch.softmax(x, dim=axis)

def _gelu(x):
    return torch.nn.functional.gelu(x, approximate='tanh')

def _silu(x):
    return torch.nn.functional.silu(x)

def _sigmoid(x):
    return torch.sigmoid(x)

def _layernorm(x, axis=-1, eps=1e-05):
    m = x.mean(dim=axis, keepdim=True)
    v = x.var(dim=axis, keepdim=True, unbiased=False)
    return (x - m) / torch.sqrt(v + eps)

def _scatter_add(tgt, idx, src, axis=0):
    return tgt.clone().index_add_(axis, idx, src)

def _segment_sum(src, seg, n):
    out = torch.zeros((n,) + src.shape[1:], dtype=src.dtype)
    return out.index_add_(0, seg, src)

def _pad(x, pw):
    flat = tuple((v for pair in reversed(pw) for v in pair))
    return torch.nn.functional.pad(x, flat)
kernel_name = 'adaLN_cond__ssm_conv_s4d__dense_activation_silu__prompt'

def setup_inputs():

    _w = lambda a: (lambda t: t.to(torch.bfloat16) if t.is_floating_point() else t)(torch.as_tensor(a))

    def _A_setup():
        Bsz, L, D, N = (1, 2048, 640, 128)
        return {'u': _w((lambda *s: torch.randn(*s, dtype=torch.bfloat16) * 0.05)(Bsz, L, D)), 'log_A_real': _w((lambda *s: torch.randn(*s, dtype=torch.bfloat16) * 3.2)(D, N) * 0.5), 'A_imag': _w((lambda *s: torch.randn(*s, dtype=torch.bfloat16) * 0.05)(D, N) * 3.14), 'C_real': _w((lambda *s: torch.randn(*s, dtype=torch.bfloat16) * 0.1)(D, N) / N ** 0.5), 'C_imag': _w((lambda *s: torch.randn(*s, dtype=torch.bfloat16) * 0.2)(D, N) / N ** 0.5), 'log_dt': _w((lambda *s: torch.randn(*s, dtype=torch.bfloat16) * 0.05)(D) * 0.5 - 4.0), 'D_skip': _w((lambda *s: torch.randn(*s, dtype=torch.bfloat16) * 0.05)(D))}
    _A_in = _A_setup()

    def _B_setup():
        B, S, D, F = (1, 2048, 640, 1728)
        return {'x': _w((lambda *s: torch.randn(*s, dtype=torch.bfloat16) * 0.05)(B, S, D)), 'w1': _w((lambda *s: torch.randn(*s, dtype=torch.bfloat16) * 3.2)(D, F) * D ** (-0.5)), 'w2': _w((lambda *s: torch.randn(*s, dtype=torch.bfloat16) * 0.2)(F, D) * F ** (-0.5))}
    _B_in = _B_setup()
    return {'A_u': _A_in['u'], 'A_log_A_real': _A_in['log_A_real'], 'A_A_imag': _A_in['A_imag'], 'A_C_real': _A_in['C_real'], 'A_C_imag': _A_in['C_imag'], 'A_log_dt': _A_in['log_dt'], 'A_D_skip': _A_in['D_skip'], 'B_x': _B_in['x'], 'B_w1': _B_in['w1'], 'B_w2': _B_in['w2'], 'c': _w((lambda *s: torch.randn(*s, dtype=torch.bfloat16) * 0.2)(1, 640) * 8.0), 'w_mod': _w((lambda *s: torch.randn(*s, dtype=torch.bfloat16) * 0.2)(640, 6 * 640) * 640 ** (-0.5) * 8.0)}

def reference(A_u, A_log_A_real, A_A_imag, A_C_real, A_C_imag, A_log_dt, A_D_skip, B_x, B_w1, B_w2, c, w_mod):

    def _A_ref(u, log_A_real, A_imag, C_real, C_imag, log_dt, D_skip):
        L = u.shape[1]
        dt = torch.exp(log_dt)
        A = -torch.exp(log_A_real) + 1j * A_imag
        C = (C_real + 1j * C_imag) * dt[:, None]
        pos = (lambda x, dt: x.to(dt))(torch.arange(L), log_dt.dtype)
        P = torch.exp((A * dt[:, None])[:, :, None] * pos[None, None, :])
        K = 2.0 * torch.einsum('dn,dnl->dl', C, P).real
        L2 = 2 * L
        u_t = (lambda x, *d: x.permute(*d))(u, 0, 2, 1)
        Kf = (lambda x, *a, **k: torch.fft.rfft(x.float(), *a, **k))(K, L2)
        Uf = (lambda x, *a, **k: torch.fft.rfft(x.float(), *a, **k))(u_t, L2)
        y = (lambda x, *a, **k: torch.fft.irfft(x, *a, **k).to(torch.bfloat16))(Uf * Kf[None, :, :], L2)[:, :, :L]
        y = (lambda x, *d: x.permute(*d))(y, 0, 2, 1)
        return y + u * D_skip[None, None, :]

    def _B_ref(x, w1, w2):
        h = torch.einsum('bsd,df->bsf', x, w1)
        h = _silu(h)
        out = torch.einsum('bsf,fd->bsd', h, w2)
        return out
    x = A_u
    mod = (_silu(c) @ w_mod).reshape(c.shape[0], 6, 1, -1)
    sa, ca, ga, sb, cb, gb = (mod[:, 0].clone(), mod[:, 1].clone(), mod[:, 2].clone(), mod[:, 3].clone(), mod[:, 4].clone(), mod[:, 5].clone())
    h = _layernorm(x, axis=-1) * (1 + ca) + sa
    x = x + ga * _A_ref(h, A_log_A_real, A_A_imag, A_C_real, A_C_imag, A_log_dt, A_D_skip)
    h = _layernorm(x, axis=-1) * (1 + cb) + sb
    x = x + gb * _B_ref(h, B_w1, B_w2)
    return x
```

```asm
; @launch grid=(256,1,1) block=(256,1,1) lds=163840
.amdgcn_target "amdgcn-amd-amdhsa--gfx950"
.text
.globl adaLN_cond__ssm_conv_s4d__dense_activation_silu__prompt_kernel
.p2align 8
.type adaLN_cond__ssm_conv_s4d__dense_activation_silu__prompt_kernel,@function
adaLN_cond__ssm_conv_s4d__dense_activation_silu__prompt_kernel:
    s_cmp_ge_u32 s2, 256
    s_cbranch_scc1 L_exit
    s_load_dwordx16 s[4:19], s[0:1], 0
    s_load_dwordx8 s[20:27], s[0:1], 64
    s_load_dwordx4 s[28:31], s[0:1], 96
    s_load_dwordx2 s[32:33], s[0:1], 112
    v_lshrrev_b32 v2, 6, v0
    v_and_b32 v1, 63, v0
    v_readfirstlane_b32 s34, v2
    s_and_b32 s35, s2, 7
    s_lshr_b32 s36, s2, 3
    s_mov_b32 s86, 0x20000
    s_mov_b32 s56, 0x3f803f80
    s_mov_b32 s57, 0xffff0000
    s_lshr_b32 s44, s35, 1
    s_lshl_b32 s44, s44, 2
    s_lshr_b32 s39, s36, 3
    s_add_u32 s39, s39, s44
    s_and_b32 s44, s35, 1
    s_lshl_b32 s44, s44, 3
    s_and_b32 s40, s36, 7
    s_add_u32 s40, s40, s44
    s_lshr_b32 s44, s35, 1
    s_lshl_b32 s44, s44, 2
    s_lshr_b32 s43, s36, 3
    s_add_u32 s43, s43, s44
    s_bfe_u32 s42, s36, 65538
    s_and_b32 s44, s35, 1
    s_lshl_b32 s44, s44, 2
    s_and_b32 s41, s36, 3
    s_add_u32 s41, s41, s44
    v_mov_b32 v190, 0
    v_mov_b32_e64 v220, 0
    s_cmp_lg_u32 s34, 3
    s_cbranch_scc1 L_skipw_1
    s_getpc_b64 s[52:53]
L_pc:
    s_sub_u32 s52, s52, L_pc-adaLN_cond__ssm_conv_s4d__dense_activation_silu__prompt_kernel
    s_subb_u32 s53, s53, 0
    s_mul_i32 s44, s36, 1536
    v_min_u32 v2, 11, v1
    v_lshl_add_u32 v2, v2, 7, s44
    v_min_u32 v2, 45580, v2
    global_load_dword v229, v2, s[52:53]
L_skipw_1:
    s_waitcnt lgkmcnt(0)
    s_load_dword s37, s[32:33], 0
    s_cmp_ge_u32 s36, 20
    s_cbranch_scc1 L_aux
    s_mul_i32 s38, s35, 20
    s_add_u32 s38, s38, s36
    s_lshl_b32 s44, s38, 2
    s_add_u32 s45, s44, s34
    s_lshl_b32 s46, s45, 8
    v_lshl_add_u32 v2, v1, 2, s46
    global_load_dword v46, v2, s[6:7]
    global_load_dword v47, v2, s[8:9]
    global_load_dword v48, v2, s[10:11]
    global_load_dword v49, v2, s[12:13]
    s_lshl_b32 s45, s45, 1
    v_mov_b32 v2, s45
    global_load_ushort v50, v2, s[14:15]
    v_bfe_u32 v9, v1, 2, 2
    v_add_u32 v9, s44, v9
    v_lshlrev_b32_e64 v9, 1, v9
    s_lshl_b32 s59, s35, 4
    s_add_u32 s59, s59, s36
    s_lshl_b32 s59, s59, 1
    s_lshr_b32 s44, s34, 1
    s_add_u32 s59, s59, s44
    s_mul_i32 s50, s34, 17408
    s_mul_i32 s44, s59, 10240
    s_cmp_ge_u32 s36, 16
    s_cbranch_scc1 L_aj_3
    s_mov_b32 s45, s59
    s_bitcmp1_b32 s34, 0
    s_cbranch_scc1 L_a1_2
    v_lshl_add_u32 v2, v1, 4, s44
    s_add_u32 m0, s50, 0
    s_nop 0
    global_load_lds_dwordx4 v2, s[4:5] offset:0
    global_load_lds_dwordx4 v2, s[4:5] offset:1024
    global_load_lds_dwordx4 v2, s[4:5] offset:2048
    global_load_lds_dwordx4 v2, s[4:5] offset:3072
    s_add_u32 m0, s50, 4096
    v_add_u32 v2, 4096, v2
    global_load_lds_dwordx4 v2, s[4:5] offset:0
    global_load_lds_dwordx4 v2, s[4:5] offset:1024
    global_load_lds_dwordx4 v2, s[4:5] offset:2048
    global_load_lds_dwordx4 v2, s[4:5] offset:3072
    s_add_u32 m0, s50, 8192
    v_add_u32 v2, 4096, v2
    global_load_lds_dwordx4 v2, s[4:5] offset:0
    global_load_lds_dwordx4 v2, s[4:5] offset:1024
    s_branch L_aj_3
L_a1_2:
    s_add_u32 s44, s44, 2560
    v_lshrrev_b32_e64 v2, 4, v1
    v_mul_u32_u24 v2, 1280, v2
    v_and_b32_e64 v3, 15, v1
    v_lshl_add_u32 v2, v3, 4, v2
    v_add_u32_e64 v2, s44, v2
    global_load_dwordx4 v[148:151], v2, s[4:5] offset:-2560
    global_load_dwordx4 v[152:155], v2, s[4:5] offset:-2304
    global_load_dwordx4 v[156:159], v2, s[4:5] offset:-2048
    global_load_dwordx4 v[160:163], v2, s[4:5] offset:-1792
    global_load_dwordx4 v[164:167], v2, s[4:5] offset:-1536
    global_load_dwordx4 v[168:171], v2, s[4:5] offset:2560
    global_load_dwordx4 v[172:175], v2, s[4:5] offset:2816
    global_load_dwordx4 v[176:179], v2, s[4:5] offset:3072
    global_load_dwordx4 v[180:183], v2, s[4:5] offset:3328
    global_load_dwordx4 v[184:187], v2, s[4:5] offset:3584
L_aj_3:
    s_mul_i32 s48, s34, 2368
    s_add_u32 s48, s48, 69632
    v_lshlrev_b32_e64 v5, 3, v1
    v_sub_u32 v10, 511, v5
    v_cvt_f32_i32_e64 v6, v10
    v_sub_u32 v11, 510, v5
    v_cvt_f32_i32_e64 v7, v11
    v_cvt_pk_bf16_f32 v6, v6, v7
    v_lshrrev_b32_e64 v7, 16, v6
    v_and_b32 v6, 0xffff, v6
    v_cmp_gt_i32 vcc, 128, v10
    v_subrev_u32 v6, 0x4280, v6
    s_nop 0
    v_cndmask_b32 v6, v6, v10, vcc
    v_lshl_add_u32 v10, v6, 1, s48
    v_cmp_gt_i32 vcc, 128, v11
    v_subrev_u32 v7, 0x4280, v7
    s_nop 0
    v_cndmask_b32 v7, v7, v11, vcc
    v_lshl_add_u32 v11, v7, 1, s48
    v_sub_u32 v12, 509, v5
    v_cvt_f32_i32_e64 v6, v12
    v_sub_u32 v13, 508, v5
    v_cvt_f32_i32_e64 v7, v13
    v_cvt_pk_bf16_f32 v6, v6, v7
    v_lshrrev_b32_e64 v7, 16, v6
    v_and_b32 v6, 0xffff, v6
    v_cmp_gt_i32 vcc, 128, v12
    v_subrev_u32 v6, 0x4280, v6
    s_nop 0
    v_cndmask_b32 v6, v6, v12, vcc
    v_lshl_add_u32 v12, v6, 1, s48
    v_cmp_gt_i32 vcc, 128, v13
    v_subrev_u32 v7, 0x4280, v7
    s_nop 0
    v_cndmask_b32 v7, v7, v13, vcc
    v_lshl_add_u32 v13, v7, 1, s48
    v_sub_u32 v14, 507, v5
    v_cvt_f32_i32_e64 v6, v14
    v_sub_u32 v15, 506, v5
    v_cvt_f32_i32_e64 v7, v15
    v_cvt_pk_bf16_f32 v6, v6, v7
    v_lshrrev_b32_e64 v7, 16, v6
    v_and_b32 v6, 0xffff, v6
    v_cmp_gt_i32 vcc, 128, v14
    v_subrev_u32 v6, 0x4280, v6
    s_nop 0
    v_cndmask_b32 v6, v6, v14, vcc
    v_lshl_add_u32 v14, v6, 1, s48
    v_cmp_gt_i32 vcc, 128, v15
    v_subrev_u32 v7, 0x4280, v7
    s_nop 0
    v_cndmask_b32 v7, v7, v15, vcc
    v_lshl_add_u32 v15, v7, 1, s48
    v_sub_u32 v16, 505, v5
    v_cvt_f32_i32_e64 v6, v16
    v_sub_u32 v17, 504, v5
    v_cvt_f32_i32_e64 v7, v17
    v_cvt_pk_bf16_f32 v6, v6, v7
    v_lshrrev_b32_e64 v7, 16, v6
    v_and_b32 v6, 0xffff, v6
    v_cmp_gt_i32 vcc, 128, v16
    v_subrev_u32 v6, 0x4280, v6
    s_nop 0
    v_cndmask_b32 v6, v6, v16, vcc
    v_lshl_add_u32 v16, v6, 1, s48
    v_cmp_gt_i32 vcc, 128, v17
    v_subrev_u32 v7, 0x4280, v7
    s_nop 0
    v_cndmask_b32 v7, v7, v17, vcc
    v_lshl_add_u32 v17, v7, 1, s48
    v_sub_u32 v18, 503, v5
    v_cvt_f32_i32_e64 v6, v18
    v_sub_u32 v19, 502, v5
    v_cvt_f32_i32_e64 v7, v19
    v_cvt_pk_bf16_f32 v6, v6, v7
    v_lshrrev_b32_e64 v7, 16, v6
    v_and_b32 v6, 0xffff, v6
    v_cmp_gt_i32 vcc, 128, v18
    v_subrev_u32 v6, 0x4280, v6
    s_nop 0
    v_cndmask_b32 v6, v6, v18, vcc
    v_min_u32 v6, 1152, v6
    v_lshl_add_u32 v18, v6, 1, s48
    s_add_u32 s44, s48, 1272
    v_sub_u32_e64 v19, s44, v5
    s_add_u32 s44, s48, 1532
    v_lshlrev_b32 v5, 2, v1
    v_sub_u32 v20, s44, v5
    s_mul_i32 s44, s34, 17408
    s_add_u32 s44, s44, 0
    v_lshl_add_u32 v21, v1, 3, s44
    v_and_b32 v2, 15, v1
    v_lshrrev_b32_e64 v3, 4, v1
    v_lshl_add_u32 v4, v3, 4, s44
    s_mov_b32 s45, 544
    v_mad_u32_u24 v22, v2, s45, v4
    v_lshlrev_b32 v5, 1, v2
    v_lshrrev_b32 v6, 3, v2
    v_and_or_b32 v5, v5, 15, v6
    v_mad_u32_u24 v23, v5, s45, v4
    v_lshlrev_b32 v5, 2, v2
    v_lshrrev_b32 v6, 2, v2
    v_and_or_b32 v5, v5, 15, v6
    v_mad_u32_u24 v24, v5, s45, v4
    v_lshlrev_b32 v5, 3, v2
    v_lshrrev_b32 v6, 1, v2
    v_and_or_b32 v5, v5, 15, v6
    v_mad_u32_u24 v25, v5, s45, v4
    v_lshlrev_b32_e64 v5, 5, v2
    v_lshl_add_u32 v5, v3, 3, v5
    v_add_u32 v26, s48, v5
    v_add_u32_e64 v27, v26, v5
    s_lshl_b32 s44, s35, 14
    s_lshl_b32 s45, s34, 11
    s_add_u32 s44, s44, s45
    s_add_u32 s44, s44, 180224
    v_lshl_add_u32 v28, v1, 4, s44
    v_add_u32 v29, 8192, v28
    s_lshl_b32 s44, s38, 2
    v_lshrrev_b32 v6, 4, v1
    v_min_u32_e64 v6, 2, v6
    v_mul_u32_u24 v5, 640, v6
    v_bfe_u32 v7, v1, 2, 2
    v_add3_u32 v30, v5, v7, s44
    v_and_b32_e64 v7, 3, v1
    v_mul_u32_u24 v7, 30720, v7
    v_add_u32 v7, 311296, v7
    v_and_b32 v5, 7, v30
    v_lshlrev_b32 v5, 6, v5
    v_and_or_b32 v5, v30, 56, v5
    v_lshrrev_b32_e64 v30, 6, v30
    v_lshl_add_u32 v30, v30, 9, v5
    v_add_u32 v30, v30, v7
    v_lshrrev_b32 v6, 5, v1
    s_lshl_b32 s44, s34, 5
    v_lshlrev_b32 v6, 7, v6
    v_and_or_b32 v6, v1, 31, v6
    v_add_u32 v6, s44, v6
    s_lshl_b32 s45, s35, 12
    s_add_u32 s45, s45, 4096
    v_lshl_add_u32 v31, v6, 4, s45
    v_lshrrev_b32 v3, 2, v1
    v_add_u32 v4, s44, v3
    v_mul_u32_u24 v4, 10368, v4
    v_lshrrev_b32 v5, 3, v1
    v_sub_u32 v6, v1, v5
    v_and_b32_e64 v6, 3, v6
    v_lshl_add_u32 v4, v6, 4, v4
    s_lshl_b32 s45, s38, 6
    s_add_u32 s45, s45, 720896
    v_add_u32 v32, s45, v4
    v_add_u32 v33, 164864, v32
    v_add_u32 v34, 1325056, v32
    v_add_u32 v35, 1489920, v32
    s_lshl_b32 s46, s34, 12
    s_add_u32 s61, s46, 79104
    v_lshlrev_b32 v3, 6, v3
    v_and_b32_e64 v4, 3, v1
    v_lshl_add_u32 v3, v4, 2, v3
    v_add_u32 v3, s61, v3
    v_add_u32 v4, 0, v5
    v_and_b32_e64 v4, 3, v4
    v_lshl_add_u32 v36, v4, 4, v3
    v_add_u32 v4, 1, v5
    v_and_b32 v4, 3, v4
    v_lshl_add_u32 v37, v4, 4, v3
    v_add_u32 v4, 2, v5
    v_and_b32 v4, 3, v4
    v_lshl_add_u32 v38, v4, 4, v3
    v_add_u32 v4, 3, v5
    v_and_b32 v4, 3, v4
    v_lshl_add_u32 v39, v4, 4, v3
    s_lshl_b32 s44, s34, 9
    s_add_u32 s44, s44, 144704
    v_lshl_add_u32 v40, v1, 2, s44
    v_and_b32 v2, 15, v1
    v_lshrrev_b32_e64 v3, 4, v1
    s_mul_i32 s44, s34, 8320
    s_add_u32 s44, s44, 118172
    v_and_b32_e64 v4, 1, v2
    v_mul_u32_u24 v4, 4158, v4
    v_lshl_add_u32 v4, v2, 1, v4
    v_lshlrev_b32 v5, 4, v3
    v_sub_u32 v4, v5, v4
    v_add_u32_e64 v4, s44, v4
    v_accvgpr_write_b32 a255, v4
    s_mul_i32 s44, s34, 4608
    s_add_u32 s44, s44, 144192
    v_lshl_add_u32 v4, v2, 5, v5
    v_add_u32_e64 v4, s44, v4
    v_accvgpr_write_b32 a254, v4
    v_mov_b32 v2, 0
    v_mov_b32 v3, 0
    v_mov_b32_e64 v4, s48
    ds_write_b32 v4, v2 offset:2304
    s_mul_i32 s45, s34, 8320
    s_add_u32 s45, s45, 110912
    v_bfe_u32 v6, v1, 3, 1
    v_mul_u32_u24 v6, 4160, v6
    v_and_b32_e64 v5, 7, v1
    v_lshl_add_u32 v6, v5, 2, v6
    v_add_u32_e64 v6, s45, v6
    ds_write_b32 v6, v2 offset:4096
    s_mul_i32 s46, s34, 4608
    s_add_u32 s46, s46, 144192
    v_lshl_add_u32 v7, v1, 3, s46
    ds_write_b64 v7, v[2:3]
    v_lshl_add_u32 v5, v1, 4, s45
    v_accvgpr_write_b32 a253, v5
    s_waitcnt vmcnt(10)
    s_cmp_lt_u32 s36, 16
    s_cbranch_scc1 L_par_8
    s_waitcnt vmcnt(0)
L_par_8:
    v_lshlrev_b32 v50, 16, v50
    v_lshlrev_b32 v2, 16, v46
    v_and_b32 v3, 0xffff0000, v46
    v_mul_f32 v50, 0x3fb8aa3b, v50
    v_mul_f32 v2, 0x3fb8aa3b, v2
    v_mul_f32 v3, 0x3fb8aa3b, v3
    v_exp_f32 v50, v50
    v_exp_f32 v2, v2
    v_exp_f32 v3, v3
    v_lshlrev_b32 v6, 16, v47
    v_and_b32 v7, 0xffff0000, v47
    v_cvt_pk_bf16_f32 v4, v2, v3
    v_lshlrev_b32_e64 v2, 16, v4
    v_and_b32 v3, 0xffff0000, v4
    v_cvt_pk_bf16_f32 v50, v50, v50
    v_lshlrev_b32 v50, 16, v50
    v_mul_f32 v108, v2, v50
    v_mul_f32_e64 v109, v6, v50
    v_mul_f32 v108, 0xbfb8aa3b, v108
    v_mul_f32 v109, 0x3e22f983, v109
    v_mul_f32 v110, v3, v50
    v_mul_f32_e64 v111, v7, v50
    v_mul_f32 v110, 0xbfb8aa3b, v110
    v_mul_f32 v111, 0x3e22f983, v111
    v_add_f32 v50, v50, v50
    v_lshlrev_b32 v96, 16, v48
    v_lshlrev_b32 v97, 16, v49
    v_and_b32 v98, 0xffff0000, v48
    v_and_b32 v99, 0xffff0000, v49
    v_mul_f32 v96, v50, v96
    v_mul_f32 v97, v50, v97
    v_mul_f32 v98, v50, v98
    v_mul_f32 v99, v50, v99
    v_exp_f32 v2, v108
    v_fract_f32 v4, v109
    v_exp_f32 v3, v110
    v_fract_f32 v5, v111
    v_cos_f32 v52, v4
    v_sin_f32 v53, v4
    v_cos_f32 v54, v5
    v_sin_f32 v55, v5
    v_mul_f32 v52, v2, v52
    v_mul_f32 v53, v2, v53
    v_mul_f32 v54, v3, v54
    v_mul_f32 v55, v3, v55
    v_mul_f32 v108, 0x41800000, v108
    v_mul_f32 v109, 0x41800000, v109
    v_exp_f32 v2, v108
    v_fract_f32 v4, v109
    v_mul_f32 v110, 0x41800000, v110
    v_mul_f32 v111, 0x41800000, v111
    v_exp_f32 v3, v110
    v_fract_f32 v5, v111
    v_cos_f32 v68, v4
    v_sin_f32 v69, v4
    v_cos_f32 v70, v5
    v_sin_f32 v71, v5
    v_mul_f32 v68, v2, v68
    v_mul_f32 v69, v2, v69
    v_mul_f32 v70, v3, v70
    v_mul_f32 v71, v3, v71
    v_mul_f32 v108, 0x41800000, v108
    v_mul_f32 v109, 0x41800000, v109
    v_exp_f32 v2, v108
    v_fract_f32 v4, v109
    v_mul_f32 v110, 0x41800000, v110
    v_mul_f32 v111, 0x41800000, v111
    v_exp_f32 v3, v110
    v_fract_f32 v5, v111
    v_cos_f32 v84, v4
    v_sin_f32 v85, v4
    v_cos_f32 v86, v5
    v_sin_f32 v87, v5
    v_mul_f32 v84, v2, v84
    v_mul_f32 v85, v2, v85
    v_mul_f32 v86, v3, v86
    v_mul_f32 v87, v3, v87
    v_pk_mul_f32 v[104:105], v[52:53], v[52:53] op_sel:[0,0] op_sel_hi:[0,1]
    v_pk_fma_f32 v[56:57], v[52:53], v[52:53], v[104:105] op_sel:[1,1,0] op_sel_hi:[1,0,1] neg_lo:[0,1,0]
    v_pk_mul_f32 v[106:107], v[54:55], v[54:55] op_sel:[0,0] op_sel_hi:[0,1]
    v_pk_fma_f32 v[58:59], v[54:55], v[54:55], v[106:107] op_sel:[1,1,0] op_sel_hi:[1,0,1] neg_lo:[0,1,0]
    v_pk_mul_f32 v[104:105], v[68:69], v[68:69] op_sel:[0,0] op_sel_hi:[0,1]
    v_pk_fma_f32 v[72:73], v[68:69], v[68:69], v[104:105] op_sel:[1,1,0] op_sel_hi:[1,0,1] neg_lo:[0,1,0]
    v_pk_mul_f32 v[106:107], v[70:71], v[70:71] op_sel:[0,0] op_sel_hi:[0,1]
    v_pk_fma_f32 v[74:75], v[70:71], v[70:71], v[106:107] op_sel:[1,1,0] op_sel_hi:[1,0,1] neg_lo:[0,1,0]
    v_pk_mul_f32 v[104:105], v[84:85], v[84:85] op_sel:[0,0] op_sel_hi:[0,1]
    v_pk_fma_f32 v[88:89], v[84:85], v[84:85], v[104:105] op_sel:[1,1,0] op_sel_hi:[1,0,1] neg_lo:[0,1,0]
    v_pk_mul_f32 v[106:107], v[86:87], v[86:87] op_sel:[0,0] op_sel_hi:[0,1]
    v_pk_fma_f32 v[90:91], v[86:87], v[86:87], v[106:107] op_sel:[1,1,0] op_sel_hi:[1,0,1] neg_lo:[0,1,0]
    v_pk_mul_f32 v[104:105], v[56:57], v[56:57] op_sel:[0,0] op_sel_hi:[0,1]
    v_pk_fma_f32 v[60:61], v[56:57], v[56:57], v[104:105] op_sel:[1,1,0] op_sel_hi:[1,0,1] neg_lo:[0,1,0]
    v_pk_mul_f32 v[106:107], v[58:59], v[58:59] op_sel:[0,0] op_sel_hi:[0,1]
    v_pk_fma_f32 v[62:63], v[58:59], v[58:59], v[106:107] op_sel:[1,1,0] op_sel_hi:[1,0,1] neg_lo:[0,1,0]
    v_pk_mul_f32 v[104:105], v[72:73], v[72:73] op_sel:[0,0] op_sel_hi:[0,1]
    v_pk_fma_f32 v[76:77], v[72:73], v[72:73], v[104:105] op_sel:[1,1,0] op_sel_hi:[1,0,1] neg_lo:[0,1,0]
    v_pk_mul_f32 v[106:107], v[74:75], v[74:75] op_sel:[0,0] op_sel_hi:[0,1]
    v_pk_fma_f32 v[78:79], v[74:75], v[74:75], v[106:107] op_sel:[1,1,0] op_sel_hi:[1,0,1] neg_lo:[0,1,0]
    v_pk_mul_f32 v[104:105], v[88:89], v[88:89] op_sel:[0,0] op_sel_hi:[0,1]
    v_pk_fma_f32 v[92:93], v[88:89], v[88:89], v[104:105] op_sel:[1,1,0] op_sel_hi:[1,0,1] neg_lo:[0,1,0]
    v_pk_mul_f32 v[106:107], v[90:91], v[90:91] op_sel:[0,0] op_sel_hi:[0,1]
    v_pk_fma_f32 v[94:95], v[90:91], v[90:91], v[106:107] op_sel:[1,1,0] op_sel_hi:[1,0,1] neg_lo:[0,1,0]
    v_pk_mul_f32 v[104:105], v[60:61], v[60:61] op_sel:[0,0] op_sel_hi:[0,1]
    v_pk_fma_f32 v[64:65], v[60:61], v[60:61], v[104:105] op_sel:[1,1,0] op_sel_hi:[1,0,1] neg_lo:[0,1,0]
    v_pk_mul_f32 v[106:107], v[62:63], v[62:63] op_sel:[0,0] op_sel_hi:[0,1]
    v_pk_fma_f32 v[66:67], v[62:63], v[62:63], v[106:107] op_sel:[1,1,0] op_sel_hi:[1,0,1] neg_lo:[0,1,0]
    v_pk_mul_f32 v[104:105], v[76:77], v[76:77] op_sel:[0,0] op_sel_hi:[0,1]
    v_pk_fma_f32 v[80:81], v[76:77], v[76:77], v[104:105] op_sel:[1,1,0] op_sel_hi:[1,0,1] neg_lo:[0,1,0]
    v_pk_mul_f32 v[106:107], v[78:79], v[78:79] op_sel:[0,0] op_sel_hi:[0,1]
    v_pk_fma_f32 v[82:83], v[78:79], v[78:79], v[106:107] op_sel:[1,1,0] op_sel_hi:[1,0,1] neg_lo:[0,1,0]
    s_waitcnt lgkmcnt(0)
    s_mul_i32 s37, s37, 0x9E3779B1
    s_add_u32 s37, s37, 0x7F4A7C15
    s_add_u32 s60, s37, 20
    s_cmp_ge_u32 s36, 16
    s_cbranch_scc1 L_bj_6
    s_bitcmp1_b32 s34, 0
    s_cbranch_scc1 L_b1_4
    v_bfe_u32 v2, v1, 2, 2
    v_mul_u32_u24 v2, 1280, v2
    v_lshrrev_b32_e64 v3, 4, v1
    v_lshl_add_u32 v2, v3, 5, v2
    v_and_b32_e64 v3, 3, v1
    v_lshl_add_u32 v2, v3, 3, v2
    v_add_u32_e64 v2, s50, v2
    s_mul_i32 s44, s59, 10368
    s_add_u32 s44, s44, 724992
    v_lshl_add_u32 v3, v1, 4, s44
    v_add_u32 v4, 8192, v3
    s_lshl_b32 s44, s59, 7
    s_add_u32 s44, s44, 65536
    v_lshl_add_u32 v5, v1, 15, s44
    v_mov_b32_e64 v6, s37
    s_waitcnt vmcnt(0)
    ds_read_b64_tr_b16 v[148:149], v2 offset:0
    ds_read_b64_tr_b16 v[150:151], v2 offset:5120
    ds_read_b64_tr_b16 v[152:153], v2 offset:128
    ds_read_b64_tr_b16 v[154:155], v2 offset:5248
    ds_read_b64_tr_b16 v[156:157], v2 offset:256
    ds_read_b64_tr_b16 v[158:159], v2 offset:5376
    ds_read_b64_tr_b16 v[160:161], v2 offset:384
    ds_read_b64_tr_b16 v[162:163], v2 offset:5504
    ds_read_b64_tr_b16 v[164:165], v2 offset:512
    ds_read_b64_tr_b16 v[166:167], v2 offset:5632
    s_waitcnt lgkmcnt(8)
    global_store_dwordx4 v3, v[148:151], s[32:33] offset:-4096 sc1
    ds_read_b64_tr_b16 v[168:169], v2 offset:640
    ds_read_b64_tr_b16 v[170:171], v2 offset:5760
    s_waitcnt lgkmcnt(8)
    global_store_dwordx4 v3, v[152:155], s[32:33] offset:-3072 sc1
    ds_read_b64_tr_b16 v[172:173], v2 offset:768
    ds_read_b64_tr_b16 v[174:175], v2 offset:5888
    s_waitcnt lgkmcnt(8)
    global_store_dwordx4 v3, v[156:159], s[32:33] offset:-2048 sc1
    ds_read_b64_tr_b16 v[176:177], v2 offset:896
    ds_read_b64_tr_b16 v[178:179], v2 offset:6016
    s_waitcnt lgkmcnt(8)
    global_store_dwordx4 v3, v[160:163], s[32:33] offset:-1024 sc1
    ds_read_b64_tr_b16 v[180:181], v2 offset:1024
    ds_read_b64_tr_b16 v[182:183], v2 offset:6144
    s_waitcnt lgkmcnt(8)
    global_store_dwordx4 v3, v[164:167], s[32:33] offset:0 sc1
    ds_read_b64_tr_b16 v[184:185], v2 offset:1152
    ds_read_b64_tr_b16 v[186:187], v2 offset:6272
    s_waitcnt lgkmcnt(8)
    global_store_dwordx4 v3, v[168:171], s[32:33] offset:1024 sc1
    s_waitcnt lgkmcnt(6)
    global_store_dwordx4 v3, v[172:175], s[32:33] offset:2048 sc1
    s_waitcnt lgkmcnt(4)
    global_store_dwordx4 v3, v[176:179], s[32:33] offset:3072 sc1
    s_waitcnt lgkmcnt(2)
    global_store_dwordx4 v4, v[180:183], s[32:33] offset:-4096 sc1
    s_waitcnt lgkmcnt(0)
    global_store_dwordx4 v4, v[184:187], s[32:33] offset:-3072 sc1
    s_mov_b64 exec, 0x3
    global_store_dword v5, v6, s[32:33] sc1
    s_mov_b64 exec, -1
    s_branch L_bj_6
L_b1_4:
    v_mov_b32 v200, 0
    v_mov_b32 v201, 0
    v_mov_b32 v202, 0
    v_mov_b32 v203, 0
    v_and_b32 v2, 3, v1
    v_and_b32 v3, 4, v1
    v_lshlrev_b32 v3, 3, v3
    v_lshl_add_u32 v6, v2, 6, v3
    s_lshl_b32 s44, s59, 6
    s_add_u32 s44, s44, 180224
    v_lshrrev_b32 v2, 3, v1
    v_lshlrev_b32 v2, 14, v2
    v_and_b32 v3, 7, v1
    v_lshl_add_u32 v2, v3, 3, v2
    v_add_u32 v2, s44, v2
    s_waitcnt vmcnt(0)
    v_dot2_f32_bf16 v200, v148, s56, v200
    v_dot2_f32_bf16 v201, v148, v148, v201
    v_dot2_f32_bf16 v202, v168, s56, v202
    v_dot2_f32_bf16 v203, v168, v168, v203
    v_dot2_f32_bf16 v200, v149, s56, v200
    v_dot2_f32_bf16 v201, v149, v149, v201
    v_dot2_f32_bf16 v202, v169, s56, v202
    v_dot2_f32_bf16 v203, v169, v169, v203
    v_dot2_f32_bf16 v200, v150, s56, v200
    v_dot2_f32_bf16 v201, v150, v150, v201
    v_dot2_f32_bf16 v202, v170, s56, v202
    v_dot2_f32_bf16 v203, v170, v170, v203
    v_dot2_f32_bf16 v200, v151, s56, v200
    v_dot2_f32_bf16 v201, v151, v151, v201
    v_dot2_f32_bf16 v202, v171, s56, v202
    v_dot2_f32_bf16 v203, v171, v171, v203
    v_dot2_f32_bf16 v200, v152, s56, v200
    v_dot2_f32_bf16 v201, v152, v152, v201
    v_dot2_f32_bf16 v202, v172, s56, v202
    v_dot2_f32_bf16 v203, v172, v172, v203
    v_dot2_f32_bf16 v200, v153, s56, v200
    v_dot2_f32_bf16 v201, v153, v153, v201
    v_dot2_f32_bf16 v202, v173, s56, v202
    v_dot2_f32_bf16 v203, v173, v173, v203
    v_dot2_f32_bf16 v200, v154, s56, v200
    v_dot2_f32_bf16 v201, v154, v154, v201
    v_dot2_f32_bf16 v202, v174, s56, v202
    v_dot2_f32_bf16 v203, v174, v174, v203
    v_dot2_f32_bf16 v200, v155, s56, v200
    v_dot2_f32_bf16 v201, v155, v155, v201
    v_dot2_f32_bf16 v202, v175, s56, v202
    v_dot2_f32_bf16 v203, v175, v175, v203
    v_dot2_f32_bf16 v200, v156, s56, v200
    v_dot2_f32_bf16 v201, v156, v156, v201
    v_dot2_f32_bf16 v202, v176, s56, v202
    v_dot2_f32_bf16 v203, v176, v176, v203
    v_dot2_f32_bf16 v200, v157, s56, v200
    v_dot2_f32_bf16 v201, v157, v157, v201
    v_dot2_f32_bf16 v202, v177, s56, v202
    v_dot2_f32_bf16 v203, v177, v177, v203
    v_dot2_f32_bf16 v200, v158, s56, v200
    v_dot2_f32_bf16 v201, v158, v158, v201
    v_dot2_f32_bf16 v202, v178, s56, v202
    v_dot2_f32_bf16 v203, v178, v178, v203
    v_dot2_f32_bf16 v200, v159, s56, v200
    v_dot2_f32_bf16 v201, v159, v159, v201
    v_dot2_f32_bf16 v202, v179, s56, v202
    v_dot2_f32_bf16 v203, v179, v179, v203
    v_dot2_f32_bf16 v200, v160, s56, v200
    v_dot2_f32_bf16 v201, v160, v160, v201
    v_dot2_f32_bf16 v202, v180, s56, v202
    v_dot2_f32_bf16 v203, v180, v180, v203
    v_dot2_f32_bf16 v200, v161, s56, v200
    v_dot2_f32_bf16 v201, v161, v161, v201
    v_dot2_f32_bf16 v202, v181, s56, v202
    v_dot2_f32_bf16 v203, v181, v181, v203
    v_dot2_f32_bf16 v200, v162, s56, v200
    v_dot2_f32_bf16 v201, v162, v162, v201
    v_dot2_f32_bf16 v202, v182, s56, v202
    v_dot2_f32_bf16 v203, v182, v182, v203
    v_dot2_f32_bf16 v200, v163, s56, v200
    v_dot2_f32_bf16 v201, v163, v163, v201
    v_dot2_f32_bf16 v202, v183, s56, v202
    v_dot2_f32_bf16 v203, v183, v183, v203
    v_dot2_f32_bf16 v200, v164, s56, v200
    v_dot2_f32_bf16 v201, v164, v164, v201
    v_dot2_f32_bf16 v202, v184, s56, v202
    v_dot2_f32_bf16 v203, v184, v184, v203
    v_dot2_f32_bf16 v200, v165, s56, v200
    v_dot2_f32_bf16 v201, v165, v165, v201
    v_dot2_f32_bf16 v202, v185, s56, v202
    v_dot2_f32_bf16 v203, v185, v185, v203
    v_dot2_f32_bf16 v200, v166, s56, v200
    v_dot2_f32_bf16 v201, v166, v166, v201
    v_dot2_f32_bf16 v202, v186, s56, v202
    v_dot2_f32_bf16 v203, v186, v186, v203
    v_dot2_f32_bf16 v200, v167, s56, v200
    v_dot2_f32_bf16 v201, v167, v167, v201
    v_dot2_f32_bf16 v202, v187, s56, v202
    v_dot2_f32_bf16 v203, v187, v187, v203
    v_add_f32_dpp v200, v200, v200 row_ror:8 row_mask:0xf bank_mask:0xf
    v_add_f32_dpp v201, v201, v201 row_ror:8 row_mask:0xf bank_mask:0xf
    v_add_f32_dpp v202, v202, v202 row_ror:8 row_mask:0xf bank_mask:0xf
    v_add_f32_dpp v203, v203, v203 row_ror:8 row_mask:0xf bank_mask:0xf
    v_add_f32_dpp v200, v200, v200 row_ror:4 row_mask:0xf bank_mask:0xf
    v_add_f32_dpp v201, v201, v201 row_ror:4 row_mask:0xf bank_mask:0xf
    v_add_f32_dpp v202, v202, v202 row_ror:4 row_mask:0xf bank_mask:0xf
    v_add_f32_dpp v203, v203, v203 row_ror:4 row_mask:0xf bank_mask:0xf
    v_add_f32_dpp v200, v200, v200 row_ror:2 row_mask:0xf bank_mask:0xf
    v_add_f32_dpp v201, v201, v201 row_ror:2 row_mask:0xf bank_mask:0xf
    v_add_f32_dpp v202, v202, v202 row_ror:2 row_mask:0xf bank_mask:0xf
    v_add_f32_dpp v203, v203, v203 row_ror:2 row_mask:0xf bank_mask:0xf
    v_add_f32_dpp v200, v200, v200 row_ror:1 row_mask:0xf bank_mask:0xf
    v_add_f32_dpp v201, v201, v201 row_ror:1 row_mask:0xf bank_mask:0xf
    v_add_f32_dpp v202, v202, v202 row_ror:1 row_mask:0xf bank_mask:0xf
    v_add_f32_dpp v203, v203, v203 row_ror:1 row_mask:0xf bank_mask:0xf
    s_nop 0
    s_nop 0
    v_mov_b32_dpp v200, v202 quad_perm:[0,1,2,3] row_mask:0xf bank_mask:0xc
    v_mov_b32_dpp v201, v203 quad_perm:[0,1,2,3] row_mask:0xf bank_mask:0xc
    v_mul_f32 v200, 0x3acccccd, v200
    v_mul_f32 v201, 0x3acccccd, v201
    v_fma_f32 v201, -v200, v200, v201
    v_max_f32_e64 v201, 0, v201
    v_cvt_pk_bf16_f32 v201, v201, v201
    v_lshlrev_b32_e64 v201, 16, v201
    v_add_f32 v201, 0x3727c5ac, v201
    v_cvt_pk_bf16_f32 v201, v201, v201
    v_lshlrev_b32 v201, 16, v201
    v_sqrt_f32_e64 v201, v201
    s_nop 0
    v_cvt_pk_bf16_f32 v200, v200, v201
    ds_bpermute_b32 v4, v6, v200
    s_waitcnt lgkmcnt(0)
    v_mov_b32 v5, s37
    global_store_dwordx2 v2, v[4:5], s[32:33] sc1
L_bj_6:
    s_lshr_b32 s87, s36, 4
    s_and_b32 s44, s34, 1
    s_or_b32 s87, s87, s44
    s_nop 0
    v_mov_b32 v216, 0x00003f80
    v_mov_b32 v217, 0x00003f80
    v_cvt_pk_bf16_f32 v218, v52, v53
    v_cvt_pk_bf16_f32 v219, v54, v55
    v_pk_mul_f32 v[104:105], v[52:53], v[52:53] op_sel:[0,0] op_sel_hi:[0,1]
    v_pk_fma_f32 v[100:101], v[52:53], v[52:53], v[104:105] op_sel:[1,1,0] op_sel_hi:[1,0,1] neg_lo:[0,1,0]
    v_pk_mul_f32 v[106:107], v[54:55], v[54:55] op_sel:[0,0] op_sel_hi:[0,1]
    v_pk_fma_f32 v[102:103], v[54:55], v[54:55], v[106:107] op_sel:[1,1,0] op_sel_hi:[1,0,1] neg_lo:[0,1,0]
    v_cvt_pk_bf16_f32 v220, v100, v101
    v_cvt_pk_bf16_f32 v221, v102, v103
    v_pk_mul_f32 v[104:105], v[100:101], v[52:53] op_sel:[0,0] op_sel_hi:[0,1]
    v_pk_fma_f32 v[100:101], v[100:101], v[52:53], v[104:105] op_sel:[1,1,0] op_sel_hi:[1,0,1] neg_lo:[0,1,0]
    v_pk_mul_f32 v[106:107], v[102:103], v[54:55] op_sel:[0,0] op_sel_hi:[0,1]
    v_pk_fma_f32 v[102:103], v[102:103], v[54:55], v[106:107] op_sel:[1,1,0] op_sel_hi:[1,0,1] neg_lo:[0,1,0]
    v_cvt_pk_bf16_f32 v222, v100, v101
    v_cvt_pk_bf16_f32 v223, v102, v103
    ds_write_b64 v21, v[216:217] offset:0
    ds_write_b64 v21, v[218:219] offset:544
    ds_write_b64 v21, v[220:221] offset:1088
    ds_write_b64 v21, v[222:223] offset:1632
    v_pk_mul_f32 v[104:105], v[100:101], v[52:53] op_sel:[0,0] op_sel_hi:[0,1]
    v_pk_fma_f32 v[100:101], v[100:101], v[52:53], v[104:105] op_sel:[1,1,0] op_sel_hi:[1,0,1] neg_lo:[0,1,0]
    v_pk_mul_f32 v[106:107], v[102:103], v[54:55] op_sel:[0,0] op_sel_hi:[0,1]
    v_pk_fma_f32 v[102:103], v[102:103], v[54:55], v[106:107] op_sel:[1,1,0] op_sel_hi:[1,0,1] neg_lo:[0,1,0]
    v_cvt_pk_bf16_f32 v216, v100, v101
    v_cvt_pk_bf16_f32 v217, v102, v103
    v_pk_mul_f32 v[104:105], v[100:101], v[52:53] op_sel:[0,0] op_sel_hi:[0,1]
    v_pk_fma_f32 v[100:101], v[100:101], v[52:53], v[104:105] op_sel:[1,1,0] op_sel_hi:[1,0,1] neg_lo:[0,1,0]
    v_pk_mul_f32 v[106:107], v[102:103], v[54:55] op_sel:[0,0] op_sel_hi:[0,1]
    v_pk_fma_f32 v[102:103], v[102:103], v[54:55], v[106:107] op_sel:[1,1,0] op_sel_hi:[1,0,1] neg_lo:[0,1,0]
    v_cvt_pk_bf16_f32 v218, v100, v101
    v_cvt_pk_bf16_f32 v219, v102, v103
    v_pk_mul_f32 v[104:105], v[100:101], v[52:53] op_sel:[0,0] op_sel_hi:[0,1]
    v_pk_fma_f32 v[100:101], v[100:101], v[52:53], v[104:105] op_sel:[1,1,0] op_sel_hi:[1,0,1] neg_lo:[0,1,0]
    v_pk_mul_f32 v[106:107], v[102:103], v[54:55] op_sel:[0,0] op_sel_hi:[0,1]
    v_pk_fma_f32 v[102:103], v[102:103], v[54:55], v[106:107] op_sel:[1,1,0] op_sel_hi:[1,0,1] neg_lo:[0,1,0]
    v_cvt_pk_bf16_f32 v220, v100, v101
    v_cvt_pk_bf16_f32 v221, v102, v103
    v_pk_mul_f32 v[104:105], v[100:101], v[52:53] op_sel:[0,0] op_sel_hi:[0,1]
    v_pk_fma_f32 v[100:101], v[100:101], v[52:53], v[104:105] op_sel:[1,1,0] op_sel_hi:[1,0,1] neg_lo:[0,1,0]
    v_pk_mul_f32 v[106:107], v[102:103], v[54:55] op_sel:[0,0] op_sel_hi:[0,1]
    v_pk_fma_f32 v[102:103], v[102:103], v[54:55], v[106:107] op_sel:[1,1,0] op_sel_hi:[1,0,1] neg_lo:[0,1,0]
    v_cvt_pk_bf16_f32 v222, v100, v101
    v_cvt_pk_bf16_f32 v223, v102, v103
    ds_write_b64 v21, v[216:217] offset:2176
    ds_write_b64 v21, v[218:219] offset:2720
    ds_write_b64 v21, v[220:221] offset:3264
    ds_write_b64 v21, v[222:223] offset:3808
    v_pk_mul_f32 v[104:105], v[100:101], v[52:53] op_sel:[0,0] op_sel_hi:[0,1]
    v_pk_fma_f32 v[100:101], v[100:101], v[52:53], v[104:105] op_sel:[1,1,0] op_sel_hi:[1,0,1] neg_lo:[0,1,0]
    v_pk_mul_f32 v[106:107], v[102:103], v[54:55] op_sel:[0,0] op_sel_hi:[0,1]
    v_pk_fma_f32 v[102:103], v[102:103], v[54:55], v[106:107] op_sel:[1,1,0] op_sel_hi:[1,0,1] neg_lo:[0,1,0]
    v_cvt_pk_bf16_f32 v216, v100, v101
    v_cvt_pk_bf16_f32 v217, v102, v103
    v_pk_mul_f32 v[104:105], v[100:101], v[52:53] op_sel:[0,0] op_sel_hi:[0,1]
    v_pk_fma_f32 v[100:101], v[100:101], v[52:53], v[104:105] op_sel:[1,1,0] op_sel_hi:[1,0,1] neg_lo:[0,1,0]
    v_pk_mul_f32 v[106:107], v[102:103], v[54:55] op_sel:[0,0] op_sel_hi:[0,1]
    v_pk_fma_f32 v[102:103], v[102:103], v[54:55], v[106:107] op_sel:[1,1,0] op_sel_hi:[1,0,1] neg_lo:[0,1,0]
    v_cvt_pk_bf16_f32 v218, v100, v101
    v_cvt_pk_bf16_f32 v219, v102, v103
    v_pk_mul_f32 v[104:105], v[100:101], v[52:53] op_sel:[0,0] op_sel_hi:[0,1]
    v_pk_fma_f32 v[100:101], v[100:101], v[52:53], v[104:105] op_sel:[1,1,0] op_sel_hi:[1,0,1] neg_lo:[0,1,0]
    v_pk_mul_f32 v[106:107], v[102:103], v[54:55] op_sel:[0,0] op_sel_hi:[0,1]
    v_pk_fma_f32 v[102:103], v[102:103], v[54:55], v[106:107] op_sel:[1,1,0] op_sel_hi:[1,0,1] neg_lo:[0,1,0]
    v_cvt_pk_bf16_f32 v220, v100, v101
    v_cvt_pk_bf16_f32 v221, v102, v103
    v_pk_mul_f32 v[104:105], v[100:101], v[52:53] op_sel:[0,0] op_sel_hi:[0,1]
    v_pk_fma_f32 v[100:101], v[100:101], v[52:53], v[104:105] op_sel:[1,1,0] op_sel_hi:[1,0,1] neg_lo:[0,1,0]
    v_pk_mul_f32 v[106:107], v[102:103], v[54:55] op_sel:[0,0] op_sel_hi:[0,1]
    v_pk_fma_f32 v[102:103], v[102:103], v[54:55], v[106:107] op_sel:[1,1,0] op_sel_hi:[1,0,1] neg_lo:[0,1,0]
    v_cvt_pk_bf16_f32 v222, v100, v101
    v_cvt_pk_bf16_f32 v223, v102, v103
    ds_write_b64 v21, v[216:217] offset:4352
    ds_write_b64 v21, v[218:219] offset:4896
    ds_write_b64 v21, v[220:221] offset:5440
    ds_write_b64 v21, v[222:223] offset:5984
    v_pk_mul_f32 v[104:105], v[100:101], v[52:53] op_sel:[0,0] op_sel_hi:[0,1]
    v_pk_fma_f32 v[100:101], v[100:101], v[52:53], v[104:105] op_sel:[1,1,0] op_sel_hi:[1,0,1] neg_lo:[0,1,0]
    v_pk_mul_f32 v[106:107], v[102:103], v[54:55] op_sel:[0,0] op_sel_hi:[0,1]
    v_pk_fma_f32 v[102:103], v[102:103], v[54:55], v[106:107] op_sel:[1,1,0] op_sel_hi:[1,0,1] neg_lo:[0,1,0]
    v_cvt_pk_bf16_f32 v216, v100, v101
    v_cvt_pk_bf16_f32 v217, v102, v103
    v_pk_mul_f32 v[104:105], v[100:101], v[52:53] op_sel:[0,0] op_sel_hi:[0,1]
    v_pk_fma_f32 v[100:101], v[100:101], v[52:53], v[104:105] op_sel:[1,1,0] op_sel_hi:[1,0,1] neg_lo:[0,1,0]
    v_pk_mul_f32 v[106:107], v[102:103], v[54:55] op_sel:[0,0] op_sel_hi:[0,1]
    v_pk_fma_f32 v[102:103], v[102:103], v[54:55], v[106:107] op_sel:[1,1,0] op_sel_hi:[1,0,1] neg_lo:[0,1,0]
    v_cvt_pk_bf16_f32 v218, v100, v101
    v_cvt_pk_bf16_f32 v219, v102, v103
    v_pk_mul_f32 v[104:105], v[100:101], v[52:53] op_sel:[0,0] op_sel_hi:[0,1]
    v_pk_fma_f32 v[100:101], v[100:101], v[52:53], v[104:105] op_sel:[1,1,0] op_sel_hi:[1,0,1] neg_lo:[0,1,0]
    v_pk_mul_f32 v[106:107], v[102:103], v[54:55] op_sel:[0,0] op_sel_hi:[0,1]
    v_pk_fma_f32 v[102:103], v[102:103], v[54:55], v[106:107] op_sel:[1,1,0] op_sel_hi:[1,0,1] neg_lo:[0,1,0]
    v_cvt_pk_bf16_f32 v220, v100, v101
    v_cvt_pk_bf16_f32 v221, v102, v103
    v_pk_mul_f32 v[104:105], v[100:101], v[52:53] op_sel:[0,0] op_sel_hi:[0,1]
    v_pk_fma_f32 v[100:101], v[100:101], v[52:53], v[104:105] op_sel:[1,1,0] op_sel_hi:[1,0,1] neg_lo:[0,1,0]
    v_pk_mul_f32 v[106:107], v[102:103], v[54:55] op_sel:[0,0] op_sel_hi:[0,1]
    v_pk_fma_f32 v[102:103], v[102:103], v[54:55], v[106:107] op_sel:[1,1,0] op_sel_hi:[1,0,1] neg_lo:[0,1,0]
    v_cvt_pk_bf16_f32 v222, v100, v101
    v_cvt_pk_bf16_f32 v223, v102, v103
    ds_write_b64 v21, v[216:217] offset:6528
    ds_write_b64 v21, v[218:219] offset:7072
    ds_write_b64 v21, v[220:221] offset:7616
    ds_write_b64 v21, v[222:223] offset:8160
    s_cmp_lg_u32 s87, 0
    s_cbranch_scc1 L_nopub_9
    s_getreg_b32 s44, hwreg(HW_REG_IB_STS, 0, 4)
    s_cmp_lg_u32 s44, 0
    s_cbranch_scc1 L_nopub_9
    s_waitcnt vmcnt(0)
    s_lshl_b32 s44, s59, 4
    s_add_u32 s44, s44, 4096
    v_mov_b32 v7, s37
    v_mul_u32_u24 v6, 4096, v1
    v_add_u32_e64 v6, s44, v6
    s_mov_b64 exec, 0xff
    global_store_dword v6, v7, s[32:33] sc1
    s_mov_b64 exec, -1
    s_mov_b32 s87, 1
L_nopub_9:
    v_cvt_pk_bf16_f32 v216, v96, -v97
    v_cvt_pk_bf16_f32 v217, v98, -v99
    v_pk_mul_f32 v[104:105], v[96:97], v[68:69] op_sel:[0,0] op_sel_hi:[0,1]
    v_pk_fma_f32 v[100:101], v[96:97], v[68:69], v[104:105] op_sel:[1,1,0] op_sel_hi:[1,0,1] neg_lo:[0,1,0]
    v_pk_mul_f32 v[106:107], v[98:99], v[70:71] op_sel:[0,0] op_sel_hi:[0,1]
    v_pk_fma_f32 v[102:103], v[98:99], v[70:71], v[106:107] op_sel:[1,1,0] op_sel_hi:[1,0,1] neg_lo:[0,1,0]
    v_cvt_pk_bf16_f32 v218, v100, -v101
    v_cvt_pk_bf16_f32 v219, v102, -v103
    v_pk_mul_f32 v[104:105], v[100:101], v[68:69] op_sel:[0,0] op_sel_hi:[0,1]
    v_pk_fma_f32 v[100:101], v[100:101], v[68:69], v[104:105] op_sel:[1,1,0] op_sel_hi:[1,0,1] neg_lo:[0,1,0]
    v_pk_mul_f32 v[106:107], v[102:103], v[70:71] op_sel:[0,0] op_sel_hi:[0,1]
    v_pk_fma_f32 v[102:103], v[102:103], v[70:71], v[106:107] op_sel:[1,1,0] op_sel_hi:[1,0,1] neg_lo:[0,1,0]
    v_cvt_pk_bf16_f32 v220, v100, -v101
    v_cvt_pk_bf16_f32 v221, v102, -v103
    v_pk_mul_f32 v[104:105], v[100:101], v[68:69] op_sel:[0,0] op_sel_hi:[0,1]
    v_pk_fma_f32 v[100:101], v[100:101], v[68:69], v[104:105] op_sel:[1,1,0] op_sel_hi:[1,0,1] neg_lo:[0,1,0]
    v_pk_mul_f32 v[106:107], v[102:103], v[70:71] op_sel:[0,0] op_sel_hi:[0,1]
    v_pk_fma_f32 v[102:103], v[102:103], v[70:71], v[106:107] op_sel:[1,1,0] op_sel_hi:[1,0,1] neg_lo:[0,1,0]
    v_cvt_pk_bf16_f32 v222, v100, -v101
    v_cvt_pk_bf16_f32 v223, v102, -v103
    ds_write_b64 v21, v[216:217] offset:8704
    ds_write_b64 v21, v[218:219] offset:9248
    ds_write_b64 v21, v[220:221] offset:9792
    ds_write_b64 v21, v[222:223] offset:10336
    v_pk_mul_f32 v[104:105], v[100:101], v[68:69] op_sel:[0,0] op_sel_hi:[0,1]
    v_pk_fma_f32 v[100:101], v[100:101], v[68:69], v[104:105] op_sel:[1,1,0] op_sel_hi:[1,0,1] neg_lo:[0,1,0]
    v_pk_mul_f32 v[106:107], v[102:103], v[70:71] op_sel:[0,0] op_sel_hi:[0,1]
    v_pk_fma_f32 v[102:103], v[102:103], v[70:71], v[106:107] op_sel:[1,1,0] op_sel_hi:[1,0,1] neg_lo:[0,1,0]
    v_cvt_pk_bf16_f32 v216, v100, -v101
    v_cvt_pk_bf16_f32 v217, v102, -v103
    v_pk_mul_f32 v[104:105], v[100:101], v[68:69] op_sel:[0,0] op_sel_hi:[0,1]
    v_pk_fma_f32 v[100:101], v[100:101], v[68:69], v[104:105] op_sel:[1,1,0] op_sel_hi:[1,0,1] neg_lo:[0,1,0]
    v_pk_mul_f32 v[106:107], v[102:103], v[70:71] op_sel:[0,0] op_sel_hi:[0,1]
    v_pk_fma_f32 v[102:103], v[102:103], v[70:71], v[106:107] op_sel:[1,1,0] op_sel_hi:[1,0,1] neg_lo:[0,1,0]
    v_cvt_pk_bf16_f32 v218, v100, -v101
    v_cvt_pk_bf16_f32 v219, v102, -v103
    v_pk_mul_f32 v[104:105], v[100:101], v[68:69] op_sel:[0,0] op_sel_hi:[0,1]
    v_pk_fma_f32 v[100:101], v[100:101], v[68:69], v[104:105] op_sel:[1,1,0] op_sel_hi:[1,0,1] neg_lo:[0,1,0]
    v_pk_mul_f32 v[106:107], v[102:103], v[70:71] op_sel:[0,0] op_sel_hi:[0,1]
    v_pk_fma_f32 v[102:103], v[102:103], v[70:71], v[106:107] op_sel:[1,1,0] op_sel_hi:[1,0,1] neg_lo:[0,1,0]
    v_cvt_pk_bf16_f32 v220, v100, -v101
    v_cvt_pk_bf16_f32 v221, v102, -v103
    v_pk_mul_f32 v[104:105], v[100:101], v[68:69] op_sel:[0,0] op_sel_hi:[0,1]
    v_pk_fma_f32 v[100:101], v[100:101], v[68:69], v[104:105] op_sel:[1,1,0] op_sel_hi:[1,0,1] neg_lo:[0,1,0]
    v_pk_mul_f32 v[106:107], v[102:103], v[70:71] op_sel:[0,0] op_sel_hi:[0,1]
    v_pk_fma_f32 v[102:103], v[102:103], v[70:71], v[106:107] op_sel:[1,1,0] op_sel_hi:[1,0,1] neg_lo:[0,1,0]
    v_cvt_pk_bf16_f32 v222, v100, -v101
    v_cvt_pk_bf16_f32 v223, v102, -v103
    ds_write_b64 v21, v[216:217] offset:10880
    ds_write_b64 v21, v[218:219] offset:11424
    ds_write_b64 v21, v[220:221] offset:11968
    ds_write_b64 v21, v[222:223] offset:12512
    v_pk_mul_f32 v[104:105], v[100:101], v[68:69] op_sel:[0,0] op_sel_hi:[0,1]
    v_pk_fma_f32 v[100:101], v[100:101], v[68:69], v[104:105] op_sel:[1,1,0] op_sel_hi:[1,0,1] neg_lo:[0,1,0]
    v_pk_mul_f32 v[106:107], v[102:103], v[70:71] op_sel:[0,0] op_sel_hi:[0,1]
    v_pk_fma_f32 v[102:103], v[102:103], v[70:71], v[106:107] op_sel:[1,1,0] op_sel_hi:[1,0,1] neg_lo:[0,1,0]
    v_cvt_pk_bf16_f32 v216, v100, -v101
    v_cvt_pk_bf16_f32 v217, v102, -v103
    v_pk_mul_f32 v[104:105], v[100:101], v[68:69] op_sel:[0,0] op_sel_hi:[0,1]
    v_pk_fma_f32 v[100:101], v[100:101], v[68:69], v[104:105] op_sel:[1,1,0] op_sel_hi:[1,0,1] neg_lo:[0,1,0]
    v_pk_mul_f32 v[106:107], v[102:103], v[70:71] op_sel:[0,0] op_sel_hi:[0,1]
    v_pk_fma_f32 v[102:103], v[102:103], v[70:71], v[106:107] op_sel:[1,1,0] op_sel_hi:[1,0,1] neg_lo:[0,1,0]
    v_cvt_pk_bf16_f32 v218, v100, -v101
    v_cvt_pk_bf16_f32 v219, v102, -v103
    v_pk_mul_f32 v[104:105], v[100:101], v[68:69] op_sel:[0,0] op_sel_hi:[0,1]
    v_pk_fma_f32 v[100:101], v[100:101], v[68:69], v[104:105] op_sel:[1,1,0] op_sel_hi:[1,0,1] neg_lo:[0,1,0]
    v_pk_mul_f32 v[106:107], v[102:103], v[70:71] op_sel:[0,0] op_sel_hi:[0,1]
    v_pk_fma_f32 v[102:103], v[102:103], v[70:71], v[106:107] op_sel:[1,1,0] op_sel_hi:[1,0,1] neg_lo:[0,1,0]
    v_cvt_pk_bf16_f32 v220, v100, -v101
    v_cvt_pk_bf16_f32 v221, v102, -v103
    v_pk_mul_f32 v[104:105], v[100:101], v[68:69] op_sel:[0,0] op_sel_hi:[0,1]
    v_pk_fma_f32 v[100:101], v[100:101], v[68:69], v[104:105] op_sel:[1,1,0] op_sel_hi:[1,0,1] neg_lo:[0,1,0]
    v_pk_mul_f32 v[106:107], v[102:103], v[70:71] op_sel:[0,0] op_sel_hi:[0,1]
    v_pk_fma_f32 v[102:103], v[102:103], v[70:71], v[106:107] op_sel:[1,1,0] op_sel_hi:[1,0,1] neg_lo:[0,1,0]
    v_cvt_pk_bf16_f32 v222, v100, -v101
    v_cvt_pk_bf16_f32 v223, v102, -v103
    ds_write_b64 v21, v[216:217] offset:13056
    ds_write_b64 v21, v[218:219] offset:13600
    ds_write_b64 v21, v[220:221] offset:14144
    ds_write_b64 v21, v[222:223] offset:14688
    v_pk_mul_f32 v[104:105], v[100:101], v[68:69] op_sel:[0,0] op_sel_hi:[0,1]
    v_pk_fma_f32 v[100:101], v[100:101], v[68:69], v[104:105] op_sel:[1,1,0] op_sel_hi:[1,0,1] neg_lo:[0,1,0]
    v_pk_mul_f32 v[106:107], v[102:103], v[70:71] op_sel:[0,0] op_sel_hi:[0,1]
    v_pk_fma_f32 v[102:103], v[102:103], v[70:71], v[106:107] op_sel:[1,1,0] op_sel_hi:[1,0,1] neg_lo:[0,1,0]
    v_cvt_pk_bf16_f32 v216, v100, -v101
    v_cvt_pk_bf16_f32 v217, v102, -v103
    v_pk_mul_f32 v[104:105], v[100:101], v[68:69] op_sel:[0,0] op_sel_hi:[0,1]
    v_pk_fma_f32 v[100:101], v[100:101], v[68:69], v[104:105] op_sel:[1,1,0] op_sel_hi:[1,0,1] neg_lo:[0,1,0]
    v_pk_mul_f32 v[106:107], v[102:103], v[70:71] op_sel:[0,0] op_sel_hi:[0,1]
    v_pk_fma_f32 v[102:103], v[102:103], v[70:71], v[106:107] op_sel:[1,1,0] op_sel_hi:[1,0,1] neg_lo:[0,1,0]
    v_cvt_pk_bf16_f32 v218, v100, -v101
    v_cvt_pk_bf16_f32 v219, v102, -v103
    v_pk_mul_f32 v[104:105], v[100:101], v[68:69] op_sel:[0,0] op_sel_hi:[0,1]
    v_pk_fma_f32 v[100:101], v[100:101], v[68:69], v[104:105] op_sel:[1,1,0] op_sel_hi:[1,0,1] neg_lo:[0,1,0]
    v_pk_mul_f32 v[106:107], v[102:103], v[70:71] op_sel:[0,0] op_sel_hi:[0,1]
    v_pk_fma_f32 v[102:103], v[102:103], v[70:71], v[106:107] op_sel:[1,1,0] op_sel_hi:[1,0,1] neg_lo:[0,1,0]
    v_cvt_pk_bf16_f32 v220, v100, -v101
    v_cvt_pk_bf16_f32 v221, v102, -v103
    v_pk_mul_f32 v[104:105], v[100:101], v[68:69] op_sel:[0,0] op_sel_hi:[0,1]
    v_pk_fma_f32 v[100:101], v[100:101], v[68:69], v[104:105] op_sel:[1,1,0] op_sel_hi:[1,0,1] neg_lo:[0,1,0]
    v_pk_mul_f32 v[106:107], v[102:103], v[70:71] op_sel:[0,0] op_sel_hi:[0,1]
    v_pk_fma_f32 v[102:103], v[102:103], v[70:71], v[106:107] op_sel:[1,1,0] op_sel_hi:[1,0,1] neg_lo:[0,1,0]
    v_cvt_pk_bf16_f32 v222, v100, -v101
    v_cvt_pk_bf16_f32 v223, v102, -v103
    ds_write_b64 v21, v[216:217] offset:15232
    ds_write_b64 v21, v[218:219] offset:15776
    ds_write_b64 v21, v[220:221] offset:16320
    ds_write_b64 v21, v[222:223] offset:16864
    s_waitcnt lgkmcnt(0)
    ds_read_b128 v[144:147], v22 offset:0
    ds_read_b128 v[148:151], v22 offset:8704
    ds_read_b128 v[152:155], v22 offset:64
    ds_read_b128 v[156:159], v22 offset:8768
    ds_read_b128 v[160:163], v22 offset:128
    ds_read_b128 v[164:167], v22 offset:8832
    ds_read_b128 v[168:171], v22 offset:192
    ds_read_b128 v[172:175], v22 offset:8896
    ds_read_b128 v[176:179], v22 offset:256
    ds_read_b128 v[180:183], v22 offset:8960
    ds_read_b128 v[184:187], v22 offset:320
    ds_read_b128 v[188:191], v22 offset:9024
    ds_read_b128 v[192:195], v22 offset:384
    ds_read_b128 v[196:199], v22 offset:9088
    ds_read_b128 v[200:203], v22 offset:448
    ds_read_b128 v[204:207], v22 offset:9152
    s_cmp_lg_u32 s87, 0
    s_cbranch_scc1 L_nopub_10
    s_getreg_b32 s44, hwreg(HW_REG_IB_STS, 0, 4)
    s_cmp_lg_u32 s44, 0
    s_cbranch_scc1 L_nopub_10
    s_waitcnt vmcnt(0)
    s_lshl_b32 s44, s59, 4
    s_add_u32 s44, s44, 4096
    v_mov_b32_e64 v7, s37
    v_mul_u32_u24 v6, 4096, v1
    v_add_u32_e64 v6, s44, v6
    s_mov_b64 exec, 0xff
    global_store_dword v6, v7, s[32:33] sc1
    s_mov_b64 exec, -1
    s_mov_b32 s87, 1
L_nopub_10:
    v_cvt_pk_bf16_f32 v112, v68, v69
    v_cvt_pk_bf16_f32 v113, v70, v71
    v_pk_mul_f32 v[104:105], v[68:69], v[56:57] op_sel:[0,0] op_sel_hi:[0,1]
    v_pk_fma_f32 v[100:101], v[68:69], v[56:57], v[104:105] op_sel:[1,1,0] op_sel_hi:[1,0,1] neg_lo:[0,1,0]
    v_pk_mul_f32 v[106:107], v[70:71], v[58:59] op_sel:[0,0] op_sel_hi:[0,1]
    v_pk_fma_f32 v[102:103], v[70:71], v[58:59], v[106:107] op_sel:[1,1,0] op_sel_hi:[1,0,1] neg_lo:[0,1,0]
    v_cvt_pk_bf16_f32 v114, v100, v101
    v_cvt_pk_bf16_f32 v115, v102, v103
    v_pk_mul_f32 v[104:105], v[100:101], v[56:57] op_sel:[0,0] op_sel_hi:[0,1]
    v_pk_fma_f32 v[100:101], v[100:101], v[56:57], v[104:105] op_sel:[1,1,0] op_sel_hi:[1,0,1] neg_lo:[0,1,0]
    v_pk_mul_f32 v[106:107], v[102:103], v[58:59] op_sel:[0,0] op_sel_hi:[0,1]
    v_pk_fma_f32 v[102:103], v[102:103], v[58:59], v[106:107] op_sel:[1,1,0] op_sel_hi:[1,0,1] neg_lo:[0,1,0]
    v_cvt_pk_bf16_f32 v116, v100, v101
    v_cvt_pk_bf16_f32 v117, v102, v103
    v_pk_mul_f32 v[104:105], v[100:101], v[56:57] op_sel:[0,0] op_sel_hi:[0,1]
    v_pk_fma_f32 v[100:101], v[100:101], v[56:57], v[104:105] op_sel:[1,1,0] op_sel_hi:[1,0,1] neg_lo:[0,1,0]
    v_pk_mul_f32 v[106:107], v[102:103], v[58:59] op_sel:[0,0] op_sel_hi:[0,1]
    v_pk_fma_f32 v[102:103], v[102:103], v[58:59], v[106:107] op_sel:[1,1,0] op_sel_hi:[1,0,1] neg_lo:[0,1,0]
    v_cvt_pk_bf16_f32 v118, v100, v101
    v_cvt_pk_bf16_f32 v119, v102, v103
    v_pk_mul_f32 v[104:105], v[100:101], v[56:57] op_sel:[0,0] op_sel_hi:[0,1]
    v_pk_fma_f32 v[100:101], v[100:101], v[56:57], v[104:105] op_sel:[1,1,0] op_sel_hi:[1,0,1] neg_lo:[0,1,0]
    v_pk_mul_f32 v[106:107], v[102:103], v[58:59] op_sel:[0,0] op_sel_hi:[0,1]
    v_pk_fma_f32 v[102:103], v[102:103], v[58:59], v[106:107] op_sel:[1,1,0] op_sel_hi:[1,0,1] neg_lo:[0,1,0]
    v_cvt_pk_bf16_f32 v120, v100, v101
    v_cvt_pk_bf16_f32 v121, v102, v103
    v_pk_mul_f32 v[104:105], v[100:101], v[56:57] op_sel:[0,0] op_sel_hi:[0,1]
    v_pk_fma_f32 v[100:101], v[100:101], v[56:57], v[104:105] op_sel:[1,1,0] op_sel_hi:[1,0,1] neg_lo:[0,1,0]
    v_pk_mul_f32 v[106:107], v[102:103], v[58:59] op_sel:[0,0] op_sel_hi:[0,1]
    v_pk_fma_f32 v[102:103], v[102:103], v[58:59], v[106:107] op_sel:[1,1,0] op_sel_hi:[1,0,1] neg_lo:[0,1,0]
    v_cvt_pk_bf16_f32 v122, v100, v101
    v_cvt_pk_bf16_f32 v123, v102, v103
    v_pk_mul_f32 v[104:105], v[100:101], v[56:57] op_sel:[0,0] op_sel_hi:[0,1]
    v_pk_fma_f32 v[100:101], v[100:101], v[56:57], v[104:105] op_sel:[1,1,0] op_sel_hi:[1,0,1] neg_lo:[0,1,0]
    v_pk_mul_f32 v[106:107], v[102:103], v[58:59] op_sel:[0,0] op_sel_hi:[0,1]
    v_pk_fma_f32 v[102:103], v[102:103], v[58:59], v[106:107] op_sel:[1,1,0] op_sel_hi:[1,0,1] neg_lo:[0,1,0]
    v_cvt_pk_bf16_f32 v124, v100, v101
    v_cvt_pk_bf16_f32 v125, v102, v103
    v_pk_mul_f32 v[104:105], v[100:101], v[56:57] op_sel:[0,0] op_sel_hi:[0,1]
    v_pk_fma_f32 v[100:101], v[100:101], v[56:57], v[104:105] op_sel:[1,1,0] op_sel_hi:[1,0,1] neg_lo:[0,1,0]
    v_pk_mul_f32 v[106:107], v[102:103], v[58:59] op_sel:[0,0] op_sel_hi:[0,1]
    v_pk_fma_f32 v[102:103], v[102:103], v[58:59], v[106:107] op_sel:[1,1,0] op_sel_hi:[1,0,1] neg_lo:[0,1,0]
    v_cvt_pk_bf16_f32 v126, v100, v101
    v_cvt_pk_bf16_f32 v127, v102, v103
    s_waitcnt lgkmcnt(0)
    v_mfma_f32_16x16x32_bf16 v[208:211], v[144:147], v[148:151], 0
    ds_write_b64 v21, v[112:113] offset:544
    v_mfma_f32_16x16x32_bf16 v[208:211], v[152:155], v[156:159], v[208:211]
    ds_write_b64 v21, v[114:115] offset:1632
    v_mfma_f32_16x16x32_bf16 v[208:211], v[160:163], v[164:167], v[208:211]
    ds_write_b64 v21, v[116:117] offset:2720
    v_mfma_f32_16x16x32_bf16 v[208:211], v[168:171], v[172:175], v[208:211]
    ds_write_b64 v21, v[118:119] offset:3808
    v_mfma_f32_16x16x32_bf16 v[208:211], v[176:179], v[180:183], v[208:211]
    ds_write_b64 v21, v[120:121] offset:4896
    v_mfma_f32_16x16x32_bf16 v[208:211], v[184:187], v[188:191], v[208:211]
    ds_write_b64 v21, v[122:123] offset:5984
    v_mfma_f32_16x16x32_bf16 v[208:211], v[192:195], v[196:199], v[208:211]
    ds_write_b64 v21, v[124:125] offset:7072
    v_mfma_f32_16x16x32_bf16 v[208:211], v[200:203], v[204:207], v[208:211]
    ds_write_b64 v21, v[126:127] offset:8160
    s_nop 6
    v_cvt_pk_bf16_f32 v2, v208, v209
    v_cvt_pk_bf16_f32 v3, v210, v211
    ds_write_b64 v26, v[2:3] offset:0
    s_cmp_lg_u32 s87, 0
    s_cbranch_scc1 L_nopub_11
    s_getreg_b32 s44, hwreg(HW_REG_IB_STS, 0, 4)
    s_cmp_lg_u32 s44, 0
    s_cbranch_scc1 L_nopub_11
    s_waitcnt vmcnt(0)
    s_lshl_b32 s44, s59, 4
    s_add_u32 s44, s44, 4096
    v_mov_b32 v7, s37
    v_mul_u32_u24 v6, 4096, v1
    v_add_u32_e64 v6, s44, v6
    s_mov_b64 exec, 0xff
    global_store_dword v6, v7, s[32:33] sc1
    s_mov_b64 exec, -1
    s_mov_b32 s87, 1
L_nopub_11:
    v_pk_mul_f32 v[104:105], v[96:97], v[84:85] op_sel:[0,0] op_sel_hi:[0,1]
    v_pk_fma_f32 v[100:101], v[96:97], v[84:85], v[104:105] op_sel:[1,1,0] op_sel_hi:[1,0,1] neg_lo:[0,1,0]
    v_pk_mul_f32 v[106:107], v[98:99], v[86:87] op_sel:[0,0] op_sel_hi:[0,1]
    v_pk_fma_f32 v[102:103], v[98:99], v[86:87], v[106:107] op_sel:[1,1,0] op_sel_hi:[1,0,1] neg_lo:[0,1,0]
    v_cvt_pk_bf16_f32 v216, v100, -v101
    v_cvt_pk_bf16_f32 v217, v102, -v103
    v_pk_mul_f32 v[104:105], v[100:101], v[72:73] op_sel:[0,0] op_sel_hi:[0,1]
    v_pk_fma_f32 v[100:101], v[100:101], v[72:73], v[104:105] op_sel:[1,1,0] op_sel_hi:[1,0,1] neg_lo:[0,1,0]
    v_pk_mul_f32 v[106:107], v[102:103], v[74:75] op_sel:[0,0] op_sel_hi:[0,1]
    v_pk_fma_f32 v[102:103], v[102:103], v[74:75], v[106:107] op_sel:[1,1,0] op_sel_hi:[1,0,1] neg_lo:[0,1,0]
    v_cvt_pk_bf16_f32 v218, v100, -v101
    v_cvt_pk_bf16_f32 v219, v102, -v103
    v_pk_mul_f32 v[104:105], v[100:101], v[72:73] op_sel:[0,0] op_sel_hi:[0,1]
    v_pk_fma_f32 v[100:101], v[100:101], v[72:73], v[104:105] op_sel:[1,1,0] op_sel_hi:[1,0,1] neg_lo:[0,1,0]
    v_pk_mul_f32 v[106:107], v[102:103], v[74:75] op_sel:[0,0] op_sel_hi:[0,1]
    v_pk_fma_f32 v[102:103], v[102:103], v[74:75], v[106:107] op_sel:[1,1,0] op_sel_hi:[1,0,1] neg_lo:[0,1,0]
    v_cvt_pk_bf16_f32 v220, v100, -v101
    v_cvt_pk_bf16_f32 v221, v102, -v103
    v_pk_mul_f32 v[104:105], v[100:101], v[72:73] op_sel:[0,0] op_sel_hi:[0,1]
    v_pk_fma_f32 v[100:101], v[100:101], v[72:73], v[104:105] op_sel:[1,1,0] op_sel_hi:[1,0,1] neg_lo:[0,1,0]
    v_pk_mul_f32 v[106:107], v[102:103], v[74:75] op_sel:[0,0] op_sel_hi:[0,1]
    v_pk_fma_f32 v[102:103], v[102:103], v[74:75], v[106:107] op_sel:[1,1,0] op_sel_hi:[1,0,1] neg_lo:[0,1,0]
    v_cvt_pk_bf16_f32 v222, v100, -v101
    v_cvt_pk_bf16_f32 v223, v102, -v103
    ds_write_b64 v21, v[216:217] offset:8704
    ds_write_b64 v21, v[218:219] offset:9248
    ds_write_b64 v21, v[220:221] offset:9792
    ds_write_b64 v21, v[222:223] offset:10336
    v_pk_mul_f32 v[104:105], v[100:101], v[72:73] op_sel:[0,0] op_sel_hi:[0,1]
    v_pk_fma_f32 v[100:101], v[100:101], v[72:73], v[104:105] op_sel:[1,1,0] op_sel_hi:[1,0,1] neg_lo:[0,1,0]
    v_pk_mul_f32 v[106:107], v[102:103], v[74:75] op_sel:[0,0] op_sel_hi:[0,1]
    v_pk_fma_f32 v[102:103], v[102:103], v[74:75], v[106:107] op_sel:[1,1,0] op_sel_hi:[1,0,1] neg_lo:[0,1,0]
    v_cvt_pk_bf16_f32 v216, v100, -v101
    v_cvt_pk_bf16_f32 v217, v102, -v103
    v_pk_mul_f32 v[104:105], v[100:101], v[72:73] op_sel:[0,0] op_sel_hi:[0,1]
    v_pk_fma_f32 v[100:101], v[100:101], v[72:73], v[104:105] op_sel:[1,1,0] op_sel_hi:[1,0,1] neg_lo:[0,1,0]
    v_pk_mul_f32 v[106:107], v[102:103], v[74:75] op_sel:[0,0] op_sel_hi:[0,1]
    v_pk_fma_f32 v[102:103], v[102:103], v[74:75], v[106:107] op_sel:[1,1,0] op_sel_hi:[1,0,1] neg_lo:[0,1,0]
    v_cvt_pk_bf16_f32 v218, v100, -v101
    v_cvt_pk_bf16_f32 v219, v102, -v103
    v_pk_mul_f32 v[104:105], v[100:101], v[72:73] op_sel:[0,0] op_sel_hi:[0,1]
    v_pk_fma_f32 v[100:101], v[100:101], v[72:73], v[104:105] op_sel:[1,1,0] op_sel_hi:[1,0,1] neg_lo:[0,1,0]
    v_pk_mul_f32 v[106:107], v[102:103], v[74:75] op_sel:[0,0] op_sel_hi:[0,1]
    v_pk_fma_f32 v[102:103], v[102:103], v[74:75], v[106:107] op_sel:[1,1,0] op_sel_hi:[1,0,1] neg_lo:[0,1,0]
    v_cvt_pk_bf16_f32 v220, v100, -v101
    v_cvt_pk_bf16_f32 v221, v102, -v103
    v_pk_mul_f32 v[104:105], v[100:101], v[72:73] op_sel:[0,0] op_sel_hi:[0,1]
    v_pk_fma_f32 v[100:101], v[100:101], v[72:73], v[104:105] op_sel:[1,1,0] op_sel_hi:[1,0,1] neg_lo:[0,1,0]
    v_pk_mul_f32 v[106:107], v[102:103], v[74:75] op_sel:[0,0] op_sel_hi:[0,1]
    v_pk_fma_f32 v[102:103], v[102:103], v[74:75], v[106:107] op_sel:[1,1,0] op_sel_hi:[1,0,1] neg_lo:[0,1,0]
    v_cvt_pk_bf16_f32 v222, v100, -v101
    v_cvt_pk_bf16_f32 v223, v102, -v103
    ds_write_b64 v21, v[216:217] offset:10880
    ds_write_b64 v21, v[218:219] offset:11424
    ds_write_b64 v21, v[220:221] offset:11968
    ds_write_b64 v21, v[222:223] offset:12512
    s_waitcnt lgkmcnt(0)
    ds_read_b128 v[144:147], v23 offset:0
    ds_read_b128 v[148:151], v22 offset:8704
    ds_read_b128 v[152:155], v23 offset:64
    ds_read_b128 v[156:159], v22 offset:8768
    ds_read_b128 v[160:163], v23 offset:128
    ds_read_b128 v[164:167], v22 offset:8832
    ds_read_b128 v[168:171], v23 offset:192
    ds_read_b128 v[172:175], v22 offset:8896
    ds_read_b128 v[176:179], v23 offset:256
    ds_read_b128 v[180:183], v22 offset:8960
    ds_read_b128 v[184:187], v23 offset:320
    ds_read_b128 v[188:191], v22 offset:9024
    ds_read_b128 v[192:195], v23 offset:384
    ds_read_b128 v[196:199], v22 offset:9088
    ds_read_b128 v[200:203], v23 offset:448
    ds_read_b128 v[204:207], v22 offset:9152
    s_cmp_lg_u32 s87, 0
    s_cbranch_scc1 L_nopub_12
    s_getreg_b32 s44, hwreg(HW_REG_IB_STS, 0, 4)
    s_cmp_lg_u32 s44, 0
    s_cbranch_scc1 L_nopub_12
    s_waitcnt vmcnt(0)
    s_lshl_b32 s44, s59, 4
    s_add_u32 s44, s44, 4096
    v_mov_b32_e64 v7, s37
    v_mul_u32_u24 v6, 4096, v1
    v_add_u32_e64 v6, s44, v6
    s_mov_b64 exec, 0xff
    global_store_dword v6, v7, s[32:33] sc1
    s_mov_b64 exec, -1
    s_mov_b32 s87, 1
L_nopub_12:
    v_cvt_pk_bf16_f32 v112, v72, v73
    v_cvt_pk_bf16_f32 v113, v74, v75
    v_pk_mul_f32 v[104:105], v[72:73], v[60:61] op_sel:[0,0] op_sel_hi:[0,1]
    v_pk_fma_f32 v[100:101], v[72:73], v[60:61], v[104:105] op_sel:[1,1,0] op_sel_hi:[1,0,1] neg_lo:[0,1,0]
    v_pk_mul_f32 v[106:107], v[74:75], v[62:63] op_sel:[0,0] op_sel_hi:[0,1]
    v_pk_fma_f32 v[102:103], v[74:75], v[62:63], v[106:107] op_sel:[1,1,0] op_sel_hi:[1,0,1] neg_lo:[0,1,0]
    v_cvt_pk_bf16_f32 v114, v100, v101
    v_cvt_pk_bf16_f32 v115, v102, v103
    v_pk_mul_f32 v[104:105], v[100:101], v[60:61] op_sel:[0,0] op_sel_hi:[0,1]
    v_pk_fma_f32 v[100:101], v[100:101], v[60:61], v[104:105] op_sel:[1,1,0] op_sel_hi:[1,0,1] neg_lo:[0,1,0]
    v_pk_mul_f32 v[106:107], v[102:103], v[62:63] op_sel:[0,0] op_sel_hi:[0,1]
    v_pk_fma_f32 v[102:103], v[102:103], v[62:63], v[106:107] op_sel:[1,1,0] op_sel_hi:[1,0,1] neg_lo:[0,1,0]
    v_cvt_pk_bf16_f32 v116, v100, v101
    v_cvt_pk_bf16_f32 v117, v102, v103
    v_pk_mul_f32 v[104:105], v[100:101], v[60:61] op_sel:[0,0] op_sel_hi:[0,1]
    v_pk_fma_f32 v[100:101], v[100:101], v[60:61], v[104:105] op_sel:[1,1,0] op_sel_hi:[1,0,1] neg_lo:[0,1,0]
    v_pk_mul_f32 v[106:107], v[102:103], v[62:63] op_sel:[0,0] op_sel_hi:[0,1]
    v_pk_fma_f32 v[102:103], v[102:103], v[62:63], v[106:107] op_sel:[1,1,0] op_sel_hi:[1,0,1] neg_lo:[0,1,0]
    v_cvt_pk_bf16_f32 v118, v100, v101
    v_cvt_pk_bf16_f32 v119, v102, v103
    v_pk_mul_f32 v[104:105], v[100:101], v[60:61] op_sel:[0,0] op_sel_hi:[0,1]
    v_pk_fma_f32 v[100:101], v[100:101], v[60:61], v[104:105] op_sel:[1,1,0] op_sel_hi:[1,0,1] neg_lo:[0,1,0]
    v_pk_mul_f32 v[106:107], v[102:103], v[62:63] op_sel:[0,0] op_sel_hi:[0,1]
    v_pk_fma_f32 v[102:103], v[102:103], v[62:63], v[106:107] op_sel:[1,1,0] op_sel_hi:[1,0,1] neg_lo:[0,1,0]
    v_cvt_pk_bf16_f32 v120, v100, v101
    v_cvt_pk_bf16_f32 v121, v102, v103
    v_pk_mul_f32 v[104:105], v[100:101], v[60:61] op_sel:[0,0] op_sel_hi:[0,1]
    v_pk_fma_f32 v[100:101], v[100:101], v[60:61], v[104:105] op_sel:[1,1,0] op_sel_hi:[1,0,1] neg_lo:[0,1,0]
    v_pk_mul_f32 v[106:107], v[102:103], v[62:63] op_sel:[0,0] op_sel_hi:[0,1]
    v_pk_fma_f32 v[102:103], v[102:103], v[62:63], v[106:107] op_sel:[1,1,0] op_sel_hi:[1,0,1] neg_lo:[0,1,0]
    v_cvt_pk_bf16_f32 v122, v100, v101
    v_cvt_pk_bf16_f32 v123, v102, v103
    v_pk_mul_f32 v[104:105], v[100:101], v[60:61] op_sel:[0,0] op_sel_hi:[0,1]
    v_pk_fma_f32 v[100:101], v[100:101], v[60:61], v[104:105] op_sel:[1,1,0] op_sel_hi:[1,0,1] neg_lo:[0,1,0]
    v_pk_mul_f32 v[106:107], v[102:103], v[62:63] op_sel:[0,0] op_sel_hi:[0,1]
    v_pk_fma_f32 v[102:103], v[102:103], v[62:63], v[106:107] op_sel:[1,1,0] op_sel_hi:[1,0,1] neg_lo:[0,1,0]
    v_cvt_pk_bf16_f32 v124, v100, v101
    v_cvt_pk_bf16_f32 v125, v102, v103
    v_pk_mul_f32 v[104:105], v[100:101], v[60:61] op_sel:[0,0] op_sel_hi:[0,1]
    v_pk_fma_f32 v[100:101], v[100:101], v[60:61], v[104:105] op_sel:[1,1,0] op_sel_hi:[1,0,1] neg_lo:[0,1,0]
    v_pk_mul_f32 v[106:107], v[102:103], v[62:63] op_sel:[0,0] op_sel_hi:[0,1]
    v_pk_fma_f32 v[102:103], v[102:103], v[62:63], v[106:107] op_sel:[1,1,0] op_sel_hi:[1,0,1] neg_lo:[0,1,0]
    v_cvt_pk_bf16_f32 v126, v100, v101
    v_cvt_pk_bf16_f32 v127, v102, v103
    s_waitcnt lgkmcnt(0)
    v_mfma_f32_16x16x32_bf16 v[208:211], v[144:147], v[148:151], 0
    ds_write_b64 v21, v[112:113] offset:1088
    v_mfma_f32_16x16x32_bf16 v[208:211], v[152:155], v[156:159], v[208:211]
    ds_write_b64 v21, v[114:115] offset:3264
    v_mfma_f32_16x16x32_bf16 v[208:211], v[160:163], v[164:167], v[208:211]
    ds_write_b64 v21, v[116:117] offset:5440
    v_mfma_f32_16x16x32_bf16 v[208:211], v[168:171], v[172:175], v[208:211]
    ds_write_b64 v21, v[118:119] offset:7616
    v_mfma_f32_16x16x32_bf16 v[208:211], v[176:179], v[180:183], v[208:211]
    ds_write_b64 v21, v[120:121] offset:1632
    v_mfma_f32_16x16x32_bf16 v[208:211], v[184:187], v[188:191], v[208:211]
    ds_write_b64 v21, v[122:123] offset:3808
    v_mfma_f32_16x16x32_bf16 v[208:211], v[192:195], v[196:199], v[208:211]
    ds_write_b64 v21, v[124:125] offset:5984
    v_mfma_f32_16x16x32_bf16 v[208:211], v[200:203], v[204:207], v[208:211]
    ds_write_b64 v21, v[126:127] offset:8160
    s_nop 6
    v_cvt_pk_bf16_f32 v2, v208, v209
    v_cvt_pk_bf16_f32 v3, v210, v211
    ds_write_b64 v26, v[2:3] offset:512
    s_cmp_lg_u32 s87, 0
    s_cbranch_scc1 L_nopub_13
    s_waitcnt vmcnt(0)
    s_lshl_b32 s44, s59, 4
    s_add_u32 s44, s44, 4096
    v_mov_b32_e64 v7, s37
    v_mul_u32_u24 v6, 4096, v1
    v_add_u32_e64 v6, s44, v6
    s_mov_b64 exec, 0xff
    global_store_dword v6, v7, s[32:33] sc1
    s_mov_b64 exec, -1
    s_mov_b32 s87, 1
L_nopub_13:
    v_pk_mul_f32 v[104:105], v[96:97], v[88:89] op_sel:[0,0] op_sel_hi:[0,1]
    v_pk_fma_f32 v[100:101], v[96:97], v[88:89], v[104:105] op_sel:[1,1,0] op_sel_hi:[1,0,1] neg_lo:[0,1,0]
    v_pk_mul_f32 v[106:107], v[98:99], v[90:91] op_sel:[0,0] op_sel_hi:[0,1]
    v_pk_fma_f32 v[102:103], v[98:99], v[90:91], v[106:107] op_sel:[1,1,0] op_sel_hi:[1,0,1] neg_lo:[0,1,0]
    v_cvt_pk_bf16_f32 v216, v100, -v101
    v_cvt_pk_bf16_f32 v217, v102, -v103
    v_pk_mul_f32 v[104:105], v[100:101], v[76:77] op_sel:[0,0] op_sel_hi:[0,1]
    v_pk_fma_f32 v[100:101], v[100:101], v[76:77], v[104:105] op_sel:[1,1,0] op_sel_hi:[1,0,1] neg_lo:[0,1,0]
    v_pk_mul_f32 v[106:107], v[102:103], v[78:79] op_sel:[0,0] op_sel_hi:[0,1]
    v_pk_fma_f32 v[102:103], v[102:103], v[78:79], v[106:107] op_sel:[1,1,0] op_sel_hi:[1,0,1] neg_lo:[0,1,0]
    v_cvt_pk_bf16_f32 v218, v100, -v101
    v_cvt_pk_bf16_f32 v219, v102, -v103
    v_pk_mul_f32 v[104:105], v[100:101], v[76:77] op_sel:[0,0] op_sel_hi:[0,1]
    v_pk_fma_f32 v[100:101], v[100:101], v[76:77], v[104:105] op_sel:[1,1,0] op_sel_hi:[1,0,1] neg_lo:[0,1,0]
    v_pk_mul_f32 v[106:107], v[102:103], v[78:79] op_sel:[0,0] op_sel_hi:[0,1]
    v_pk_fma_f32 v[102:103], v[102:103], v[78:79], v[106:107] op_sel:[1,1,0] op_sel_hi:[1,0,1] neg_lo:[0,1,0]
    v_cvt_pk_bf16_f32 v220, v100, -v101
    v_cvt_pk_bf16_f32 v221, v102, -v103
    v_pk_mul_f32 v[104:105], v[100:101], v[76:77] op_sel:[0,0] op_sel_hi:[0,1]
    v_pk_fma_f32 v[100:101], v[100:101], v[76:77], v[104:105] op_sel:[1,1,0] op_sel_hi:[1,0,1] neg_lo:[0,1,0]
    v_pk_mul_f32 v[106:107], v[102:103], v[78:79] op_sel:[0,0] op_sel_hi:[0,1]
    v_pk_fma_f32 v[102:103], v[102:103], v[78:79], v[106:107] op_sel:[1,1,0] op_sel_hi:[1,0,1] neg_lo:[0,1,0]
    v_cvt_pk_bf16_f32 v222, v100, -v101
    v_cvt_pk_bf16_f32 v223, v102, -v103
    ds_write_b64 v21, v[216:217] offset:8704
    ds_write_b64 v21, v[218:219] offset:9248
    ds_write_b64 v21, v[220:221] offset:9792
    ds_write_b64 v21, v[222:223] offset:10336
    v_pk_mul_f32 v[104:105], v[100:101], v[76:77] op_sel:[0,0] op_sel_hi:[0,1]
    v_pk_fma_f32 v[100:101], v[100:101], v[76:77], v[104:105] op_sel:[1,1,0] op_sel_hi:[1,0,1] neg_lo:[0,1,0]
    v_pk_mul_f32 v[106:107], v[102:103], v[78:79] op_sel:[0,0] op_sel_hi:[0,1]
    v_pk_fma_f32 v[102:103], v[102:103], v[78:79], v[106:107] op_sel:[1,1,0] op_sel_hi:[1,0,1] neg_lo:[0,1,0]
    v_cvt_pk_bf16_f32 v216, v100, -v101
    v_cvt_pk_bf16_f32 v217, v102, -v103
    v_pk_mul_f32 v[104:105], v[100:101], v[76:77] op_sel:[0,0] op_sel_hi:[0,1]
    v_pk_fma_f32 v[100:101], v[100:101], v[76:77], v[104:105] op_sel:[1,1,0] op_sel_hi:[1,0,1] neg_lo:[0,1,0]
    v_pk_mul_f32 v[106:107], v[102:103], v[78:79] op_sel:[0,0] op_sel_hi:[0,1]
    v_pk_fma_f32 v[102:103], v[102:103], v[78:79], v[106:107] op_sel:[1,1,0] op_sel_hi:[1,0,1] neg_lo:[0,1,0]
    v_cvt_pk_bf16_f32 v218, v100, -v101
    v_cvt_pk_bf16_f32 v219, v102, -v103
    v_pk_mul_f32 v[104:105], v[100:101], v[76:77] op_sel:[0,0] op_sel_hi:[0,1]
    v_pk_fma_f32 v[100:101], v[100:101], v[76:77], v[104:105] op_sel:[1,1,0] op_sel_hi:[1,0,1] neg_lo:[0,1,0]
    v_pk_mul_f32 v[106:107], v[102:103], v[78:79] op_sel:[0,0] op_sel_hi:[0,1]
    v_pk_fma_f32 v[102:103], v[102:103], v[78:79], v[106:107] op_sel:[1,1,0] op_sel_hi:[1,0,1] neg_lo:[0,1,0]
    v_cvt_pk_bf16_f32 v220, v100, -v101
    v_cvt_pk_bf16_f32 v221, v102, -v103
    v_pk_mul_f32 v[104:105], v[100:101], v[76:77] op_sel:[0,0] op_sel_hi:[0,1]
    v_pk_fma_f32 v[100:101], v[100:101], v[76:77], v[104:105] op_sel:[1,1,0] op_sel_hi:[1,0,1] neg_lo:[0,1,0]
    v_pk_mul_f32 v[106:107], v[102:103], v[78:79] op_sel:[0,0] op_sel_hi:[0,1]
    v_pk_fma_f32 v[102:103], v[102:103], v[78:79], v[106:107] op_sel:[1,1,0] op_sel_hi:[1,0,1] neg_lo:[0,1,0]
    v_cvt_pk_bf16_f32 v222, v100, -v101
    v_cvt_pk_bf16_f32 v223, v102, -v103
    ds_write_b64 v21, v[216:217] offset:10880
    ds_write_b64 v21, v[218:219] offset:11424
    ds_write_b64 v21, v[220:221] offset:11968
    ds_write_b64 v21, v[222:223] offset:12512
    s_waitcnt lgkmcnt(0)
    s_nop 0
    ds_read_b128 v[144:147], v24 offset:0
    ds_read_b128 v[148:151], v22 offset:8704
    ds_read_b128 v[152:155], v24 offset:64
    ds_read_b128 v[156:159], v22 offset:8768
    ds_read_b128 v[160:163], v24 offset:128
    ds_read_b128 v[164:167], v22 offset:8832
    ds_read_b128 v[168:171], v24 offset:192
    ds_read_b128 v[172:175], v22 offset:8896
    ds_read_b128 v[176:179], v24 offset:256
    ds_read_b128 v[180:183], v22 offset:8960
    ds_read_b128 v[184:187], v24 offset:320
    ds_read_b128 v[188:191], v22 offset:9024
    ds_read_b128 v[192:195], v24 offset:384
    ds_read_b128 v[196:199], v22 offset:9088
    ds_read_b128 v[200:203], v24 offset:448
    ds_read_b128 v[204:207], v22 offset:9152
    v_cvt_pk_bf16_f32 v112, v76, v77
    v_cvt_pk_bf16_f32 v113, v78, v79
    v_pk_mul_f32 v[104:105], v[76:77], v[64:65] op_sel:[0,0] op_sel_hi:[0,1]
    v_pk_fma_f32 v[100:101], v[76:77], v[64:65], v[104:105] op_sel:[1,1,0] op_sel_hi:[1,0,1] neg_lo:[0,1,0]
    v_pk_mul_f32 v[106:107], v[78:79], v[66:67] op_sel:[0,0] op_sel_hi:[0,1]
    v_pk_fma_f32 v[102:103], v[78:79], v[66:67], v[106:107] op_sel:[1,1,0] op_sel_hi:[1,0,1] neg_lo:[0,1,0]
    v_cvt_pk_bf16_f32 v114, v100, v101
    v_cvt_pk_bf16_f32 v115, v102, v103
    v_pk_mul_f32 v[104:105], v[100:101], v[64:65] op_sel:[0,0] op_sel_hi:[0,1]
    v_pk_fma_f32 v[100:101], v[100:101], v[64:65], v[104:105] op_sel:[1,1,0] op_sel_hi:[1,0,1] neg_lo:[0,1,0]
    v_pk_mul_f32 v[106:107], v[102:103], v[66:67] op_sel:[0,0] op_sel_hi:[0,1]
    v_pk_fma_f32 v[102:103], v[102:103], v[66:67], v[106:107] op_sel:[1,1,0] op_sel_hi:[1,0,1] neg_lo:[0,1,0]
    v_cvt_pk_bf16_f32 v116, v100, v101
    v_cvt_pk_bf16_f32 v117, v102, v103
    v_pk_mul_f32 v[104:105], v[100:101], v[64:65] op_sel:[0,0] op_sel_hi:[0,1]
    v_pk_fma_f32 v[100:101], v[100:101], v[64:65], v[104:105] op_sel:[1,1,0] op_sel_hi:[1,0,1] neg_lo:[0,1,0]
    v_pk_mul_f32 v[106:107], v[102:103], v[66:67] op_sel:[0,0] op_sel_hi:[0,1]
    v_pk_fma_f32 v[102:103], v[102:103], v[66:67], v[106:107] op_sel:[1,1,0] op_sel_hi:[1,0,1] neg_lo:[0,1,0]
    v_cvt_pk_bf16_f32 v118, v100, v101
    v_cvt_pk_bf16_f32 v119, v102, v103
    v_pk_mul_f32 v[104:105], v[100:101], v[64:65] op_sel:[0,0] op_sel_hi:[0,1]
    v_pk_fma_f32 v[100:101], v[100:101], v[64:65], v[104:105] op_sel:[1,1,0] op_sel_hi:[1,0,1] neg_lo:[0,1,0]
    v_pk_mul_f32 v[106:107], v[102:103], v[66:67] op_sel:[0,0] op_sel_hi:[0,1]
    v_pk_fma_f32 v[102:103], v[102:103], v[66:67], v[106:107] op_sel:[1,1,0] op_sel_hi:[1,0,1] neg_lo:[0,1,0]
    v_cvt_pk_bf16_f32 v120, v100, v101
    v_cvt_pk_bf16_f32 v121, v102, v103
    v_pk_mul_f32 v[104:105], v[100:101], v[64:65] op_sel:[0,0] op_sel_hi:[0,1]
    v_pk_fma_f32 v[100:101], v[100:101], v[64:65], v[104:105] op_sel:[1,1,0] op_sel_hi:[1,0,1] neg_lo:[0,1,0]
    v_pk_mul_f32 v[106:107], v[102:103], v[66:67] op_sel:[0,0] op_sel_hi:[0,1]
    v_pk_fma_f32 v[102:103], v[102:103], v[66:67], v[106:107] op_sel:[1,1,0] op_sel_hi:[1,0,1] neg_lo:[0,1,0]
    v_cvt_pk_bf16_f32 v122, v100, v101
    v_cvt_pk_bf16_f32 v123, v102, v103
    v_pk_mul_f32 v[104:105], v[100:101], v[64:65] op_sel:[0,0] op_sel_hi:[0,1]
    v_pk_fma_f32 v[100:101], v[100:101], v[64:65], v[104:105] op_sel:[1,1,0] op_sel_hi:[1,0,1] neg_lo:[0,1,0]
    v_pk_mul_f32 v[106:107], v[102:103], v[66:67] op_sel:[0,0] op_sel_hi:[0,1]
    v_pk_fma_f32 v[102:103], v[102:103], v[66:67], v[106:107] op_sel:[1,1,0] op_sel_hi:[1,0,1] neg_lo:[0,1,0]
    v_cvt_pk_bf16_f32 v124, v100, v101
    v_cvt_pk_bf16_f32 v125, v102, v103
    v_pk_mul_f32 v[104:105], v[100:101], v[64:65] op_sel:[0,0] op_sel_hi:[0,1]
    v_pk_fma_f32 v[100:101], v[100:101], v[64:65], v[104:105] op_sel:[1,1,0] op_sel_hi:[1,0,1] neg_lo:[0,1,0]
    v_pk_mul_f32 v[106:107], v[102:103], v[66:67] op_sel:[0,0] op_sel_hi:[0,1]
    v_pk_fma_f32 v[102:103], v[102:103], v[66:67], v[106:107] op_sel:[1,1,0] op_sel_hi:[1,0,1] neg_lo:[0,1,0]
    v_cvt_pk_bf16_f32 v126, v100, v101
    v_cvt_pk_bf16_f32 v127, v102, v103
    s_waitcnt lgkmcnt(0)
    v_mfma_f32_16x16x32_bf16 v[208:211], v[144:147], v[148:151], 0
    ds_write_b64 v21, v[112:113] offset:2176
    v_mfma_f32_16x16x32_bf16 v[208:211], v[152:155], v[156:159], v[208:211]
    ds_write_b64 v21, v[114:115] offset:6528
    v_mfma_f32_16x16x32_bf16 v[208:211], v[160:163], v[164:167], v[208:211]
    ds_write_b64 v21, v[116:117] offset:2720
    v_mfma_f32_16x16x32_bf16 v[208:211], v[168:171], v[172:175], v[208:211]
    ds_write_b64 v21, v[118:119] offset:7072
    v_mfma_f32_16x16x32_bf16 v[208:211], v[176:179], v[180:183], v[208:211]
    ds_write_b64 v21, v[120:121] offset:3264
    v_mfma_f32_16x16x32_bf16 v[208:211], v[184:187], v[188:191], v[208:211]
    ds_write_b64 v21, v[122:123] offset:7616
    v_mfma_f32_16x16x32_bf16 v[208:211], v[192:195], v[196:199], v[208:211]
    ds_write_b64 v21, v[124:125] offset:3808
    v_mfma_f32_16x16x32_bf16 v[208:211], v[200:203], v[204:207], v[208:211]
    ds_write_b64 v21, v[126:127] offset:8160
    s_nop 6
    v_cvt_pk_bf16_f32 v2, v208, v208
    v_cvt_pk_bf16_f32 v3, v209, v209
    v_cvt_pk_bf16_f32 v4, v210, v210
    v_cvt_pk_bf16_f32 v5, v211, v211
    ds_write_b128 v27, v[2:5] offset:768
    global_load_ushort v9, v9, s[16:17]
    global_load_dwordx4 v[232:235], v28, s[32:33] offset:0 sc1
    global_load_dwordx4 v[236:239], v28, s[32:33] offset:1024 sc1
    global_load_dwordx4 v[240:243], v29, s[32:33] offset:0 sc1
    global_load_dwordx4 v[244:247], v29, s[32:33] offset:1024 sc1
    global_load_dword v252, v31, s[32:33] sc1
    v_pk_mul_f32 v[104:105], v[96:97], v[92:93] op_sel:[0,0] op_sel_hi:[0,1]
    v_pk_fma_f32 v[100:101], v[96:97], v[92:93], v[104:105] op_sel:[1,1,0] op_sel_hi:[1,0,1] neg_lo:[0,1,0]
    v_pk_mul_f32 v[106:107], v[98:99], v[94:95] op_sel:[0,0] op_sel_hi:[0,1]
    v_pk_fma_f32 v[102:103], v[98:99], v[94:95], v[106:107] op_sel:[1,1,0] op_sel_hi:[1,0,1] neg_lo:[0,1,0]
    v_cvt_pk_bf16_f32 v216, v100, -v101
    v_cvt_pk_bf16_f32 v217, v102, -v103
    v_pk_mul_f32 v[104:105], v[100:101], v[80:81] op_sel:[0,0] op_sel_hi:[0,1]
    v_pk_fma_f32 v[100:101], v[100:101], v[80:81], v[104:105] op_sel:[1,1,0] op_sel_hi:[1,0,1] neg_lo:[0,1,0]
    v_pk_mul_f32 v[106:107], v[102:103], v[82:83] op_sel:[0,0] op_sel_hi:[0,1]
    v_pk_fma_f32 v[102:103], v[102:103], v[82:83], v[106:107] op_sel:[1,1,0] op_sel_hi:[1,0,1] neg_lo:[0,1,0]
    v_cvt_pk_bf16_f32 v218, v100, -v101
    v_cvt_pk_bf16_f32 v219, v102, -v103
    v_pk_mul_f32 v[104:105], v[100:101], v[80:81] op_sel:[0,0] op_sel_hi:[0,1]
    v_pk_fma_f32 v[100:101], v[100:101], v[80:81], v[104:105] op_sel:[1,1,0] op_sel_hi:[1,0,1] neg_lo:[0,1,0]
    v_pk_mul_f32 v[106:107], v[102:103], v[82:83] op_sel:[0,0] op_sel_hi:[0,1]
    v_pk_fma_f32 v[102:103], v[102:103], v[82:83], v[106:107] op_sel:[1,1,0] op_sel_hi:[1,0,1] neg_lo:[0,1,0]
    v_cvt_pk_bf16_f32 v220, v100, -v101
    v_cvt_pk_bf16_f32 v221, v102, -v103
    v_pk_mul_f32 v[104:105], v[100:101], v[80:81] op_sel:[0,0] op_sel_hi:[0,1]
    v_pk_fma_f32 v[100:101], v[100:101], v[80:81], v[104:105] op_sel:[1,1,0] op_sel_hi:[1,0,1] neg_lo:[0,1,0]
    v_pk_mul_f32 v[106:107], v[102:103], v[82:83] op_sel:[0,0] op_sel_hi:[0,1]
    v_pk_fma_f32 v[102:103], v[102:103], v[82:83], v[106:107] op_sel:[1,1,0] op_sel_hi:[1,0,1] neg_lo:[0,1,0]
    v_cvt_pk_bf16_f32 v222, v100, -v101
    v_cvt_pk_bf16_f32 v223, v102, -v103
    ds_write_b64 v21, v[216:217] offset:8704
    ds_write_b64 v21, v[218:219] offset:9248
    ds_write_b64 v21, v[220:221] offset:9792
    ds_write_b64 v21, v[222:223] offset:10336
    v_pk_mul_f32 v[104:105], v[100:101], v[80:81] op_sel:[0,0] op_sel_hi:[0,1]
    v_pk_fma_f32 v[100:101], v[100:101], v[80:81], v[104:105] op_sel:[1,1,0] op_sel_hi:[1,0,1] neg_lo:[0,1,0]
    v_pk_mul_f32 v[106:107], v[102:103], v[82:83] op_sel:[0,0] op_sel_hi:[0,1]
    v_pk_fma_f32 v[102:103], v[102:103], v[82:83], v[106:107] op_sel:[1,1,0] op_sel_hi:[1,0,1] neg_lo:[0,1,0]
    v_cvt_pk_bf16_f32 v216, v100, -v101
    v_cvt_pk_bf16_f32 v217, v102, -v103
    v_pk_mul_f32 v[104:105], v[100:101], v[80:81] op_sel:[0,0] op_sel_hi:[0,1]
    v_pk_fma_f32 v[100:101], v[100:101], v[80:81], v[104:105] op_sel:[1,1,0] op_sel_hi:[1,0,1] neg_lo:[0,1,0]
    v_pk_mul_f32 v[106:107], v[102:103], v[82:83] op_sel:[0,0] op_sel_hi:[0,1]
    v_pk_fma_f32 v[102:103], v[102:103], v[82:83], v[106:107] op_sel:[1,1,0] op_sel_hi:[1,0,1] neg_lo:[0,1,0]
    v_cvt_pk_bf16_f32 v218, v100, -v101
    v_cvt_pk_bf16_f32 v219, v102, -v103
    v_pk_mul_f32 v[104:105], v[100:101], v[80:81] op_sel:[0,0] op_sel_hi:[0,1]
    v_pk_fma_f32 v[100:101], v[100:101], v[80:81], v[104:105] op_sel:[1,1,0] op_sel_hi:[1,0,1] neg_lo:[0,1,0]
    v_pk_mul_f32 v[106:107], v[102:103], v[82:83] op_sel:[0,0] op_sel_hi:[0,1]
    v_pk_fma_f32 v[102:103], v[102:103], v[82:83], v[106:107] op_sel:[1,1,0] op_sel_hi:[1,0,1] neg_lo:[0,1,0]
    v_cvt_pk_bf16_f32 v220, v100, -v101
    v_cvt_pk_bf16_f32 v221, v102, -v103
    v_pk_mul_f32 v[104:105], v[100:101], v[80:81] op_sel:[0,0] op_sel_hi:[0,1]
    v_pk_fma_f32 v[100:101], v[100:101], v[80:81], v[104:105] op_sel:[1,1,0] op_sel_hi:[1,0,1] neg_lo:[0,1,0]
    v_pk_mul_f32 v[106:107], v[102:103], v[82:83] op_sel:[0,0] op_sel_hi:[0,1]
    v_pk_fma_f32 v[102:103], v[102:103], v[82:83], v[106:107] op_sel:[1,1,0] op_sel_hi:[1,0,1] neg_lo:[0,1,0]
    v_cvt_pk_bf16_f32 v222, v100, -v101
    v_cvt_pk_bf16_f32 v223, v102, -v103
    ds_write_b64 v21, v[216:217] offset:10880
    ds_write_b64 v21, v[218:219] offset:11424
    ds_write_b64 v21, v[220:221] offset:11968
    ds_write_b64 v21, v[222:223] offset:12512
    v_pk_mul_f32 v[104:105], v[100:101], v[80:81] op_sel:[0,0] op_sel_hi:[0,1]
    v_pk_fma_f32 v[100:101], v[100:101], v[80:81], v[104:105] op_sel:[1,1,0] op_sel_hi:[1,0,1] neg_lo:[0,1,0]
    v_pk_mul_f32 v[106:107], v[102:103], v[82:83] op_sel:[0,0] op_sel_hi:[0,1]
    v_pk_fma_f32 v[102:103], v[102:103], v[82:83], v[106:107] op_sel:[1,1,0] op_sel_hi:[1,0,1] neg_lo:[0,1,0]
    v_cvt_pk_bf16_f32 v216, v100, -v101
    v_cvt_pk_bf16_f32 v217, v102, -v103
    ds_write_b64 v21, v[216:217] offset:13056
    s_waitcnt lgkmcnt(0)
    ds_read_b128 v[144:147], v25 offset:0
    ds_read_b128 v[148:151], v22 offset:8704
    ds_read_b128 v[152:155], v25 offset:64
    ds_read_b128 v[156:159], v22 offset:8768
    ds_read_b128 v[160:163], v25 offset:128
    ds_read_b128 v[164:167], v22 offset:8832
    ds_read_b128 v[168:171], v25 offset:192
    ds_read_b128 v[172:175], v22 offset:8896
    ds_read_b128 v[176:179], v25 offset:256
    ds_read_b128 v[180:183], v22 offset:8960
    ds_read_b128 v[184:187], v25 offset:320
    ds_read_b128 v[188:191], v22 offset:9024
    ds_read_b128 v[192:195], v25 offset:384
    ds_read_b128 v[196:199], v22 offset:9088
    ds_read_b128 v[200:203], v25 offset:448
    ds_read_b128 v[204:207], v22 offset:9152
    s_mov_b32 m0, s61
    s_waitcnt vmcnt(0)
    v_xor_b32 v6, s37, v233
    v_bitop3_b32 v6, v6, v235, s37 bitop3:0xf6
    v_bitop3_b32 v6, v6, v237, s37 bitop3:0xf6
    v_bitop3_b32 v6, v6, v239, s37 bitop3:0xf6
    v_bitop3_b32 v6, v6, v241, s37 bitop3:0xf6
    v_bitop3_b32 v6, v6, v243, s37 bitop3:0xf6
    v_bitop3_b32 v6, v6, v245, s37 bitop3:0xf6
    v_bitop3_b32 v6, v6, v247, s37 bitop3:0xf6
    v_bitop3_b32 v6, v6, v252, s37 bitop3:0xf6
    v_cmp_ne_u32 vcc, 0, v6
    s_nop 1
    s_cbranch_vccnz L_hin_retry_14
L_hin_back_15:
    global_load_lds_dwordx4 v32, s[32:33] offset:0 sc1
    global_load_lds_dwordx4 v33, s[32:33] offset:1024 sc1
    global_load_lds_dwordx4 v34, s[32:33] offset:2048 sc1
    global_load_lds_dwordx4 v35, s[32:33] offset:3072 sc1
    global_load_dwordx2 v[248:249], v30, s[32:33] sc1
    v_and_b32 v52, 0xffff0000, v232
    v_lshlrev_b32 v232, 16, v232
    v_rcp_f32_e64 v52, v52
    v_and_b32 v53, 0xffff0000, v234
    v_lshlrev_b32 v234, 16, v234
    v_rcp_f32 v53, v53
    v_mul_f32 v54, -v232, v52
    v_mul_f32 v55, -v234, v53
    v_and_b32 v56, 0xffff0000, v236
    v_lshlrev_b32 v236, 16, v236
    v_rcp_f32 v56, v56
    v_and_b32 v57, 0xffff0000, v238
    v_lshlrev_b32 v238, 16, v238
    v_rcp_f32 v57, v57
    v_mul_f32 v58, -v236, v56
    v_mul_f32 v59, -v238, v57
    v_and_b32 v60, 0xffff0000, v240
    v_lshlrev_b32 v240, 16, v240
    v_rcp_f32 v60, v60
    v_and_b32 v61, 0xffff0000, v242
    v_lshlrev_b32 v242, 16, v242
    v_rcp_f32 v61, v61
    v_mul_f32 v62, -v240, v60
    v_mul_f32 v63, -v242, v61
    v_and_b32 v68, 0xffff0000, v244
    v_lshlrev_b32 v244, 16, v244
    v_rcp_f32 v68, v68
    v_and_b32 v69, 0xffff0000, v246
    v_lshlrev_b32 v246, 16, v246
    v_rcp_f32 v69, v69
    v_mul_f32 v70, -v244, v68
    v_mul_f32 v71, -v246, v69
    v_accvgpr_read_b32 v8, a253
    s_waitcnt lgkmcnt(0)
    v_mfma_f32_16x16x32_bf16 v[208:211], v[144:147], v[148:151], 0
    v_mfma_f32_16x16x32_bf16 v[208:211], v[152:155], v[156:159], v[208:211]
    v_mfma_f32_16x16x32_bf16 v[208:211], v[160:163], v[164:167], v[208:211]
    v_mfma_f32_16x16x32_bf16 v[208:211], v[168:171], v[172:175], v[208:211]
    v_mfma_f32_16x16x32_bf16 v[208:211], v[176:179], v[180:183], v[208:211]
    v_mfma_f32_16x16x32_bf16 v[208:211], v[184:187], v[188:191], v[208:211]
    v_mfma_f32_16x16x32_bf16 v[208:211], v[192:195], v[196:199], v[208:211]
    v_mfma_f32_16x16x32_bf16 v[208:211], v[200:203], v[204:207], v[208:211]
    s_nop 7
    v_cvt_pk_bf16_f32 v2, v208, v208
    v_cvt_pk_bf16_f32 v3, v209, v209
    v_cvt_pk_bf16_f32 v4, v210, v210
    v_cvt_pk_bf16_f32 v5, v211, v211
    ds_write_b128 v27, v[2:5] offset:1280
    ds_read_u16 v112, v10
    ds_read_u16 v113, v11
    ds_read_u16 v114, v12
    ds_read_u16 v115, v13
    ds_read_u16 v116, v14
    ds_read_u16 v117, v15
    ds_read_u16 v118, v16
    ds_read_u16 v119, v17
    ds_read_u16 v120, v18
    ds_read2_b32 v[122:123], v19 offset0:0 offset1:1
    ds_read_b32 v124, v19 offset:8
    ds_read2_b32 v[126:127], v20 offset0:0 offset1:1
    ds_read2_b32 v[128:129], v20 offset0:64 offset1:65
    v_and_b32_e64 v2, 1, v1
    v_cmp_eq_u32 vcc, 0, v2
    s_waitcnt lgkmcnt(4)
    v_lshl_or_b32 v160, v113, 16, v112
    v_lshl_or_b32 v161, v115, 16, v114
    v_lshl_or_b32 v162, v117, 16, v116
    v_lshl_or_b32 v163, v119, 16, v118
    v_lshl_or_b32 v164, v114, 16, v113
    v_lshl_or_b32 v165, v116, 16, v115
    v_lshl_or_b32 v166, v118, 16, v117
    v_lshl_or_b32 v167, v120, 16, v119
    ds_write_b128 v8, v[160:163] offset:3072
    ds_write_b128 v8, v[164:167] offset:7232
    s_waitcnt lgkmcnt(4)
    v_mov_b32 v168, v124
    v_mov_b32_e64 v169, v123
    v_bfi_b32 v170, s57, v122, v123
    v_mov_b32_e64 v171, v122
    v_bfi_b32 v172, s57, v123, v124
    v_mov_b32 v173, v123
    v_mov_b32 v174, v122
    v_mov_b32_e64 v175, v122
    ds_write_b128 v8, v[168:171] offset:2048
    ds_write_b128 v8, v[172:175] offset:6208
    s_waitcnt lgkmcnt(5)
    v_bfi_b32 v2, s57, v126, v127
    v_mov_b32 v152, v127
    v_mov_b32 v154, v126
    v_mov_b32 v155, v126
    v_mov_b32 v156, v127
    v_mov_b32 v158, v126
    v_mov_b32_e64 v159, v126
    v_cndmask_b32 v153, v2, v127, vcc
    v_cndmask_b32 v157, v126, v2, vcc
    ds_write_b128 v8, v[152:155] offset:1024
    ds_write_b128 v8, v[156:159] offset:5184
    s_waitcnt lgkmcnt(6)
    v_bfi_b32 v2, s57, v128, v129
    v_mov_b32 v144, v129
    v_mov_b32 v146, v128
    v_mov_b32 v147, v128
    v_mov_b32 v148, v129
    v_mov_b32 v150, v128
    v_mov_b32_e64 v151, v128
    v_cndmask_b32 v145, v2, v129, vcc
    v_cndmask_b32 v149, v128, v2, vcc
    ds_write_b128 v8, v[144:147] offset:0
    ds_write_b128 v8, v[148:151] offset:4160
    s_waitcnt vmcnt(1)
    ds_read2st64_b32 v[112:113], v36 offset0:0 offset1:4
    ds_read2st64_b32 v[114:115], v37 offset0:0 offset1:4
    ds_read2st64_b32 v[116:117], v38 offset0:0 offset1:4
    ds_read2st64_b32 v[118:119], v39 offset0:0 offset1:4
    ds_read2st64_b32 v[120:121], v36 offset0:8 offset1:12
    ds_read2st64_b32 v[122:123], v37 offset0:8 offset1:12
    ds_read2st64_b32 v[124:125], v38 offset0:8 offset1:12
    ds_read2st64_b32 v[126:127], v39 offset0:8 offset1:12
    s_waitcnt vmcnt(0)
    v_cmp_ne_u32 vcc, s37, v249
    s_nop 1
    s_cbranch_vccnz L_fmc_retry_16
L_fmc_back_17:
    v_add_f32_dpp v248, v248, v248 quad_perm:[1,0,3,2] row_mask:0xf bank_mask:0xf
    s_nop 1
    v_add_f32_dpp v248, v248, v248 quad_perm:[2,3,0,1] row_mask:0xf bank_mask:0xf
    v_cvt_pk_bf16_f32 v248, v248, v248
    v_lshlrev_b32 v248, 16, v248
    v_add_f32 v6, 1.0, v248
    v_cvt_pk_bf16_f32 v6, v6, v6
    v_lshlrev_b32 v6, 16, v6
    v_lshlrev_b32 v9, 16, v9
    v_mul_f32_e64 v9, v9, v248
    v_readlane_b32 s64, v6, 16
    v_readlane_b32 s65, v248, 0
    v_readlane_b32 s72, v248, 32
    v_readlane_b32 s73, v9, 32
    v_readlane_b32 s66, v6, 20
    v_readlane_b32 s67, v248, 4
    v_readlane_b32 s74, v248, 36
    v_readlane_b32 s75, v9, 36
    v_readlane_b32 s68, v6, 24
    v_readlane_b32 s69, v248, 8
    v_readlane_b32 s76, v248, 40
    v_readlane_b32 s77, v9, 40
    v_readlane_b32 s70, v6, 28
    v_readlane_b32 s71, v248, 12
    v_readlane_b32 s78, v248, 44
    v_readlane_b32 s79, v9, 44
    s_waitcnt lgkmcnt(4)
    v_lshlrev_b32 v196, 16, v112
    v_and_b32 v197, 0xffff0000, v112
    v_pk_fma_f32 v[76:77], v[196:197], v[52:53], v[54:55]
    v_pk_fma_f32 v[76:77], v[76:77], s[64:65], s[64:65] op_sel:[0,0,1] op_sel_hi:[1,0,1]
    v_cvt_pk_bf16_f32 v112, v76, v77
    v_lshlrev_b32_e64 v204, 16, v113
    v_and_b32 v205, 0xffff0000, v113
    v_pk_fma_f32 v[78:79], v[204:205], v[56:57], v[58:59]
    v_pk_fma_f32 v[78:79], v[78:79], s[64:65], s[64:65] op_sel:[0,0,1] op_sel_hi:[1,0,1]
    v_cvt_pk_bf16_f32 v113, v78, v79
    v_lshlrev_b32_e64 v198, 16, v114
    v_and_b32 v199, 0xffff0000, v114
    v_pk_fma_f32 v[80:81], v[198:199], v[52:53], v[54:55]
    v_pk_fma_f32 v[80:81], v[80:81], s[66:67], s[66:67] op_sel:[0,0,1] op_sel_hi:[1,0,1]
    v_cvt_pk_bf16_f32 v114, v80, v81
    v_lshlrev_b32_e64 v206, 16, v115
    v_and_b32 v207, 0xffff0000, v115
    v_pk_fma_f32 v[82:83], v[206:207], v[56:57], v[58:59]
    v_pk_fma_f32 v[82:83], v[82:83], s[66:67], s[66:67] op_sel:[0,0,1] op_sel_hi:[1,0,1]
    v_cvt_pk_bf16_f32 v115, v82, v83
    v_lshlrev_b32_e64 v200, 16, v116
    v_and_b32 v201, 0xffff0000, v116
    v_pk_fma_f32 v[84:85], v[200:201], v[52:53], v[54:55]
    v_pk_fma_f32 v[84:85], v[84:85], s[68:69], s[68:69] op_sel:[0,0,1] op_sel_hi:[1,0,1]
    v_cvt_pk_bf16_f32 v116, v84, v85
    v_lshlrev_b32_e64 v208, 16, v117
    v_and_b32 v209, 0xffff0000, v117
    v_pk_fma_f32 v[86:87], v[208:209], v[56:57], v[58:59]
    v_pk_fma_f32 v[86:87], v[86:87], s[68:69], s[68:69] op_sel:[0,0,1] op_sel_hi:[1,0,1]
    v_cvt_pk_bf16_f32 v117, v86, v87
    v_lshlrev_b32_e64 v202, 16, v118
    v_and_b32 v203, 0xffff0000, v118
    v_pk_fma_f32 v[88:89], v[202:203], v[52:53], v[54:55]
    v_pk_fma_f32 v[88:89], v[88:89], s[70:71], s[70:71] op_sel:[0,0,1] op_sel_hi:[1,0,1]
    v_cvt_pk_bf16_f32 v118, v88, v89
    v_lshlrev_b32_e64 v210, 16, v119
    v_and_b32 v211, 0xffff0000, v119
    v_pk_fma_f32 v[90:91], v[210:211], v[56:57], v[58:59]
    v_pk_fma_f32 v[90:91], v[90:91], s[70:71], s[70:71] op_sel:[0,0,1] op_sel_hi:[1,0,1]
    v_cvt_pk_bf16_f32 v119, v90, v91
    ds_write2st64_b32 v40, v112, v113 offset0:0 offset1:1
    ds_write2st64_b32 v40, v114, v115 offset0:18 offset1:19
    ds_write2st64_b32 v40, v116, v117 offset0:36 offset1:37
    ds_write2st64_b32 v40, v118, v119 offset0:54 offset1:55
    s_waitcnt lgkmcnt(4)
    v_lshlrev_b32 v212, 16, v120
    v_and_b32 v213, 0xffff0000, v120
    v_pk_fma_f32 v[92:93], v[212:213], v[60:61], v[62:63]
    v_pk_fma_f32 v[92:93], v[92:93], s[64:65], s[64:65] op_sel:[0,0,1] op_sel_hi:[1,0,1]
    v_cvt_pk_bf16_f32 v120, v92, v93
    v_lshlrev_b32_e64 v220, 16, v121
    v_and_b32 v221, 0xffff0000, v121
    v_pk_fma_f32 v[94:95], v[220:221], v[68:69], v[70:71]
    v_pk_fma_f32 v[94:95], v[94:95], s[64:65], s[64:65] op_sel:[0,0,1] op_sel_hi:[1,0,1]
    v_cvt_pk_bf16_f32 v121, v94, v95
    v_lshlrev_b32_e64 v214, 16, v122
    v_and_b32 v215, 0xffff0000, v122
    v_pk_fma_f32 v[96:97], v[214:215], v[60:61], v[62:63]
    v_pk_fma_f32 v[96:97], v[96:97], s[66:67], s[66:67] op_sel:[0,0,1] op_sel_hi:[1,0,1]
    v_cvt_pk_bf16_f32 v122, v96, v97
    v_lshlrev_b32_e64 v222, 16, v123
    v_and_b32 v223, 0xffff0000, v123
    v_pk_fma_f32 v[98:99], v[222:223], v[68:69], v[70:71]
    v_pk_fma_f32 v[98:99], v[98:99], s[66:67], s[66:67] op_sel:[0,0,1] op_sel_hi:[1,0,1]
    v_cvt_pk_bf16_f32 v123, v98, v99
    v_lshlrev_b32_e64 v216, 16, v124
    v_and_b32 v217, 0xffff0000, v124
    v_pk_fma_f32 v[100:101], v[216:217], v[60:61], v[62:63]
    v_pk_fma_f32 v[100:101], v[100:101], s[68:69], s[68:69] op_sel:[0,0,1] op_sel_hi:[1,0,1]
    v_cvt_pk_bf16_f32 v124, v100, v101
    v_lshlrev_b32_e64 v224, 16, v125
    v_and_b32 v225, 0xffff0000, v125
    v_pk_fma_f32 v[102:103], v[224:225], v[68:69], v[70:71]
    v_pk_fma_f32 v[102:103], v[102:103], s[68:69], s[68:69] op_sel:[0,0,1] op_sel_hi:[1,0,1]
    v_cvt_pk_bf16_f32 v125, v102, v103
    v_lshlrev_b32_e64 v218, 16, v126
    v_and_b32 v219, 0xffff0000, v126
    v_pk_fma_f32 v[104:105], v[218:219], v[60:61], v[62:63]
    v_pk_fma_f32 v[104:105], v[104:105], s[70:71], s[70:71] op_sel:[0,0,1] op_sel_hi:[1,0,1]
    v_cvt_pk_bf16_f32 v126, v104, v105
    v_lshlrev_b32_e64 v226, 16, v127
    v_and_b32 v227, 0xffff0000, v127
    v_pk_fma_f32 v[106:107], v[226:227], v[68:69], v[70:71]
    v_pk_fma_f32 v[106:107], v[106:107], s[70:71], s[70:71] op_sel:[0,0,1] op_sel_hi:[1,0,1]
    v_cvt_pk_bf16_f32 v127, v106, v107
    ds_write2st64_b32 v40, v120, v121 offset0:8 offset1:9
    ds_write2st64_b32 v40, v122, v123 offset0:26 offset1:27
    ds_write2st64_b32 v40, v124, v125 offset0:44 offset1:45
    ds_write2st64_b32 v40, v126, v127 offset0:62 offset1:63
    v_pk_fma_f32 v[196:197], v[76:77], s[72:73], v[196:197] op_sel:[0,1,0] op_sel_hi:[1,1,1]
    v_pk_fma_f32 v[204:205], v[78:79], s[72:73], v[204:205] op_sel:[0,1,0] op_sel_hi:[1,1,1]
    v_pk_fma_f32 v[198:199], v[80:81], s[74:75], v[198:199] op_sel:[0,1,0] op_sel_hi:[1,1,1]
    v_pk_fma_f32 v[206:207], v[82:83], s[74:75], v[206:207] op_sel:[0,1,0] op_sel_hi:[1,1,1]
    v_pk_fma_f32 v[200:201], v[84:85], s[76:77], v[200:201] op_sel:[0,1,0] op_sel_hi:[1,1,1]
    v_pk_fma_f32 v[208:209], v[86:87], s[76:77], v[208:209] op_sel:[0,1,0] op_sel_hi:[1,1,1]
    v_pk_fma_f32 v[202:203], v[88:89], s[78:79], v[202:203] op_sel:[0,1,0] op_sel_hi:[1,1,1]
    v_pk_fma_f32 v[210:211], v[90:91], s[78:79], v[210:211] op_sel:[0,1,0] op_sel_hi:[1,1,1]
    v_pk_fma_f32 v[212:213], v[92:93], s[72:73], v[212:213] op_sel:[0,1,0] op_sel_hi:[1,1,1]
    v_pk_fma_f32 v[220:221], v[94:95], s[72:73], v[220:221] op_sel:[0,1,0] op_sel_hi:[1,1,1]
    v_pk_fma_f32 v[214:215], v[96:97], s[74:75], v[214:215] op_sel:[0,1,0] op_sel_hi:[1,1,1]
    v_pk_fma_f32 v[222:223], v[98:99], s[74:75], v[222:223] op_sel:[0,1,0] op_sel_hi:[1,1,1]
    v_pk_fma_f32 v[216:217], v[100:101], s[76:77], v[216:217] op_sel:[0,1,0] op_sel_hi:[1,1,1]
    v_pk_fma_f32 v[224:225], v[102:103], s[76:77], v[224:225] op_sel:[0,1,0] op_sel_hi:[1,1,1]
    v_pk_fma_f32 v[218:219], v[104:105], s[78:79], v[218:219] op_sel:[0,1,0] op_sel_hi:[1,1,1]
    v_pk_fma_f32 v[226:227], v[106:107], s[78:79], v[226:227] op_sel:[0,1,0] op_sel_hi:[1,1,1]
    v_accvgpr_read_b32 v2, a255
    v_accvgpr_read_b32 v6, a254
    v_subrev_u32 v3, 1024, v2
    v_subrev_u32 v4, 2048, v2
    v_subrev_u32 v5, 3072, v2
    s_waitcnt lgkmcnt(0)
    s_barrier
    ds_read2_b32 v[48:49], v2 offset0:240 offset1:241
    ds_read2_b32 v[50:51], v2 offset0:242 offset1:243
    ds_read_b128 v[80:83], v6 offset:480
    ds_read_b128 v[84:87], v6 offset:992
    ds_read2_b32 v[52:53], v2 offset0:112 offset1:113
    ds_read2_b32 v[54:55], v2 offset0:114 offset1:115
    ds_read_b128 v[88:91], v6 offset:1504
    ds_read2_b32 v[56:57], v3 offset0:240 offset1:241
    ds_read2_b32 v[58:59], v3 offset0:242 offset1:243
    ds_read_b128 v[92:95], v6 offset:2016
    ds_read2_b32 v[60:61], v3 offset0:112 offset1:113
    ds_read2_b32 v[62:63], v3 offset0:114 offset1:115
    s_waitcnt lgkmcnt(9)
    v_mfma_f32_16x16x32_bf16 v[176:179], v[48:51], v[80:83], 0
    ds_read2_b32 v[112:113], v2 offset0:224 offset1:225
    ds_read2_b32 v[114:115], v2 offset0:226 offset1:227
    s_waitcnt lgkmcnt(10)
    v_mfma_f32_16x16x32_bf16 v[180:183], v[48:51], v[84:87], 0
    ds_read_b128 v[144:147], v6 offset:416
    s_lshl_b32 s45, s35, 8
    s_waitcnt lgkmcnt(9)
    v_mfma_f32_16x16x32_bf16 v[180:183], v[52:55], v[80:83], v[180:183]
    ds_read_b128 v[148:151], v6 offset:928
    s_lshl_b32 s44, s34, 2
    s_waitcnt lgkmcnt(9)
    v_mfma_f32_16x16x32_bf16 v[184:187], v[48:51], v[88:91], 0
    ds_read2_b32 v[116:117], v2 offset0:96 offset1:97
    s_add_u32 s45, s45, s44
    v_mfma_f32_16x16x32_bf16 v[184:187], v[52:55], v[84:87], v[184:187]
    ds_read2_b32 v[118:119], v2 offset0:98 offset1:99
    s_add_u32 s45, s45, 131072
    s_waitcnt lgkmcnt(9)
    v_mfma_f32_16x16x32_bf16 v[184:187], v[56:59], v[80:83], v[184:187]
    ds_read_b128 v[152:155], v6 offset:1440
    ds_read2_b32 v[120:121], v3 offset0:224 offset1:225
    v_min_u32 v38, 8, v1
    s_waitcnt lgkmcnt(10)
    v_mfma_f32_16x16x32_bf16 v[188:191], v[48:51], v[92:95], 0
    ds_read2_b32 v[122:123], v3 offset0:226 offset1:227
    v_lshl_add_u32 v38, v38, 4, s45
    v_mfma_f32_16x16x32_bf16 v[188:191], v[52:55], v[88:91], v[188:191]
    ds_read_b128 v[156:159], v6 offset:1952
    v_min_u32_e64 v40, 13, v1
    v_mfma_f32_16x16x32_bf16 v[188:191], v[56:59], v[84:87], v[188:191]
    ds_read2_b32 v[124:125], v3 offset0:96 offset1:97
    v_lshl_add_u32 v40, v40, 4, s45
    s_waitcnt lgkmcnt(11)
    v_mfma_f32_16x16x32_bf16 v[188:191], v[60:63], v[80:83], v[188:191]
    ds_read2_b32 v[126:127], v3 offset0:98 offset1:99
    global_load_dword v41, v38, s[32:33] sc1
    s_waitcnt lgkmcnt(9)
    v_mfma_f32_16x16x32_bf16 v[176:179], v[112:115], v[144:147], v[176:179]
    ds_read2_b32 v[48:49], v2 offset0:208 offset1:209
    ds_read2_b32 v[50:51], v2 offset0:210 offset1:211
    s_waitcnt lgkmcnt(10)
    v_mfma_f32_16x16x32_bf16 v[180:183], v[112:115], v[148:151], v[180:183]
    ds_read_b128 v[80:83], v6 offset:352
    s_mul_i32 s44, s41, 286848
    s_waitcnt lgkmcnt(9)
    v_mfma_f32_16x16x32_bf16 v[180:183], v[116:119], v[144:147], v[180:183]
    ds_read_b128 v[84:87], v6 offset:864
    s_mul_i32 s45, s34, 71680
    s_waitcnt lgkmcnt(9)
    v_mfma_f32_16x16x32_bf16 v[184:187], v[112:115], v[152:155], v[184:187]
    ds_read2_b32 v[52:53], v2 offset0:80 offset1:81
    s_add_u32 s44, s44, s45
    v_mfma_f32_16x16x32_bf16 v[184:187], v[116:119], v[148:151], v[184:187]
    ds_read2_b32 v[54:55], v2 offset0:82 offset1:83
    s_add_u32 s44, s44, 8316928
    s_waitcnt lgkmcnt(9)
    v_mfma_f32_16x16x32_bf16 v[184:187], v[120:123], v[144:147], v[184:187]
    ds_read_b128 v[88:91], v6 offset:1376
    ds_read2_b32 v[56:57], v3 offset0:208 offset1:209
    s_waitcnt lgkmcnt(10)
    v_mfma_f32_16x16x32_bf16 v[188:191], v[112:115], v[156:159], v[188:191]
    ds_read2_b32 v[58:59], v3 offset0:210 offset1:211
    v_lshl_add_u32 v230, v1, 4, s44
    v_mfma_f32_16x16x32_bf16 v[188:191], v[116:119], v[152:155], v[188:191]
    ds_read_b128 v[92:95], v6 offset:1888
    v_and_b32_e64 v12, 15, v1
    v_mfma_f32_16x16x32_bf16 v[188:191], v[120:123], v[148:151], v[188:191]
    ds_read2_b32 v[60:61], v3 offset0:80 offset1:81
    v_lshrrev_b32 v13, 4, v1
    s_waitcnt lgkmcnt(11)
    v_mfma_f32_16x16x32_bf16 v[188:191], v[124:127], v[144:147], v[188:191]
    ds_read2_b32 v[62:63], v3 offset0:82 offset1:83
    s_lshl_b32 s44, s34, 12
    s_waitcnt lgkmcnt(9)
    v_mfma_f32_16x16x32_bf16 v[176:179], v[48:51], v[80:83], v[176:179]
    ds_read2_b32 v[112:113], v2 offset0:192 offset1:193
    ds_read2_b32 v[114:115], v2 offset0:194 offset1:195
    s_waitcnt lgkmcnt(10)
    v_mfma_f32_16x16x32_bf16 v[180:183], v[48:51], v[84:87], v[180:183]
    ds_read_b128 v[144:147], v6 offset:288
    s_waitcnt vmcnt(0)
    v_cmp_ne_u32 vcc, s37, v41
    s_nop 1
    s_cbranch_vccnz L_fw0_retry_18
L_fw0_back_19:
    s_waitcnt lgkmcnt(9)
    v_mfma_f32_16x16x32_bf16 v[180:183], v[52:55], v[80:83], v[180:183]
    ds_read_b128 v[148:151], v6 offset:800
    global_load_dwordx4 a[0:3], v230, s[32:33] offset:-4096 sc1
    s_waitcnt lgkmcnt(9)
    v_mfma_f32_16x16x32_bf16 v[184:187], v[48:51], v[88:91], v[184:187]
    ds_read2_b32 v[116:117], v2 offset0:64 offset1:65
    s_add_u32 s44, s44, 79104
    v_mfma_f32_16x16x32_bf16 v[184:187], v[52:55], v[84:87], v[184:187]
    ds_read2_b32 v[118:119], v2 offset0:66 offset1:67
    global_load_dwordx4 a[4:7], v230, s[32:33] offset:-3072 sc1
    s_waitcnt lgkmcnt(9)
    v_mfma_f32_16x16x32_bf16 v[184:187], v[56:59], v[80:83], v[184:187]
    ds_read_b128 v[152:155], v6 offset:1312
    ds_read2_b32 v[120:121], v3 offset0:192 offset1:193
    v_bfe_u32 v14, v12, 1, 2
    s_waitcnt lgkmcnt(10)
    v_mfma_f32_16x16x32_bf16 v[188:191], v[48:51], v[92:95], v[188:191]
    ds_read2_b32 v[122:123], v3 offset0:194 offset1:195
    global_load_dwordx4 a[8:11], v230, s[32:33] offset:-2048 sc1
    v_mfma_f32_16x16x32_bf16 v[188:191], v[52:55], v[88:91], v[188:191]
    ds_read_b128 v[156:159], v6 offset:1824
    v_xor_b32 v14, v14, v13
    v_mfma_f32_16x16x32_bf16 v[188:191], v[56:59], v[84:87], v[188:191]
    ds_read2_b32 v[124:125], v3 offset0:64 offset1:65
    global_load_dwordx4 a[12:15], v230, s[32:33] offset:-1024 sc1
    s_waitcnt lgkmcnt(11)
    v_mfma_f32_16x16x32_bf16 v[188:191], v[60:63], v[80:83], v[188:191]
    ds_read2_b32 v[126:127], v3 offset0:66 offset1:67
    v_lshl_add_u32 v14, v12, 2, v14
    s_waitcnt lgkmcnt(9)
    v_mfma_f32_16x16x32_bf16 v[176:179], v[112:115], v[144:147], v[176:179]
    ds_read2_b32 v[48:49], v2 offset0:176 offset1:177
    ds_read2_b32 v[50:51], v2 offset0:178 offset1:179
    s_waitcnt lgkmcnt(10)
    v_mfma_f32_16x16x32_bf16 v[180:183], v[112:115], v[148:151], v[180:183]
    ds_read_b128 v[80:83], v6 offset:224
    global_load_dwordx4 a[16:19], v230, s[32:33] offset:0 sc1
    s_waitcnt lgkmcnt(9)
    v_mfma_f32_16x16x32_bf16 v[180:183], v[116:119], v[144:147], v[180:183]
    ds_read_b128 v[84:87], v6 offset:736
    v_lshl_add_u32 v7, v14, 4, s44
    s_waitcnt lgkmcnt(9)
    v_mfma_f32_16x16x32_bf16 v[184:187], v[112:115], v[152:155], v[184:187]
    ds_read2_b32 v[52:53], v2 offset0:48 offset1:49
    global_load_dwordx4 a[20:23], v230, s[32:33] offset:1024 sc1
    v_mfma_f32_16x16x32_bf16 v[184:187], v[116:119], v[148:151], v[184:187]
    ds_read2_b32 v[54:55], v2 offset0:50 offset1:51
    s_lshl_b32 s44, s34, 10
    s_waitcnt lgkmcnt(9)
    v_mfma_f32_16x16x32_bf16 v[184:187], v[120:123], v[144:147], v[184:187]
    ds_read_b128 v[88:91], v6 offset:1248
    ds_read2_b32 v[56:57], v3 offset0:176 offset1:177
    s_waitcnt lgkmcnt(10)
    v_mfma_f32_16x16x32_bf16 v[188:191], v[112:115], v[156:159], v[188:191]
    ds_read2_b32 v[58:59], v3 offset0:178 offset1:179
    global_load_dwordx4 a[24:27], v230, s[32:33] offset:2048 sc1
    v_mfma_f32_16x16x32_bf16 v[188:191], v[116:119], v[152:155], v[188:191]
    ds_read_b128 v[92:95], v6 offset:1760
    s_add_u32 s44, s44, 79104
    v_mfma_f32_16x16x32_bf16 v[188:191], v[120:123], v[148:151], v[188:191]
    ds_read2_b32 v[60:61], v3 offset0:48 offset1:49
    global_load_dwordx4 a[28:31], v230, s[32:33] offset:3072 sc1
    v_add_u32 v230, 8192, v230
    s_waitcnt lgkmcnt(11)
    v_mfma_f32_16x16x32_bf16 v[188:191], v[124:127], v[144:147], v[188:191]
    ds_read2_b32 v[62:63], v3 offset0:50 offset1:51
    v_bfe_u32 v14, v1, 1, 2
    s_waitcnt lgkmcnt(9)
    v_mfma_f32_16x16x32_bf16 v[176:179], v[48:51], v[80:83], v[176:179]
    ds_read2_b32 v[112:113], v2 offset0:160 offset1:161
    ds_read2_b32 v[114:115], v2 offset0:162 offset1:163
    s_waitcnt lgkmcnt(10)
    v_mfma_f32_16x16x32_bf16 v[180:183], v[48:51], v[84:87], v[180:183]
    ds_read_b128 v[144:147], v6 offset:160
    global_load_dwordx4 a[32:35], v230, s[32:33] offset:-4096 sc1
    s_waitcnt lgkmcnt(9)
    v_mfma_f32_16x16x32_bf16 v[180:183], v[52:55], v[80:83], v[180:183]
    ds_read_b128 v[148:151], v6 offset:672
    v_xor_b32 v14, v14, v13
    s_waitcnt lgkmcnt(9)
    v_mfma_f32_16x16x32_bf16 v[184:187], v[48:51], v[88:91], v[184:187]
    ds_read2_b32 v[116:117], v2 offset0:32 offset1:33
    global_load_dwordx4 a[36:39], v230, s[32:33] offset:-3072 sc1
    v_mfma_f32_16x16x32_bf16 v[184:187], v[52:55], v[84:87], v[184:187]
    ds_read2_b32 v[118:119], v2 offset0:34 offset1:35
    v_lshrrev_b32 v15, 3, v1
    s_waitcnt lgkmcnt(9)
    v_mfma_f32_16x16x32_bf16 v[184:187], v[56:59], v[80:83], v[184:187]
    ds_read_b128 v[152:155], v6 offset:1184
    ds_read2_b32 v[120:121], v3 offset0:160 offset1:161
    s_waitcnt lgkmcnt(10)
    v_mfma_f32_16x16x32_bf16 v[188:191], v[48:51], v[92:95], v[188:191]
    ds_read2_b32 v[122:123], v3 offset0:162 offset1:163
    global_load_dwordx4 a[40:43], v230, s[32:33] offset:-2048 sc1
    v_mfma_f32_16x16x32_bf16 v[188:191], v[52:55], v[88:91], v[188:191]
    ds_read_b128 v[156:159], v6 offset:1696
    v_lshl_add_u32 v14, v15, 2, v14
    v_mfma_f32_16x16x32_bf16 v[188:191], v[56:59], v[84:87], v[188:191]
    ds_read2_b32 v[124:125], v3 offset0:32 offset1:33
    global_load_dwordx4 a[44:47], v230, s[32:33] offset:-1024 sc1
    s_waitcnt lgkmcnt(11)
    v_mfma_f32_16x16x32_bf16 v[188:191], v[60:63], v[80:83], v[188:191]
    ds_read2_b32 v[126:127], v3 offset0:34 offset1:35
    v_and_b32 v15, 1, v1
    s_waitcnt lgkmcnt(9)
    v_mfma_f32_16x16x32_bf16 v[176:179], v[112:115], v[144:147], v[176:179]
    ds_read2_b32 v[48:49], v2 offset0:144 offset1:145
    ds_read2_b32 v[50:51], v2 offset0:146 offset1:147
    s_waitcnt lgkmcnt(10)
    v_mfma_f32_16x16x32_bf16 v[180:183], v[112:115], v[148:151], v[180:183]
    ds_read_b128 v[80:83], v6 offset:96
    global_load_dwordx4 a[48:51], v230, s[32:33] offset:0 sc1
    s_waitcnt lgkmcnt(9)
    v_mfma_f32_16x16x32_bf16 v[180:183], v[116:119], v[144:147], v[180:183]
    ds_read_b128 v[84:87], v6 offset:608
    v_lshlrev_b32 v15, 3, v15
    s_waitcnt lgkmcnt(9)
    v_mfma_f32_16x16x32_bf16 v[184:187], v[112:115], v[152:155], v[184:187]
    ds_read2_b32 v[52:53], v2 offset0:16 offset1:17
    global_load_dwordx4 a[52:55], v230, s[32:33] offset:1024 sc1
    v_mfma_f32_16x16x32_bf16 v[184:187], v[116:119], v[148:151], v[184:187]
    ds_read2_b32 v[54:55], v2 offset0:18 offset1:19
    v_lshl_add_u32 v14, v14, 4, v15
    s_waitcnt lgkmcnt(9)
    v_mfma_f32_16x16x32_bf16 v[184:187], v[120:123], v[144:147], v[184:187]
    ds_read_b128 v[88:91], v6 offset:1120
    ds_read2_b32 v[56:57], v3 offset0:144 offset1:145
    s_waitcnt lgkmcnt(10)
    v_mfma_f32_16x16x32_bf16 v[188:191], v[112:115], v[156:159], v[188:191]
    ds_read2_b32 v[58:59], v3 offset0:146 offset1:147
    global_load_dwordx4 a[56:59], v230, s[32:33] offset:2048 sc1
    v_mfma_f32_16x16x32_bf16 v[188:191], v[116:119], v[152:155], v[188:191]
    ds_read_b128 v[92:95], v6 offset:1632
    v_add_u32_e64 v8, s44, v14
    v_mfma_f32_16x16x32_bf16 v[188:191], v[120:123], v[148:151], v[188:191]
    ds_read2_b32 v[60:61], v3 offset0:16 offset1:17
    global_load_dwordx4 a[60:63], v230, s[32:33] offset:3072 sc1
    v_add_u32 v230, 8192, v230
    s_waitcnt lgkmcnt(11)
    v_mfma_f32_16x16x32_bf16 v[188:191], v[124:127], v[144:147], v[188:191]
    ds_read2_b32 v[62:63], v3 offset0:18 offset1:19
    s_mul_i32 s44, s38, 16512
    s_waitcnt lgkmcnt(9)
    v_mfma_f32_16x16x32_bf16 v[176:179], v[48:51], v[80:83], v[176:179]
    ds_read2_b32 v[112:113], v2 offset0:128 offset1:129
    ds_read2_b32 v[114:115], v2 offset0:130 offset1:131
    s_waitcnt lgkmcnt(10)
    v_mfma_f32_16x16x32_bf16 v[180:183], v[48:51], v[84:87], v[180:183]
    ds_read_b128 v[144:147], v6 offset:32
    global_load_dwordx4 a[64:67], v230, s[32:33] offset:-4096 sc1
    s_waitcnt lgkmcnt(9)
    v_mfma_f32_16x16x32_bf16 v[180:183], v[52:55], v[80:83], v[180:183]
    ds_read_b128 v[148:151], v6 offset:544
    s_lshl_b32 s45, s34, 11
    s_waitcnt lgkmcnt(9)
    v_mfma_f32_16x16x32_bf16 v[184:187], v[48:51], v[88:91], v[184:187]
    ds_read2_b32 v[116:117], v2 offset0:0 offset1:1
    v_mfma_f32_16x16x32_bf16 v[184:187], v[52:55], v[84:87], v[184:187]
    ds_read2_b32 v[118:119], v2 offset0:2 offset1:3
    s_add_u32 s44, s44, s45
    s_waitcnt lgkmcnt(9)
    v_mfma_f32_16x16x32_bf16 v[184:187], v[56:59], v[80:83], v[184:187]
    ds_read_b128 v[152:155], v6 offset:1056
    ds_read2_b32 v[120:121], v3 offset0:128 offset1:129
    global_load_dwordx4 a[68:71], v230, s[32:33] offset:-3072 sc1
    s_waitcnt lgkmcnt(10)
    v_mfma_f32_16x16x32_bf16 v[188:191], v[48:51], v[92:95], v[188:191]
    ds_read2_b32 v[122:123], v3 offset0:130 offset1:131
    v_mfma_f32_16x16x32_bf16 v[188:191], v[52:55], v[88:91], v[188:191]
    ds_read_b128 v[156:159], v6 offset:1568
    s_add_u32 s44, s44, 3375104
    v_mfma_f32_16x16x32_bf16 v[188:191], v[56:59], v[84:87], v[188:191]
    ds_read2_b32 v[124:125], v3 offset0:0 offset1:1
    v_lshl_add_u32 v9, v1, 4, s44
    s_waitcnt lgkmcnt(11)
    v_mfma_f32_16x16x32_bf16 v[188:191], v[60:63], v[80:83], v[188:191]
    ds_read2_b32 v[126:127], v3 offset0:2 offset1:3
    global_load_dwordx4 a[72:75], v230, s[32:33] offset:-2048 sc1
    s_waitcnt lgkmcnt(9)
    v_mfma_f32_16x16x32_bf16 v[176:179], v[112:115], v[144:147], v[176:179]
    ds_read2_b32 v[48:49], v2 offset0:240 offset1:241
    ds_read2_b32 v[50:51], v2 offset0:242 offset1:243
    ds_read_b128 v[96:99], v6 offset:2528
    s_waitcnt lgkmcnt(11)
    v_mfma_f32_16x16x32_bf16 v[180:183], v[112:115], v[148:151], v[180:183]
    ds_read2_b32 v[52:53], v2 offset0:112 offset1:113
    ds_read2_b32 v[54:55], v2 offset0:114 offset1:115
    s_waitcnt lgkmcnt(11)
    v_mfma_f32_16x16x32_bf16 v[180:183], v[116:119], v[144:147], v[180:183]
    ds_read_b128 v[92:95], v6 offset:2016
    ds_read2_b32 v[56:57], v3 offset0:240 offset1:241
    ds_read2_b32 v[58:59], v3 offset0:242 offset1:243
    s_waitcnt lgkmcnt(13)
    v_mfma_f32_16x16x32_bf16 v[184:187], v[112:115], v[152:155], v[184:187]
    ds_read_b128 v[88:91], v6 offset:1504
    ds_read2_b32 v[60:61], v3 offset0:112 offset1:113
    global_load_dwordx4 a[76:79], v230, s[32:33] offset:-1024 sc1
    v_mfma_f32_16x16x32_bf16 v[184:187], v[116:119], v[148:151], v[184:187]
    ds_read2_b32 v[62:63], v3 offset0:114 offset1:115
    ds_read_b128 v[84:87], v6 offset:992
    s_waitcnt lgkmcnt(15)
    v_mfma_f32_16x16x32_bf16 v[184:187], v[120:123], v[144:147], v[184:187]
    ds_read2_b32 v[64:65], v4 offset0:240 offset1:241
    ds_read2_b32 v[66:67], v4 offset0:242 offset1:243
    ds_read_b128 v[80:83], v6 offset:480
    s_waitcnt lgkmcnt(15)
    v_mfma_f32_16x16x32_bf16 v[188:191], v[112:115], v[156:159], v[188:191]
    ds_read_b128 v[100:103], v6 offset:3040
    ds_read2_b32 v[68:69], v4 offset0:112 offset1:113
    global_load_dwordx4 a[80:83], v230, s[32:33] offset:0 sc1
    v_mfma_f32_16x16x32_bf16 v[188:191], v[116:119], v[152:155], v[188:191]
    ds_read2_b32 v[70:71], v4 offset0:114 offset1:115
    ds_read_b128 v[104:107], v6 offset:3552
    ds_read2_b32 v[72:73], v5 offset0:240 offset1:241
    v_mfma_f32_16x16x32_bf16 v[188:191], v[120:123], v[148:151], v[188:191]
    ds_read2_b32 v[74:75], v5 offset0:242 offset1:243
    ds_read_b128 v[108:111], v6 offset:4064
    s_waitcnt lgkmcnt(15)
    v_mfma_f32_16x16x32_bf16 v[188:191], v[124:127], v[144:147], v[188:191]
    ds_read2_b32 v[76:77], v5 offset0:112 offset1:113
    ds_read2_b32 v[78:79], v5 offset0:114 offset1:115
    global_load_dwordx4 a[84:87], v230, s[32:33] offset:1024 sc1
    ds_write_b128 v7, v[176:179] offset:0
    ds_write_b128 v7, v[180:183] offset:1024
    ds_write_b128 v7, v[184:187] offset:2048
    s_nop 1
    ds_write_b128 v7, v[188:191] offset:3072
    s_waitcnt lgkmcnt(0)
    s_barrier
    ds_read_b64 v[12:13], v8 offset:0
    ds_read_b64 v[14:15], v8 offset:4096
    ds_read_b64 v[16:17], v8 offset:8192
    ds_read_b64 v[18:19], v8 offset:12288
    ds_read_b64 v[20:21], v8 offset:512
    ds_read_b64 v[22:23], v8 offset:4608
    ds_read_b64 v[24:25], v8 offset:8704
    ds_read_b64 v[26:27], v8 offset:12800
    s_waitcnt lgkmcnt(4)
    s_nop 0
    v_pk_fma_f32 v[12:13], v[12:13], s[72:73], v[196:197] op_sel_hi:[1,0,1]
    v_pk_fma_f32 v[14:15], v[14:15], s[74:75], v[198:199] op_sel_hi:[1,0,1]
    v_pk_fma_f32 v[16:17], v[16:17], s[76:77], v[200:201] op_sel_hi:[1,0,1]
    v_pk_fma_f32 v[18:19], v[18:19], s[78:79], v[202:203] op_sel_hi:[1,0,1]
    v_cvt_pk_bf16_f32 v28, v12, v14
    v_cvt_pk_bf16_f32 v29, v16, v18
    v_cvt_pk_bf16_f32 v30, v13, v15
    v_cvt_pk_bf16_f32 v31, v17, v19
    global_store_dwordx4 v9, v[28:31], s[32:33] offset:0 sc1
    s_waitcnt lgkmcnt(0)
    s_nop 0
    v_pk_fma_f32 v[20:21], v[20:21], s[72:73], v[204:205] op_sel_hi:[1,0,1]
    v_pk_fma_f32 v[22:23], v[22:23], s[74:75], v[206:207] op_sel_hi:[1,0,1]
    v_pk_fma_f32 v[24:25], v[24:25], s[76:77], v[208:209] op_sel_hi:[1,0,1]
    v_pk_fma_f32 v[26:27], v[26:27], s[78:79], v[210:211] op_sel_hi:[1,0,1]
    v_cvt_pk_bf16_f32 v32, v20, v22
    v_cvt_pk_bf16_f32 v33, v24, v26
    v_cvt_pk_bf16_f32 v34, v21, v23
    v_cvt_pk_bf16_f32 v35, v25, v27
    global_store_dwordx4 v9, v[32:35], s[32:33] offset:1024 sc1
    v_add_u32 v9, 8192, v9
    s_mul_i32 s45, s34, 4224
    s_add_u32 s45, s45, 31808
    v_add_u32_e64 v7, s45, v7
    v_add_u32 v8, 31808, v8
    v_mfma_f32_16x16x32_bf16 v[176:179], v[48:51], v[96:99], 0
    ds_read2_b32 v[112:113], v2 offset0:224 offset1:225
    v_mfma_f32_16x16x32_bf16 v[176:179], v[52:55], v[92:95], v[176:179]
    ds_read2_b32 v[114:115], v2 offset0:226 offset1:227
    global_load_dwordx4 a[88:91], v230, s[32:33] offset:2048 sc1
    v_mfma_f32_16x16x32_bf16 v[176:179], v[56:59], v[88:91], v[176:179]
    ds_read_b128 v[160:163], v6 offset:2464
    s_lshl_b32 s44, s40, 7
    v_mfma_f32_16x16x32_bf16 v[176:179], v[60:63], v[84:87], v[176:179]
    ds_read2_b32 v[116:117], v2 offset0:96 offset1:97
    s_add_u32 s44, s44, 147456
    v_mfma_f32_16x16x32_bf16 v[176:179], v[64:67], v[80:83], v[176:179]
    ds_read2_b32 v[118:119], v2 offset0:98 offset1:99
    v_min_u32 v39, 19, v1
    v_mfma_f32_16x16x32_bf16 v[180:183], v[48:51], v[100:103], 0
    ds_read_b128 v[156:159], v6 offset:1952
    v_lshl_add_u32 v39, v39, 2, s44
    v_mfma_f32_16x16x32_bf16 v[180:183], v[52:55], v[96:99], v[180:183]
    ds_read2_b32 v[120:121], v3 offset0:224 offset1:225
    v_mfma_f32_16x16x32_bf16 v[180:183], v[56:59], v[92:95], v[180:183]
    ds_read2_b32 v[122:123], v3 offset0:226 offset1:227
    global_load_dwordx4 a[92:95], v230, s[32:33] offset:3072 sc1
    v_add_u32 v230, 8192, v230
    v_mfma_f32_16x16x32_bf16 v[180:183], v[60:63], v[88:91], v[180:183]
    ds_read_b128 v[152:155], v6 offset:1440
    s_lshl_b32 s44, s38, 2
    v_mfma_f32_16x16x32_bf16 v[180:183], v[64:67], v[84:87], v[180:183]
    ds_read2_b32 v[124:125], v3 offset0:96 offset1:97
    s_add_u32 s44, s44, s34
    v_mfma_f32_16x16x32_bf16 v[180:183], v[68:71], v[80:83], v[180:183]
    ds_read2_b32 v[126:127], v3 offset0:98 offset1:99
    s_and_b32 s44, s44, 31
    v_mfma_f32_16x16x32_bf16 v[184:187], v[48:51], v[104:107], 0
    ds_read_b128 v[148:151], v6 offset:928
    s_lshl_b32 s44, s44, 7
    v_mfma_f32_16x16x32_bf16 v[184:187], v[52:55], v[100:103], v[184:187]
    global_load_dwordx4 a[96:99], v230, s[32:33] offset:-4096 sc1
    v_mfma_f32_16x16x32_bf16 v[184:187], v[56:59], v[96:99], v[184:187]
    ds_read2_b32 v[128:129], v4 offset0:224 offset1:225
    v_mfma_f32_16x16x32_bf16 v[184:187], v[60:63], v[92:95], v[184:187]
    ds_read2_b32 v[130:131], v4 offset0:226 offset1:227
    s_add_u32 s44, s44, 65536
    v_mfma_f32_16x16x32_bf16 v[184:187], v[64:67], v[88:91], v[184:187]
    ds_read_b128 v[144:147], v6 offset:416
    v_lshl_add_u32 v42, v1, 12, s44
    v_mfma_f32_16x16x32_bf16 v[184:187], v[68:71], v[84:87], v[184:187]
    ds_read_b128 v[164:167], v6 offset:2976
    v_mov_b32_e64 v43, 1
    v_mfma_f32_16x16x32_bf16 v[184:187], v[72:75], v[80:83], v[184:187]
    ds_read2_b32 v[132:133], v4 offset0:96 offset1:97
    s_mul_i32 s44, s40, 143488
    v_mfma_f32_16x16x32_bf16 v[188:191], v[48:51], v[108:111], 0
    ds_read2_b32 v[134:135], v4 offset0:98 offset1:99
    global_load_dwordx4 a[100:103], v230, s[32:33] offset:-3072 sc1
    v_mfma_f32_16x16x32_bf16 v[188:191], v[52:55], v[104:107], v[188:191]
    ds_read_b128 v[168:171], v6 offset:3488
    v_mfma_f32_16x16x32_bf16 v[188:191], v[56:59], v[100:103], v[188:191]
    ds_read2_b32 v[136:137], v5 offset0:224 offset1:225
    s_lshl_b32 s45, s34, 12
    v_mfma_f32_16x16x32_bf16 v[188:191], v[60:63], v[96:99], v[188:191]
    ds_read2_b32 v[138:139], v5 offset0:226 offset1:227
    s_add_u32 s44, s44, s45
    v_mfma_f32_16x16x32_bf16 v[188:191], v[64:67], v[92:95], v[188:191]
    ds_read_b128 v[172:175], v6 offset:4000
    s_add_u32 s44, s44, 6017024
    v_mfma_f32_16x16x32_bf16 v[188:191], v[68:71], v[88:91], v[188:191]
    ds_read2_b32 v[140:141], v5 offset0:96 offset1:97
    v_lshl_add_u32 v228, v1, 4, s44
    v_mfma_f32_16x16x32_bf16 v[188:191], v[72:75], v[84:87], v[188:191]
    ds_read2_b32 v[142:143], v5 offset0:98 offset1:99
    global_load_dwordx4 a[104:107], v230, s[32:33] offset:-2048 sc1
    v_mfma_f32_16x16x32_bf16 v[188:191], v[76:79], v[80:83], v[188:191]
    s_add_u32 s58, s45, 0
    s_waitcnt lgkmcnt(15)
    v_mfma_f32_16x16x32_bf16 v[176:179], v[112:115], v[160:163], v[176:179]
    ds_read2_b32 v[48:49], v2 offset0:208 offset1:209
    s_waitcnt lgkmcnt(15)
    v_mfma_f32_16x16x32_bf16 v[176:179], v[116:119], v[156:159], v[176:179]
    ds_read2_b32 v[50:51], v2 offset0:210 offset1:211
    global_load_dword v41, v39, s[32:33] sc1
    s_waitcnt lgkmcnt(15)
    v_mfma_f32_16x16x32_bf16 v[176:179], v[120:123], v[152:155], v[176:179]
    ds_read_b128 v[96:99], v6 offset:2400
    global_load_dwordx4 a[108:111], v230, s[32:33] offset:-1024 sc1
    s_waitcnt lgkmcnt(15)
    v_mfma_f32_16x16x32_bf16 v[176:179], v[124:127], v[148:151], v[176:179]
    ds_read2_b32 v[52:53], v2 offset0:80 offset1:81
    s_mul_i32 s44, s40, 8960
    s_waitcnt lgkmcnt(13)
    v_mfma_f32_16x16x32_bf16 v[176:179], v[128:131], v[144:147], v[176:179]
    ds_read2_b32 v[54:55], v2 offset0:82 offset1:83
    s_add_u32 s44, s44, 527872
    s_waitcnt lgkmcnt(13)
    v_mfma_f32_16x16x32_bf16 v[180:183], v[112:115], v[164:167], v[180:183]
    ds_read_b128 v[92:95], v6 offset:1888
    v_min_u32 v44, 223, v0
    v_mfma_f32_16x16x32_bf16 v[180:183], v[116:119], v[160:163], v[180:183]
    ds_read2_b32 v[56:57], v3 offset0:208 offset1:209
    v_lshl_add_u32 v44, v44, 3, s44
    v_mfma_f32_16x16x32_bf16 v[180:183], v[120:123], v[156:159], v[180:183]
    ds_read2_b32 v[58:59], v3 offset0:210 offset1:211
    global_load_dwordx4 a[112:115], v230, s[32:33] offset:0 sc1
    v_mfma_f32_16x16x32_bf16 v[180:183], v[124:127], v[152:155], v[180:183]
    ds_read_b128 v[88:91], v6 offset:1376
    v_mfma_f32_16x16x32_bf16 v[180:183], v[128:131], v[148:151], v[180:183]
    ds_read2_b32 v[60:61], v3 offset0:80 offset1:81
    s_lshl_b32 s44, s41, 6
    s_waitcnt lgkmcnt(15)
    v_mfma_f32_16x16x32_bf16 v[180:183], v[132:135], v[144:147], v[180:183]
    ds_read2_b32 v[62:63], v3 offset0:82 offset1:83
    s_add_u32 s44, s44, 3200
    s_waitcnt lgkmcnt(15)
    v_mfma_f32_16x16x32_bf16 v[184:187], v[112:115], v[168:171], v[184:187]
    ds_read_b128 v[84:87], v6 offset:864
    s_lshl_b32 s45, s41, 4
    v_mfma_f32_16x16x32_bf16 v[184:187], v[116:119], v[164:167], v[184:187]
    s_add_u32 s45, s45, 3712
    v_mfma_f32_16x16x32_bf16 v[184:187], v[120:123], v[160:163], v[184:187]
    ds_read2_b32 v[64:65], v4 offset0:208 offset1:209
    global_load_dwordx4 a[116:119], v230, s[32:33] offset:1024 sc1
    v_mfma_f32_16x16x32_bf16 v[184:187], v[124:127], v[156:159], v[184:187]
    ds_read2_b32 v[66:67], v4 offset0:210 offset1:211
    v_and_b32 v12, 3, v1
    v_mfma_f32_16x16x32_bf16 v[184:187], v[128:131], v[152:155], v[184:187]
    ds_read_b128 v[80:83], v6 offset:352
    v_mul_u32_u24 v12, 30720, v12
    v_mfma_f32_16x16x32_bf16 v[184:187], v[132:135], v[148:151], v[184:187]
    ds_read_b128 v[100:103], v6 offset:2912
    v_add_u32 v12, 311296, v12
    s_waitcnt lgkmcnt(15)
    v_mfma_f32_16x16x32_bf16 v[184:187], v[136:139], v[144:147], v[184:187]
    ds_read2_b32 v[68:69], v4 offset0:80 offset1:81
    s_waitcnt lgkmcnt(15)
    v_mfma_f32_16x16x32_bf16 v[188:191], v[112:115], v[172:175], v[188:191]
    ds_read2_b32 v[70:71], v4 offset0:82 offset1:83
    v_lshrrev_b32_e64 v10, 2, v0
    v_mfma_f32_16x16x32_bf16 v[188:191], v[116:119], v[168:171], v[188:191]
    ds_read_b128 v[104:107], v6 offset:3424
    global_load_dwordx4 a[120:123], v230, s[32:33] offset:2048 sc1
    v_mfma_f32_16x16x32_bf16 v[188:191], v[120:123], v[164:167], v[188:191]
    ds_read2_b32 v[72:73], v5 offset0:208 offset1:209
    v_min_u32_e64 v11, 15, v10
    v_mfma_f32_16x16x32_bf16 v[188:191], v[124:127], v[160:163], v[188:191]
    ds_read2_b32 v[74:75], v5 offset0:210 offset1:211
    v_add_u32_e64 v10, s44, v10
    v_mfma_f32_16x16x32_bf16 v[188:191], v[128:131], v[156:159], v[188:191]
    ds_read_b128 v[108:111], v6 offset:3936
    v_and_b32_e64 v13, 7, v10
    v_mfma_f32_16x16x32_bf16 v[188:191], v[132:135], v[152:155], v[188:191]
    ds_read2_b32 v[76:77], v5 offset0:80 offset1:81
    v_lshlrev_b32_e64 v13, 6, v13
    v_mfma_f32_16x16x32_bf16 v[188:191], v[136:139], v[148:151], v[188:191]
    ds_read2_b32 v[78:79], v5 offset0:82 offset1:83
    global_load_dwordx4 a[124:127], v230, s[32:33] offset:3072 sc1
    v_add_u32 v230, 8192, v230
    s_waitcnt lgkmcnt(15)
    v_mfma_f32_16x16x32_bf16 v[188:191], v[140:143], v[144:147], v[188:191]
    v_and_or_b32 v13, v10, 56, v13
    s_waitcnt lgkmcnt(15)
    v_mfma_f32_16x16x32_bf16 v[176:179], v[48:51], v[96:99], v[176:179]
    ds_read2_b32 v[112:113], v2 offset0:192 offset1:193
    s_waitcnt lgkmcnt(15)
    v_mfma_f32_16x16x32_bf16 v[176:179], v[52:55], v[92:95], v[176:179]
    ds_read2_b32 v[114:115], v2 offset0:194 offset1:195
    s_waitcnt vmcnt(11)
    s_mov_b64 exec, 0xff
    global_atomic_add v42, v43, s[32:33] sc1
    s_mov_b64 exec, -1
    v_add_u32 v42, 0x8000, v42
    s_waitcnt lgkmcnt(15)
    v_mfma_f32_16x16x32_bf16 v[176:179], v[56:59], v[88:91], v[176:179]
    ds_read_b128 v[160:163], v6 offset:2336
    global_load_dwordx4 a[128:131], v230, s[32:33] offset:-4096 sc1
    s_waitcnt lgkmcnt(15)
    v_mfma_f32_16x16x32_bf16 v[176:179], v[60:63], v[84:87], v[176:179]
    ds_read2_b32 v[116:117], v2 offset0:64 offset1:65
    v_lshrrev_b32_e64 v10, 6, v10
    s_waitcnt lgkmcnt(13)
    v_mfma_f32_16x16x32_bf16 v[176:179], v[64:67], v[80:83], v[176:179]
    ds_read2_b32 v[118:119], v2 offset0:66 offset1:67
    v_lshl_add_u32 v10, v10, 9, v13
    s_waitcnt lgkmcnt(13)
    v_mfma_f32_16x16x32_bf16 v[180:183], v[48:51], v[100:103], v[180:183]
    ds_read_b128 v[156:159], v6 offset:1824
    v_mfma_f32_16x16x32_bf16 v[180:183], v[52:55], v[96:99], v[180:183]
    ds_read2_b32 v[120:121], v3 offset0:192 offset1:193
    v_add_u32 v10, v10, v12
    v_mfma_f32_16x16x32_bf16 v[180:183], v[56:59], v[92:95], v[180:183]
    ds_read2_b32 v[122:123], v3 offset0:194 offset1:195
    v_add_u32_e64 v11, s45, v11
    v_mfma_f32_16x16x32_bf16 v[180:183], v[60:63], v[88:91], v[180:183]
    ds_read_b128 v[152:155], v6 offset:1312
    v_and_b32_e64 v13, 7, v11
    v_mfma_f32_16x16x32_bf16 v[180:183], v[64:67], v[84:87], v[180:183]
    ds_read2_b32 v[124:125], v3 offset0:64 offset1:65
    v_lshlrev_b32 v13, 6, v13
    s_waitcnt lgkmcnt(15)
    v_mfma_f32_16x16x32_bf16 v[180:183], v[68:71], v[80:83], v[180:183]
    ds_read2_b32 v[126:127], v3 offset0:66 offset1:67
    s_waitcnt lgkmcnt(15)
    v_mfma_f32_16x16x32_bf16 v[184:187], v[48:51], v[104:107], v[184:187]
    ds_read_b128 v[148:151], v6 offset:800
    global_load_dwordx4 a[132:135], v230, s[32:33] offset:-3072 sc1
    v_mfma_f32_16x16x32_bf16 v[184:187], v[52:55], v[100:103], v[184:187]
    v_and_or_b32 v13, v11, 56, v13
    v_mfma_f32_16x16x32_bf16 v[184:187], v[56:59], v[96:99], v[184:187]
    ds_read2_b32 v[128:129], v4 offset0:192 offset1:193
    v_lshrrev_b32 v11, 6, v11
    v_mfma_f32_16x16x32_bf16 v[184:187], v[60:63], v[92:95], v[184:187]
    ds_read2_b32 v[130:131], v4 offset0:194 offset1:195
    v_lshl_add_u32 v11, v11, 9, v13
    v_mfma_f32_16x16x32_bf16 v[184:187], v[64:67], v[88:91], v[184:187]
    ds_read_b128 v[144:147], v6 offset:288
    v_mfma_f32_16x16x32_bf16 v[184:187], v[68:71], v[84:87], v[184:187]
    ds_read_b128 v[164:167], v6 offset:2848
    v_add_u32 v11, v11, v12
    s_waitcnt lgkmcnt(15)
    v_mfma_f32_16x16x32_bf16 v[184:187], v[72:75], v[80:83], v[184:187]
    ds_read2_b32 v[132:133], v4 offset0:64 offset1:65
    s_lshl_b32 s45, s35, 12
    s_waitcnt lgkmcnt(15)
    v_mfma_f32_16x16x32_bf16 v[188:191], v[48:51], v[108:111], v[188:191]
    ds_read2_b32 v[134:135], v4 offset0:66 offset1:67
    s_add_u32 s45, s45, 65536
    v_mfma_f32_16x16x32_bf16 v[188:191], v[52:55], v[104:107], v[188:191]
    ds_read_b128 v[168:171], v6 offset:3360
    global_load_dwordx4 a[136:139], v230, s[32:33] offset:-2048 sc1
    v_mfma_f32_16x16x32_bf16 v[188:191], v[56:59], v[100:103], v[188:191]
    ds_read2_b32 v[136:137], v5 offset0:192 offset1:193
    v_mfma_f32_16x16x32_bf16 v[188:191], v[60:63], v[96:99], v[188:191]
    ds_read2_b32 v[138:139], v5 offset0:194 offset1:195
    v_and_b32_e64 v46, 31, v1
    v_mfma_f32_16x16x32_bf16 v[188:191], v[64:67], v[92:95], v[188:191]
    ds_read_b128 v[172:175], v6 offset:3872
    v_lshl_add_u32 v46, v46, 7, s45
    v_mfma_f32_16x16x32_bf16 v[188:191], v[68:71], v[88:91], v[188:191]
    ds_read2_b32 v[140:141], v5 offset0:64 offset1:65
    s_lshl_b32 s44, s39, 9
    v_mfma_f32_16x16x32_bf16 v[188:191], v[72:75], v[84:87], v[188:191]
    ds_read2_b32 v[142:143], v5 offset0:66 offset1:67
    s_lshl_b32 s45, s34, 7
    s_waitcnt lgkmcnt(15)
    v_mfma_f32_16x16x32_bf16 v[188:191], v[76:79], v[80:83], v[188:191]
    s_add_u32 s44, s44, s45
    s_waitcnt lgkmcnt(15)
    v_mfma_f32_16x16x32_bf16 v[176:179], v[112:115], v[160:163], v[176:179]
    ds_read2_b32 v[48:49], v2 offset0:176 offset1:177
    s_waitcnt lgkmcnt(15)
    v_mfma_f32_16x16x32_bf16 v[176:179], v[116:119], v[156:159], v[176:179]
    ds_read2_b32 v[50:51], v2 offset0:178 offset1:179
    s_waitcnt vmcnt(9)
    v_cmp_ne_u32 vcc, s37, v41
    s_nop 1
    s_cbranch_vccnz L_fw1_retry_20
L_fw1_back_21:
    s_barrier
    s_waitcnt lgkmcnt(15)
    v_mfma_f32_16x16x32_bf16 v[176:179], v[120:123], v[152:155], v[176:179]
    ds_read_b128 v[96:99], v6 offset:2272
    s_mov_b32 m0, s58
    s_nop 0
    global_load_lds_dwordx4 v228, s[32:33] offset:0 sc1
    s_waitcnt lgkmcnt(15)
    v_mfma_f32_16x16x32_bf16 v[176:179], v[124:127], v[148:151], v[176:179]
    ds_read2_b32 v[52:53], v2 offset0:48 offset1:49
    s_add_u32 s44, s44, 3375104
    s_waitcnt lgkmcnt(13)
    v_mfma_f32_16x16x32_bf16 v[176:179], v[128:131], v[144:147], v[176:179]
    ds_read2_b32 v[54:55], v2 offset0:50 offset1:51
    v_lshrrev_b32 v192, 3, v1
    s_waitcnt lgkmcnt(13)
    v_mfma_f32_16x16x32_bf16 v[180:183], v[112:115], v[164:167], v[180:183]
    ds_read_b128 v[92:95], v6 offset:1760
    v_mul_u32_u24 v192, 16512, v192
    v_mfma_f32_16x16x32_bf16 v[180:183], v[116:119], v[160:163], v[180:183]
    ds_read2_b32 v[56:57], v3 offset0:176 offset1:177
    global_load_lds_dwordx4 v228, s[32:33] offset:1024 sc1
    v_mfma_f32_16x16x32_bf16 v[180:183], v[120:123], v[156:159], v[180:183]
    ds_read2_b32 v[58:59], v3 offset0:178 offset1:179
    v_add_u32_e64 v192, s44, v192
    v_mfma_f32_16x16x32_bf16 v[180:183], v[124:127], v[152:155], v[180:183]
    ds_read_b128 v[88:91], v6 offset:1248
    v_and_b32_e64 v47, 7, v1
    v_mfma_f32_16x16x32_bf16 v[180:183], v[128:131], v[148:151], v[180:183]
    ds_read2_b32 v[60:61], v3 offset0:48 offset1:49
    v_lshl_add_u32 v192, v47, 4, v192
    s_waitcnt lgkmcnt(15)
    v_mfma_f32_16x16x32_bf16 v[180:183], v[132:135], v[144:147], v[180:183]
    ds_read2_b32 v[62:63], v3 offset0:50 offset1:51
    global_load_lds_dwordx4 v228, s[32:33] offset:2048 sc1
    s_waitcnt lgkmcnt(15)
    v_mfma_f32_16x16x32_bf16 v[184:187], v[112:115], v[168:171], v[184:187]
    ds_read_b128 v[84:87], v6 offset:736
    v_lshlrev_b32_e64 v193, 4, v1
    v_mfma_f32_16x16x32_bf16 v[184:187], v[116:119], v[164:167], v[184:187]
    v_add_u32 v194, 64512, v193
    v_mfma_f32_16x16x32_bf16 v[184:187], v[120:123], v[160:163], v[184:187]
    ds_read2_b32 v[64:65], v4 offset0:176 offset1:177
    v_mfma_f32_16x16x32_bf16 v[184:187], v[124:127], v[156:159], v[184:187]
    ds_read2_b32 v[66:67], v4 offset0:178 offset1:179
    v_add_u32 v195, 129024, v193
    v_mfma_f32_16x16x32_bf16 v[184:187], v[128:131], v[152:155], v[184:187]
    ds_read_b128 v[80:83], v6 offset:224
    global_load_lds_dwordx4 v228, s[32:33] offset:3072 sc1
    s_add_u32 s58, s58, 16384
    v_add_u32 v228, 16384, v228
    v_mfma_f32_16x16x32_bf16 v[184:187], v[132:135], v[148:151], v[184:187]
    ds_read_b128 v[100:103], v6 offset:2784
    s_lshl_b32 s44, s39, 2
    s_waitcnt lgkmcnt(15)
    v_mfma_f32_16x16x32_bf16 v[184:187], v[136:139], v[144:147], v[184:187]
    ds_read2_b32 v[68:69], v4 offset0:48 offset1:49
    s_add_u32 s46, s44, s34
    s_waitcnt lgkmcnt(15)
    v_mfma_f32_16x16x32_bf16 v[188:191], v[112:115], v[172:175], v[188:191]
    ds_read2_b32 v[70:71], v4 offset0:50 offset1:51
    s_mul_i32 s44, s46, 57472
    v_mfma_f32_16x16x32_bf16 v[188:191], v[116:119], v[168:171], v[188:191]
    ds_read_b128 v[104:107], v6 offset:3296
    s_mov_b32 m0, s58
    s_nop 0
    global_load_lds_dwordx4 v228, s[32:33] offset:0 sc1
    v_mfma_f32_16x16x32_bf16 v[188:191], v[120:123], v[164:167], v[188:191]
    ds_read2_b32 v[72:73], v5 offset0:176 offset1:177
    s_add_u32 s44, s44, 10607616
    v_mfma_f32_16x16x32_bf16 v[188:191], v[124:127], v[160:163], v[188:191]
    ds_read2_b32 v[74:75], v5 offset0:178 offset1:179
    s_mul_i32 s45, s40, 3072
    v_mfma_f32_16x16x32_bf16 v[188:191], v[128:131], v[156:159], v[188:191]
    ds_read_b128 v[108:111], v6 offset:3808
    s_add_u32 s6, s45, s44
    v_mfma_f32_16x16x32_bf16 v[188:191], v[132:135], v[152:155], v[188:191]
    ds_read2_b32 v[76:77], v5 offset0:48 offset1:49
    global_load_lds_dwordx4 v228, s[32:33] offset:1024 sc1
    v_mfma_f32_16x16x32_bf16 v[188:191], v[136:139], v[148:151], v[188:191]
    ds_read2_b32 v[78:79], v5 offset0:50 offset1:51
    s_lshl_b32 s45, s40, 9
    s_waitcnt lgkmcnt(15)
    v_mfma_f32_16x16x32_bf16 v[188:191], v[140:143], v[144:147], v[188:191]
    s_add_u32 s45, s45, s44
    s_waitcnt lgkmcnt(15)
    v_mfma_f32_16x16x32_bf16 v[176:179], v[48:51], v[96:99], v[176:179]
    ds_read2_b32 v[112:113], v2 offset0:160 offset1:161
    global_load_lds_dwordx4 v228, s[32:33] offset:2048 sc1
    s_waitcnt lgkmcnt(15)
    v_mfma_f32_16x16x32_bf16 v[176:179], v[52:55], v[92:95], v[176:179]
    ds_read2_b32 v[114:115], v2 offset0:162 offset1:163
    global_load_dwordx2 v[196:197], v44, s[32:33] offset:-3584 sc1
    s_waitcnt lgkmcnt(15)
    v_mfma_f32_16x16x32_bf16 v[176:179], v[56:59], v[88:91], v[176:179]
    ds_read_b128 v[160:163], v6 offset:2208
    s_add_u32 s7, s45, 49152
    s_waitcnt lgkmcnt(15)
    v_mfma_f32_16x16x32_bf16 v[176:179], v[60:63], v[84:87], v[176:179]
    ds_read2_b32 v[116:117], v2 offset0:32 offset1:33
    global_load_dwordx2 v[198:199], v44, s[32:33] offset:-1792 sc1
    s_waitcnt lgkmcnt(13)
    v_mfma_f32_16x16x32_bf16 v[176:179], v[64:67], v[80:83], v[176:179]
    ds_read2_b32 v[118:119], v2 offset0:34 offset1:35
    s_lshl_b32 s46, s46, 7
    s_waitcnt lgkmcnt(13)
    v_mfma_f32_16x16x32_bf16 v[180:183], v[48:51], v[100:103], v[180:183]
    ds_read_b128 v[156:159], v6 offset:1696
    global_load_dwordx2 v[200:201], v44, s[32:33] offset:0 sc1
    v_mfma_f32_16x16x32_bf16 v[180:183], v[52:55], v[96:99], v[180:183]
    ds_read2_b32 v[120:121], v3 offset0:160 offset1:161
    s_lshl_b32 s45, s40, 2
    v_mfma_f32_16x16x32_bf16 v[180:183], v[56:59], v[92:95], v[180:183]
    ds_read2_b32 v[122:123], v3 offset0:162 offset1:163
    global_load_dwordx2 v[202:203], v44, s[32:33] offset:1792 sc1
    v_mfma_f32_16x16x32_bf16 v[180:183], v[60:63], v[88:91], v[180:183]
    ds_read_b128 v[152:155], v6 offset:1184
    global_load_lds_dwordx4 v228, s[32:33] offset:3072 sc1
    s_add_u32 s58, s58, 16384
    v_add_u32 v228, 16384, v228
    global_load_dwordx2 v[204:205], v44, s[32:33] offset:3584 sc1
    v_mfma_f32_16x16x32_bf16 v[180:183], v[64:67], v[84:87], v[180:183]
    ds_read2_b32 v[124:125], v3 offset0:32 offset1:33
    s_add_u32 s46, s46, s45
    s_waitcnt lgkmcnt(15)
    v_mfma_f32_16x16x32_bf16 v[180:183], v[68:71], v[80:83], v[180:183]
    ds_read2_b32 v[126:127], v3 offset0:34 offset1:35
    global_load_dwordx2 v[206:207], v10, s[32:33] sc1
    s_waitcnt lgkmcnt(15)
    v_mfma_f32_16x16x32_bf16 v[184:187], v[48:51], v[104:107], v[184:187]
    ds_read_b128 v[148:151], v6 offset:672
    s_add_u32 s8, s46, 155648
    v_mfma_f32_16x16x32_bf16 v[184:187], v[52:55], v[100:103], v[184:187]
    s_lshl_b32 s44, s43, 1
    v_mfma_f32_16x16x32_bf16 v[184:187], v[56:59], v[96:99], v[184:187]
    ds_read2_b32 v[128:129], v4 offset0:160 offset1:161
    s_mov_b32 m0, s58
    s_nop 0
    global_load_lds_dwordx4 v228, s[32:33] offset:0 sc1
    v_mfma_f32_16x16x32_bf16 v[184:187], v[60:63], v[92:95], v[184:187]
    ds_read2_b32 v[130:131], v4 offset0:162 offset1:163
    s_add_u32 s42, s44, s42
    v_mfma_f32_16x16x32_bf16 v[184:187], v[64:67], v[88:91], v[184:187]
    ds_read_b128 v[144:147], v6 offset:160
    s_lshl_b32 s44, s42, 8
    v_mfma_f32_16x16x32_bf16 v[184:187], v[68:71], v[84:87], v[184:187]
    ds_read_b128 v[164:167], v6 offset:2720
    s_lshl_b32 s45, s34, 4
    s_waitcnt lgkmcnt(15)
    v_mfma_f32_16x16x32_bf16 v[184:187], v[72:75], v[80:83], v[184:187]
    ds_read2_b32 v[132:133], v4 offset0:32 offset1:33
    global_load_lds_dwordx4 v228, s[32:33] offset:1024 sc1
    s_add_u32 s44, s44, s45
    s_waitcnt lgkmcnt(15)
    v_mfma_f32_16x16x32_bf16 v[188:191], v[48:51], v[108:111], v[188:191]
    ds_read2_b32 v[134:135], v4 offset0:34 offset1:35
    s_add_u32 s9, s44, 155648
    v_mfma_f32_16x16x32_bf16 v[188:191], v[52:55], v[104:107], v[188:191]
    ds_read_b128 v[168:171], v6 offset:3232
    s_and_b32 s45, s34, 1
    v_mfma_f32_16x16x32_bf16 v[188:191], v[56:59], v[100:103], v[188:191]
    ds_read2_b32 v[136:137], v5 offset0:160 offset1:161
    global_load_lds_dwordx4 v228, s[32:33] offset:2048 sc1
    v_mfma_f32_16x16x32_bf16 v[188:191], v[60:63], v[96:99], v[188:191]
    ds_read2_b32 v[138:139], v5 offset0:162 offset1:163
    s_lshl_b32 s44, s42, 1
    v_mfma_f32_16x16x32_bf16 v[188:191], v[64:67], v[92:95], v[188:191]
    ds_read_b128 v[172:175], v6 offset:3744
    s_add_u32 s44, s44, s45
    v_mfma_f32_16x16x32_bf16 v[188:191], v[68:71], v[88:91], v[188:191]
    ds_read2_b32 v[140:141], v5 offset0:32 offset1:33
    s_xor_b32 s46, s44, 1
    v_mfma_f32_16x16x32_bf16 v[188:191], v[72:75], v[84:87], v[188:191]
    ds_read2_b32 v[142:143], v5 offset0:34 offset1:35
    global_load_lds_dwordx4 v228, s[32:33] offset:3072 sc1
    s_add_u32 s58, s58, 16384
    v_add_u32 v228, 16384, v228
    s_waitcnt lgkmcnt(15)
    v_mfma_f32_16x16x32_bf16 v[188:191], v[76:79], v[80:83], v[188:191]
    s_mul_i32 s44, s44, 57472
    s_mul_i32 s45, s34, 12288
    s_waitcnt lgkmcnt(15)
    v_mfma_f32_16x16x32_bf16 v[176:179], v[112:115], v[160:163], v[176:179]
    ds_read2_b32 v[48:49], v2 offset0:144 offset1:145
    s_waitcnt lgkmcnt(15)
    v_mfma_f32_16x16x32_bf16 v[176:179], v[116:119], v[156:159], v[176:179]
    ds_read2_b32 v[50:51], v2 offset0:146 offset1:147
    s_mov_b32 m0, s58
    s_nop 0
    global_load_lds_dwordx4 v228, s[32:33] offset:0 sc1
    s_waitcnt lgkmcnt(15)
    v_mfma_f32_16x16x32_bf16 v[176:179], v[120:123], v[152:155], v[176:179]
    ds_read_b128 v[96:99], v6 offset:2144
    global_load_dwordx2 v[208:209], v11, s[32:33] sc1
    s_waitcnt lgkmcnt(15)
    v_mfma_f32_16x16x32_bf16 v[176:179], v[124:127], v[148:151], v[176:179]
    ds_read2_b32 v[52:53], v2 offset0:16 offset1:17
    s_waitcnt lgkmcnt(13)
    v_mfma_f32_16x16x32_bf16 v[176:179], v[128:131], v[144:147], v[176:179]
    ds_read2_b32 v[54:55], v2 offset0:18 offset1:19
    s_waitcnt lgkmcnt(13)
    v_mfma_f32_16x16x32_bf16 v[180:183], v[112:115], v[164:167], v[180:183]
    ds_read_b128 v[92:95], v6 offset:1632
    s_add_u32 s45, s45, s44
    v_mfma_f32_16x16x32_bf16 v[180:183], v[116:119], v[160:163], v[180:183]
    ds_read2_b32 v[56:57], v3 offset0:144 offset1:145
    s_add_u32 s10, s45, 10611712
    v_mfma_f32_16x16x32_bf16 v[180:183], v[120:123], v[156:159], v[180:183]
    ds_read2_b32 v[58:59], v3 offset0:146 offset1:147
    global_load_lds_dwordx4 v228, s[32:33] offset:1024 sc1
    v_mfma_f32_16x16x32_bf16 v[180:183], v[124:127], v[152:155], v[180:183]
    ds_read_b128 v[88:91], v6 offset:1120
    v_mfma_f32_16x16x32_bf16 v[180:183], v[128:131], v[148:151], v[180:183]
    ds_read2_b32 v[60:61], v3 offset0:16 offset1:17
    s_lshl_b32 s45, s34, 11
    s_waitcnt lgkmcnt(15)
    v_mfma_f32_16x16x32_bf16 v[180:183], v[132:135], v[144:147], v[180:183]
    ds_read2_b32 v[62:63], v3 offset0:18 offset1:19
    s_add_u32 s45, s45, s44
    s_waitcnt lgkmcnt(15)
    v_mfma_f32_16x16x32_bf16 v[184:187], v[112:115], v[168:171], v[184:187]
    ds_read_b128 v[84:87], v6 offset:608
    global_load_lds_dwordx4 v228, s[32:33] offset:2048 sc1
    v_mfma_f32_16x16x32_bf16 v[184:187], v[116:119], v[164:167], v[184:187]
    s_add_u32 s12, s45, 10656768
    v_mfma_f32_16x16x32_bf16 v[184:187], v[120:123], v[160:163], v[184:187]
    ds_read2_b32 v[64:65], v4 offset0:144 offset1:145
    v_mfma_f32_16x16x32_bf16 v[184:187], v[124:127], v[156:159], v[184:187]
    ds_read2_b32 v[66:67], v4 offset0:146 offset1:147
    s_mul_i32 s46, s46, 57472
    v_mfma_f32_16x16x32_bf16 v[184:187], v[128:131], v[152:155], v[184:187]
    ds_read_b128 v[80:83], v6 offset:96
    global_load_lds_dwordx4 v228, s[32:33] offset:3072 sc1
    s_add_u32 s58, s58, 16384
    v_add_u32 v228, 16384, v228
    v_mfma_f32_16x16x32_bf16 v[184:187], v[132:135], v[148:151], v[184:187]
    ds_read_b128 v[100:103], v6 offset:2656
    s_mul_i32 s45, s34, 12288
    s_waitcnt lgkmcnt(15)
    v_mfma_f32_16x16x32_bf16 v[184:187], v[136:139], v[144:147], v[184:187]
    ds_read2_b32 v[68:69], v4 offset0:16 offset1:17
    s_waitcnt lgkmcnt(15)
    v_mfma_f32_16x16x32_bf16 v[188:191], v[112:115], v[172:175], v[188:191]
    ds_read2_b32 v[70:71], v4 offset0:18 offset1:19
    s_add_u32 s45, s45, s46
    v_mfma_f32_16x16x32_bf16 v[188:191], v[116:119], v[168:171], v[188:191]
    ds_read_b128 v[104:107], v6 offset:3168
    s_mov_b32 m0, s58
    s_nop 0
    global_load_lds_dwordx4 v228, s[32:33] offset:0 sc1
    v_mfma_f32_16x16x32_bf16 v[188:191], v[120:123], v[164:167], v[188:191]
    ds_read2_b32 v[72:73], v5 offset0:144 offset1:145
    s_add_u32 s11, s45, 10611712
    v_mfma_f32_16x16x32_bf16 v[188:191], v[124:127], v[160:163], v[188:191]
    ds_read2_b32 v[74:75], v5 offset0:146 offset1:147
    v_mfma_f32_16x16x32_bf16 v[188:191], v[128:131], v[156:159], v[188:191]
    ds_read_b128 v[108:111], v6 offset:3680
    s_lshl_b32 s45, s34, 11
    v_mfma_f32_16x16x32_bf16 v[188:191], v[132:135], v[152:155], v[188:191]
    ds_read2_b32 v[76:77], v5 offset0:16 offset1:17
    global_load_lds_dwordx4 v228, s[32:33] offset:1024 sc1
    v_mfma_f32_16x16x32_bf16 v[188:191], v[136:139], v[148:151], v[188:191]
    ds_read2_b32 v[78:79], v5 offset0:18 offset1:19
    s_add_u32 s45, s45, s46
    s_waitcnt lgkmcnt(15)
    v_mfma_f32_16x16x32_bf16 v[188:191], v[140:143], v[144:147], v[188:191]
    s_add_u32 s13, s45, 10656768
    s_waitcnt lgkmcnt(15)
    v_mfma_f32_16x16x32_bf16 v[176:179], v[48:51], v[96:99], v[176:179]
    ds_read2_b32 v[112:113], v2 offset0:128 offset1:129
    s_waitcnt lgkmcnt(15)
    v_mfma_f32_16x16x32_bf16 v[176:179], v[52:55], v[92:95], v[176:179]
    ds_read2_b32 v[114:115], v2 offset0:130 offset1:131
    s_waitcnt lgkmcnt(15)
    v_mfma_f32_16x16x32_bf16 v[176:179], v[56:59], v[88:91], v[176:179]
    ds_read_b128 v[160:163], v6 offset:2080
    s_waitcnt lgkmcnt(15)
    v_mfma_f32_16x16x32_bf16 v[176:179], v[60:63], v[84:87], v[176:179]
    ds_read2_b32 v[116:117], v2 offset0:0 offset1:1
    s_waitcnt lgkmcnt(13)
    v_mfma_f32_16x16x32_bf16 v[176:179], v[64:67], v[80:83], v[176:179]
    ds_read2_b32 v[118:119], v2 offset0:2 offset1:3
    global_load_lds_dwordx4 v228, s[32:33] offset:2048 sc1
    s_waitcnt lgkmcnt(13)
    v_mfma_f32_16x16x32_bf16 v[180:183], v[48:51], v[100:103], v[180:183]
    ds_read_b128 v[156:159], v6 offset:1568
    v_mfma_f32_16x16x32_bf16 v[180:183], v[52:55], v[96:99], v[180:183]
    ds_read2_b32 v[120:121], v3 offset0:128 offset1:129
    v_mfma_f32_16x16x32_bf16 v[180:183], v[56:59], v[92:95], v[180:183]
    ds_read2_b32 v[122:123], v3 offset0:130 offset1:131
    v_mfma_f32_16x16x32_bf16 v[180:183], v[60:63], v[88:91], v[180:183]
    ds_read_b128 v[152:155], v6 offset:1056
    global_load_lds_dwordx4 v228, s[32:33] offset:3072 sc1
    s_add_u32 s58, s58, 16384
    v_add_u32 v228, 16384, v228
    v_mfma_f32_16x16x32_bf16 v[180:183], v[64:67], v[84:87], v[180:183]
    ds_read2_b32 v[124:125], v3 offset0:0 offset1:1
    s_waitcnt lgkmcnt(15)
    v_mfma_f32_16x16x32_bf16 v[180:183], v[68:71], v[80:83], v[180:183]
    ds_read2_b32 v[126:127], v3 offset0:2 offset1:3
    s_waitcnt lgkmcnt(15)
    v_mfma_f32_16x16x32_bf16 v[184:187], v[48:51], v[104:107], v[184:187]
    ds_read_b128 v[148:151], v6 offset:544
    v_mfma_f32_16x16x32_bf16 v[184:187], v[52:55], v[100:103], v[184:187]
    s_mov_b32 m0, s58
    s_nop 0
    global_load_lds_dwordx4 v228, s[32:33] offset:0 sc1
    v_mfma_f32_16x16x32_bf16 v[184:187], v[56:59], v[96:99], v[184:187]
    ds_read2_b32 v[128:129], v4 offset0:128 offset1:129
    v_mfma_f32_16x16x32_bf16 v[184:187], v[60:63], v[92:95], v[184:187]
    ds_read2_b32 v[130:131], v4 offset0:130 offset1:131
    v_mfma_f32_16x16x32_bf16 v[184:187], v[64:67], v[88:91], v[184:187]
    ds_read_b128 v[144:147], v6 offset:32
    v_mfma_f32_16x16x32_bf16 v[184:187], v[68:71], v[84:87], v[184:187]
    ds_read_b128 v[164:167], v6 offset:2592
    s_waitcnt lgkmcnt(15)
    v_mfma_f32_16x16x32_bf16 v[184:187], v[72:75], v[80:83], v[184:187]
    ds_read2_b32 v[132:133], v4 offset0:0 offset1:1
    global_load_lds_dwordx4 v228, s[32:33] offset:1024 sc1
    s_waitcnt lgkmcnt(15)
    v_mfma_f32_16x16x32_bf16 v[188:191], v[48:51], v[108:111], v[188:191]
    ds_read2_b32 v[134:135], v4 offset0:2 offset1:3
    v_mfma_f32_16x16x32_bf16 v[188:191], v[52:55], v[104:107], v[188:191]
    ds_read_b128 v[168:171], v6 offset:3104
    v_mfma_f32_16x16x32_bf16 v[188:191], v[56:59], v[100:103], v[188:191]
    ds_read2_b32 v[136:137], v5 offset0:128 offset1:129
    v_mfma_f32_16x16x32_bf16 v[188:191], v[60:63], v[96:99], v[188:191]
    ds_read2_b32 v[138:139], v5 offset0:130 offset1:131
    global_load_lds_dwordx4 v228, s[32:33] offset:2048 sc1
    v_mfma_f32_16x16x32_bf16 v[188:191], v[64:67], v[92:95], v[188:191]
    ds_read_b128 v[172:175], v6 offset:3616
    v_mfma_f32_16x16x32_bf16 v[188:191], v[68:71], v[88:91], v[188:191]
    ds_read2_b32 v[140:141], v5 offset0:0 offset1:1
    v_mfma_f32_16x16x32_bf16 v[188:191], v[72:75], v[84:87], v[188:191]
    ds_read2_b32 v[142:143], v5 offset0:2 offset1:3
    s_waitcnt lgkmcnt(15)
    v_mfma_f32_16x16x32_bf16 v[188:191], v[76:79], v[80:83], v[188:191]
    global_load_lds_dwordx4 v228, s[32:33] offset:3072 sc1
    s_add_u32 s58, s58, 16384
    v_add_u32 v228, 16384, v228
    s_waitcnt lgkmcnt(15)
    v_mfma_f32_16x16x32_bf16 v[176:179], v[112:115], v[160:163], v[176:179]
    s_waitcnt vmcnt(11)
    v_xor_b32 v12, s37, v197
    v_bitop3_b32 v12, v12, v199, s37 bitop3:0xf6
    v_bitop3_b32 v12, v12, v201, s37 bitop3:0xf6
    v_bitop3_b32 v12, v12, v203, s37 bitop3:0xf6
    v_bitop3_b32 v12, v12, v205, s37 bitop3:0xf6
    v_bitop3_b32 v12, v12, v207, s37 bitop3:0xf6
    v_bitop3_b32 v12, v12, v209, s37 bitop3:0xf6
    v_cmp_ne_u32 vcc, 0, v12
    s_nop 1
    s_cbranch_vccnz L_small_retry_22
L_small_back_23:
    s_waitcnt lgkmcnt(15)
    v_mfma_f32_16x16x32_bf16 v[176:179], v[116:119], v[156:159], v[176:179]
    global_load_dwordx4 a[140:143], v230, s[32:33] offset:-1024 sc1
    s_waitcnt lgkmcnt(15)
    v_mfma_f32_16x16x32_bf16 v[176:179], v[120:123], v[152:155], v[176:179]
    global_load_dwordx4 a[144:147], v230, s[32:33] offset:0 sc1
    s_waitcnt lgkmcnt(12)
    v_mfma_f32_16x16x32_bf16 v[176:179], v[124:127], v[148:151], v[176:179]
    v_add_f32_dpp v206, v206, v206 quad_perm:[1,0,3,2] row_mask:0xf bank_mask:0xf
    s_waitcnt lgkmcnt(9)
    v_mfma_f32_16x16x32_bf16 v[176:179], v[128:131], v[144:147], v[176:179]
    v_add_f32_dpp v208, v208, v208 quad_perm:[1,0,3,2] row_mask:0xf bank_mask:0xf
    s_waitcnt lgkmcnt(8)
    v_mfma_f32_16x16x32_bf16 v[180:183], v[112:115], v[164:167], v[180:183]
    v_add_f32_dpp v206, v206, v206 quad_perm:[2,3,0,1] row_mask:0xf bank_mask:0xf
    v_mfma_f32_16x16x32_bf16 v[180:183], v[116:119], v[160:163], v[180:183]
    v_add_f32_dpp v208, v208, v208 quad_perm:[2,3,0,1] row_mask:0xf bank_mask:0xf
    v_mfma_f32_16x16x32_bf16 v[180:183], v[120:123], v[156:159], v[180:183]
    v_add_f32_e64 v196, v196, v198
    v_mfma_f32_16x16x32_bf16 v[180:183], v[124:127], v[152:155], v[180:183]
    v_add_f32_e64 v200, v200, v202
    v_mfma_f32_16x16x32_bf16 v[180:183], v[128:131], v[148:151], v[180:183]
    v_add_f32 v196, v196, v204
    s_waitcnt lgkmcnt(6)
    v_mfma_f32_16x16x32_bf16 v[180:183], v[132:135], v[144:147], v[180:183]
    v_add_f32 v196, v196, v200
    s_waitcnt lgkmcnt(5)
    v_mfma_f32_16x16x32_bf16 v[184:187], v[112:115], v[168:171], v[184:187]
    v_cvt_pk_bf16_f32 v206, v206, v208
    v_mfma_f32_16x16x32_bf16 v[184:187], v[116:119], v[164:167], v[184:187]
    v_and_b32 v208, 0xffff0000, v206
    v_lshlrev_b32_e64 v206, 16, v206
    v_mfma_f32_16x16x32_bf16 v[184:187], v[120:123], v[160:163], v[184:187]
    v_mul_f32 v208, 0xbf317218, v208
    v_mfma_f32_16x16x32_bf16 v[184:187], v[124:127], v[156:159], v[184:187]
    v_mul_f32 v206, 0xbf317218, v206
    v_mfma_f32_16x16x32_bf16 v[184:187], v[128:131], v[152:155], v[184:187]
    v_mul_f32 v196, 0xbfb8aa3b, v196
    v_mfma_f32_16x16x32_bf16 v[184:187], v[132:135], v[148:151], v[184:187]
    v_and_b32 v12, 0xfc, v0
    s_waitcnt lgkmcnt(3)
    v_mfma_f32_16x16x32_bf16 v[184:187], v[136:139], v[144:147], v[184:187]
    v_add_u32 v12, 163520, v12
    s_waitcnt lgkmcnt(2)
    v_mfma_f32_16x16x32_bf16 v[188:191], v[112:115], v[172:175], v[188:191]
    v_add_u32 v13, 256, v12
    v_mfma_f32_16x16x32_bf16 v[188:191], v[116:119], v[168:171], v[188:191]
    v_min_u32 v13, 163836, v13
    v_mfma_f32_16x16x32_bf16 v[188:191], v[120:123], v[164:167], v[188:191]
    v_min_u32 v14, 223, v0
    v_mfma_f32_16x16x32_bf16 v[188:191], v[124:127], v[160:163], v[188:191]
    v_lshlrev_b32_e64 v14, 2, v14
    v_mfma_f32_16x16x32_bf16 v[188:191], v[128:131], v[156:159], v[188:191]
    v_add_u32 v14, 162624, v14
    v_mfma_f32_16x16x32_bf16 v[188:191], v[132:135], v[152:155], v[188:191]
    ds_write_b32 v12, v206
    v_mfma_f32_16x16x32_bf16 v[188:191], v[136:139], v[148:151], v[188:191]
    ds_write_b32 v13, v208
    s_waitcnt lgkmcnt(2)
    v_mfma_f32_16x16x32_bf16 v[188:191], v[140:143], v[144:147], v[188:191]
    ds_write_b32 v14, v196
    global_load_dword v47, v46, s[32:33] sc1
    ds_write_b128 v7, v[176:179] offset:0
    ds_write_b128 v7, v[180:183] offset:1024
    ds_write_b128 v7, v[184:187] offset:2048
    s_nop 2
    ds_write_b128 v7, v[188:191] offset:3072
    s_waitcnt lgkmcnt(0)
    s_barrier
    ds_read_b64 v[12:13], v8 offset:0
    ds_read_b64 v[14:15], v8 offset:8320
    ds_read_b64 v[16:17], v8 offset:16640
    ds_read_b64 v[18:19], v8 offset:24960
    ds_read_b64 v[20:21], v8 offset:512
    ds_read_b64 v[22:23], v8 offset:8832
    ds_read_b64 v[24:25], v8 offset:17152
    ds_read_b64 v[26:27], v8 offset:25472
    s_waitcnt vmcnt(0)
    v_cmp_ne_u32 vcc, s60, v47
    s_nop 1
    s_mov_b64 s[54:55], vcc
    s_cmp_lg_u64 s[54:55], 0
    s_cbranch_scc1 L_late_24
    global_load_dwordx4 v[48:51], v192, s[32:33] sc1
    v_add_u32 v192, 132096, v192
    global_load_dwordx4 v[52:55], v192, s[32:33] sc1
    v_add_u32 v192, 132096, v192
    global_load_dwordx4 v[56:59], v192, s[32:33] sc1
    v_add_u32 v192, 132096, v192
    global_load_dwordx4 v[60:63], v192, s[32:33] sc1
    v_add_u32 v192, 132096, v192
    global_load_dwordx4 v[64:67], v192, s[32:33] sc1
    v_add_u32 v192, 132096, v192
    global_load_dwordx4 v[68:71], v192, s[32:33] sc1
    v_add_u32 v192, 132096, v192
    global_load_dwordx4 v[72:75], v192, s[32:33] sc1
    v_add_u32 v192, 132096, v192
    global_load_dwordx4 v[76:79], v192, s[32:33] sc1
    v_add_u32 v192, 132096, v192
L_late_24:
    s_waitcnt lgkmcnt(4)
    s_nop 0
    v_pk_fma_f32 v[12:13], v[12:13], s[72:73], v[212:213] op_sel_hi:[1,0,1]
    v_pk_fma_f32 v[14:15], v[14:15], s[74:75], v[214:215] op_sel_hi:[1,0,1]
    v_pk_fma_f32 v[16:17], v[16:17], s[76:77], v[216:217] op_sel_hi:[1,0,1]
    v_pk_fma_f32 v[18:19], v[18:19], s[78:79], v[218:219] op_sel_hi:[1,0,1]
    v_cvt_pk_bf16_f32 v28, v12, v14
    v_cvt_pk_bf16_f32 v29, v16, v18
    v_cvt_pk_bf16_f32 v30, v13, v15
    v_cvt_pk_bf16_f32 v31, v17, v19
    global_store_dwordx4 v9, v[28:31], s[32:33] offset:0 sc1
    s_waitcnt lgkmcnt(0)
    s_nop 0
    v_pk_fma_f32 v[20:21], v[20:21], s[72:73], v[220:221] op_sel_hi:[1,0,1]
    v_pk_fma_f32 v[22:23], v[22:23], s[74:75], v[222:223] op_sel_hi:[1,0,1]
    v_pk_fma_f32 v[24:25], v[24:25], s[76:77], v[224:225] op_sel_hi:[1,0,1]
    v_pk_fma_f32 v[26:27], v[26:27], s[78:79], v[226:227] op_sel_hi:[1,0,1]
    v_cvt_pk_bf16_f32 v32, v20, v22
    v_cvt_pk_bf16_f32 v33, v24, v26
    v_cvt_pk_bf16_f32 v34, v21, v23
    v_cvt_pk_bf16_f32 v35, v25, v27
    global_store_dwordx4 v9, v[32:35], s[32:33] offset:1024 sc1
    v_mov_b32 v45, v40
    v_mov_b32 v190, v42
    v_mov_b32 v191, 1
    s_mov_b32 s87, 0
    s_cmp_lg_u64 s[54:55], 0
    s_cbranch_scc1 L_L_g1_0_slow_25
L_L_g1_0_join_26:
    s_waitcnt vmcnt(9)
    s_barrier
    ds_read_b128 v[152:155], v193 offset:6144
    ds_read_b128 v[128:131], v193 offset:0
    ds_read_b128 v[132:135], v193 offset:1024
    ds_read_b128 v[136:139], v193 offset:2048
    ds_read_b128 v[140:143], v193 offset:3072
    ds_read_b128 v[144:147], v193 offset:4096
    ds_read_b128 v[148:151], v193 offset:5120
    s_waitcnt vmcnt(9)
    v_mov_b32 v188, v50
    v_mov_b32_e64 v189, v51
    v_mov_b32_dpp v50, v48 row_ror:8 row_mask:0xf bank_mask:0x3
    v_mov_b32_dpp v51, v49 row_ror:8 row_mask:0xf bank_mask:0x3
    v_mov_b32_dpp v48, v188 row_ror:8 row_mask:0xf bank_mask:0xc
    v_mov_b32_dpp v49, v189 row_ror:8 row_mask:0xf bank_mask:0xc
    s_nop 1
    v_mfma_f32_16x16x32_bf16 v[184:187], v[48:51], v[48:51], 0
    ds_read_b128 v[180:183], v193 offset:13312
    global_load_dwordx4 v[80:83], v192, s[32:33] sc1
    v_add_u32 v192, 132096, v192
    s_waitcnt vmcnt(9) lgkmcnt(5)
    v_mfma_f32_16x16x32_bf16 v[40:43], v[152:155], v[48:51], 0
    ds_read_b128 v[156:159], v193 offset:7168
    v_mov_b32_e64 v188, v54
    v_mfma_f32_16x16x32_bf16 v[16:19], v[128:131], v[48:51], 0
    ds_read_b128 v[160:163], v193 offset:8192
    v_mov_b32_e64 v189, v55
    v_mfma_f32_16x16x32_bf16 v[20:23], v[132:135], v[48:51], 0
    ds_read_b128 v[164:167], v193 offset:9216
    v_mov_b32_dpp v54, v52 row_ror:8 row_mask:0xf bank_mask:0x3
    s_waitcnt lgkmcnt(4)
    v_mfma_f32_16x16x32_bf16 v[24:27], v[136:139], v[48:51], 0
    ds_read_b128 v[168:171], v193 offset:10240
    v_mov_b32_dpp v55, v53 row_ror:8 row_mask:0xf bank_mask:0x3
    s_mov_b32 m0, s58
    s_nop 0
    global_load_lds_dwordx4 v228, s[32:33] offset:0 sc1
    v_mfma_f32_16x16x32_bf16 v[28:31], v[140:143], v[48:51], 0
    ds_read_b128 v[172:175], v193 offset:11264
    v_mov_b32_dpp v52, v188 row_ror:8 row_mask:0xf bank_mask:0xc
    global_load_lds_dwordx4 v228, s[32:33] offset:1024 sc1
    v_mfma_f32_16x16x32_bf16 v[32:35], v[144:147], v[48:51], 0
    ds_read_b128 v[176:179], v193 offset:12288
    v_mov_b32_dpp v53, v189 row_ror:8 row_mask:0xf bank_mask:0xc
    v_lshrrev_b32 v13, 4, v1
    v_mfma_f32_16x16x32_bf16 v[36:39], v[148:151], v[48:51], 0
    v_lshlrev_b32_e64 v3, 4, v13
    v_mfma_f32_16x16x32_bf16 v[184:187], v[52:55], v[52:55], v[184:187]
    ds_read_b128 v[152:155], v193 offset:20480
    global_load_dwordx4 v[84:87], v192, s[32:33] sc1
    v_add_u32 v192, 132096, v192
    s_waitcnt vmcnt(11) lgkmcnt(5)
    v_mfma_f32_16x16x32_bf16 v[40:43], v[180:183], v[52:55], v[40:43]
    ds_read_b128 v[128:131], v193 offset:14336
    v_mov_b32 v188, v58
    v_mfma_f32_16x16x32_bf16 v[16:19], v[156:159], v[52:55], v[16:19]
    ds_read_b128 v[132:135], v193 offset:15360
    v_mov_b32_e64 v189, v59
    v_mfma_f32_16x16x32_bf16 v[20:23], v[160:163], v[52:55], v[20:23]
    ds_read_b128 v[136:139], v193 offset:16384
    v_mov_b32_dpp v58, v56 row_ror:8 row_mask:0xf bank_mask:0x3
    s_waitcnt lgkmcnt(4)
    v_mfma_f32_16x16x32_bf16 v[24:27], v[164:167], v[52:55], v[24:27]
    ds_read_b128 v[140:143], v193 offset:17408
    v_mov_b32_dpp v59, v57 row_ror:8 row_mask:0xf bank_mask:0x3
    global_load_lds_dwordx4 v228, s[32:33] offset:2048 sc1
    v_mfma_f32_16x16x32_bf16 v[28:31], v[168:171], v[52:55], v[28:31]
    ds_read_b128 v[144:147], v193 offset:18432
    v_mov_b32_dpp v56, v188 row_ror:8 row_mask:0xf bank_mask:0xc
    global_load_lds_dwordx4 v228, s[32:33] offset:3072 sc1
    s_add_u32 s58, s58, 16384
    v_add_u32 v228, 16384, v228
    v_mfma_f32_16x16x32_bf16 v[32:35], v[172:175], v[52:55], v[32:35]
    ds_read_b128 v[148:151], v193 offset:19456
    v_mov_b32_dpp v57, v189 row_ror:8 row_mask:0xf bank_mask:0xc
    v_add_u32 v3, 162624, v3
    v_mfma_f32_16x16x32_bf16 v[36:39], v[176:179], v[52:55], v[36:39]
    v_and_b32 v12, 15, v1
    v_mfma_f32_16x16x32_bf16 v[184:187], v[56:59], v[56:59], v[184:187]
    ds_read_b128 v[180:183], v193 offset:27648
    global_load_dwordx4 v[88:91], v192, s[32:33] sc1
    v_add_u32 v192, 132096, v192
    s_waitcnt vmcnt(13) lgkmcnt(5)
    v_mfma_f32_16x16x32_bf16 v[40:43], v[152:155], v[56:59], v[40:43]
    ds_read_b128 v[156:159], v193 offset:21504
    v_mov_b32 v188, v62
    v_mfma_f32_16x16x32_bf16 v[16:19], v[128:131], v[56:59], v[16:19]
    ds_read_b128 v[160:163], v193 offset:22528
    v_mov_b32_e64 v189, v63
    v_mfma_f32_16x16x32_bf16 v[20:23], v[132:135], v[56:59], v[20:23]
    ds_read_b128 v[164:167], v193 offset:23552
    v_mov_b32_dpp v62, v60 row_ror:8 row_mask:0xf bank_mask:0x3
    s_waitcnt lgkmcnt(4)
    v_mfma_f32_16x16x32_bf16 v[24:27], v[136:139], v[56:59], v[24:27]
    ds_read_b128 v[168:171], v193 offset:24576
    v_mov_b32_dpp v63, v61 row_ror:8 row_mask:0xf bank_mask:0x3
    s_mov_b32 m0, s58
    s_nop 0
    global_load_lds_dwordx4 v228, s[32:33] offset:0 sc1
    v_mfma_f32_16x16x32_bf16 v[28:31], v[140:143], v[56:59], v[28:31]
    ds_read_b128 v[172:175], v193 offset:25600
    v_mov_b32_dpp v60, v188 row_ror:8 row_mask:0xf bank_mask:0xc
    global_load_lds_dwordx4 v228, s[32:33] offset:1024 sc1
    v_mfma_f32_16x16x32_bf16 v[32:35], v[144:147], v[56:59], v[32:35]
    ds_read_b128 v[176:179], v193 offset:26624
    v_mov_b32_dpp v61, v189 row_ror:8 row_mask:0xf bank_mask:0xc
    v_and_b32 v2, 3, v1
    v_mfma_f32_16x16x32_bf16 v[36:39], v[148:151], v[56:59], v[36:39]
    v_cmp_eq_u32_e64 s[88:89], 1, v2
    v_mfma_f32_16x16x32_bf16 v[184:187], v[60:63], v[60:63], v[184:187]
    ds_read_b128 v[152:155], v193 offset:34816
    global_load_dwordx4 v[92:95], v192, s[32:33] sc1
    v_add_u32 v192, 132096, v192
    s_waitcnt vmcnt(15) lgkmcnt(5)
    v_mfma_f32_16x16x32_bf16 v[40:43], v[180:183], v[60:63], v[40:43]
    ds_read_b128 v[128:131], v193 offset:28672
    v_mov_b32 v188, v66
    v_mfma_f32_16x16x32_bf16 v[16:19], v[156:159], v[60:63], v[16:19]
    ds_read_b128 v[132:135], v193 offset:29696
    v_mov_b32_e64 v189, v67
    v_mfma_f32_16x16x32_bf16 v[20:23], v[160:163], v[60:63], v[20:23]
    ds_read_b128 v[136:139], v193 offset:30720
    v_mov_b32_dpp v66, v64 row_ror:8 row_mask:0xf bank_mask:0x3
    global_load_lds_dwordx4 v228, s[32:33] offset:2048 sc1
    s_waitcnt lgkmcnt(4)
    v_mfma_f32_16x16x32_bf16 v[24:27], v[164:167], v[60:63], v[24:27]
    ds_read_b128 v[140:143], v193 offset:31744
    v_mov_b32_dpp v67, v65 row_ror:8 row_mask:0xf bank_mask:0x3
    global_load_lds_dwordx4 v228, s[32:33] offset:3072 sc1
    s_add_u32 s58, s58, 16384
    v_add_u32 v228, 16384, v228
    v_mfma_f32_16x16x32_bf16 v[28:31], v[168:171], v[60:63], v[28:31]
    ds_read_b128 v[144:147], v193 offset:32768
    v_mov_b32_dpp v64, v188 row_ror:8 row_mask:0xf bank_mask:0xc
    s_cmp_lg_u32 s87, 0
    s_cbranch_scc1 L_pubd_27
    s_waitcnt vmcnt(12)
    s_mov_b64 exec, 0xff
    global_atomic_add v190, v191, s[32:33] sc1
    s_mov_b64 exec, -1
    s_mov_b32 s87, 1
L_pubd_27:
    v_mfma_f32_16x16x32_bf16 v[32:35], v[172:175], v[60:63], v[32:35]
    ds_read_b128 v[148:151], v193 offset:33792
    v_mov_b32_dpp v65, v189 row_ror:8 row_mask:0xf bank_mask:0xc
    v_cmp_eq_u32_e64 s[90:91], 2, v2
    v_mfma_f32_16x16x32_bf16 v[36:39], v[176:179], v[60:63], v[36:39]
    v_cmp_eq_u32_e64 s[92:93], 3, v2
    v_mfma_f32_16x16x32_bf16 v[184:187], v[64:67], v[64:67], v[184:187]
    ds_read_b128 v[180:183], v193 offset:41984
    global_load_dwordx4 v[96:99], v192, s[32:33] sc1
    v_add_u32 v192, 132096, v192
    s_waitcnt vmcnt(17) lgkmcnt(5)
    v_mfma_f32_16x16x32_bf16 v[40:43], v[152:155], v[64:67], v[40:43]
    ds_read_b128 v[156:159], v193 offset:35840
    v_mov_b32 v188, v70
    v_mfma_f32_16x16x32_bf16 v[16:19], v[128:131], v[64:67], v[16:19]
    ds_read_b128 v[160:163], v193 offset:36864
    v_mov_b32_e64 v189, v71
    v_mfma_f32_16x16x32_bf16 v[20:23], v[132:135], v[64:67], v[20:23]
    ds_read_b128 v[164:167], v193 offset:37888
    v_mov_b32_dpp v70, v68 row_ror:8 row_mask:0xf bank_mask:0x3
    s_waitcnt lgkmcnt(4)
    v_mfma_f32_16x16x32_bf16 v[24:27], v[136:139], v[64:67], v[24:27]
    ds_read_b128 v[168:171], v193 offset:38912
    v_mov_b32_dpp v71, v69 row_ror:8 row_mask:0xf bank_mask:0x3
    s_cmp_eq_u32 s34, 3
    s_cselect_b32 s51, 4096, 0
    s_sub_u32 s58, s58, s51
    v_subrev_u32 v228, s51, v228
    s_mov_b32 m0, s58
    s_nop 0
    global_load_lds_dwordx4 v228, s[32:33] offset:0 sc1
    v_mfma_f32_16x16x32_bf16 v[28:31], v[140:143], v[64:67], v[28:31]
    ds_read_b128 v[172:175], v193 offset:39936
    v_mov_b32_dpp v68, v188 row_ror:8 row_mask:0xf bank_mask:0xc
    global_load_lds_dwordx4 v228, s[32:33] offset:1024 sc1
    v_mfma_f32_16x16x32_bf16 v[32:35], v[144:147], v[64:67], v[32:35]
    ds_read_b128 v[176:179], v193 offset:40960
    v_mov_b32_dpp v69, v189 row_ror:8 row_mask:0xf bank_mask:0xc
    v_lshrrev_b32_e64 v5, 2, v12
    v_mfma_f32_16x16x32_bf16 v[36:39], v[148:151], v[64:67], v[36:39]
    v_lshl_add_u32 v5, v5, 4, v12
    v_mfma_f32_16x16x32_bf16 v[184:187], v[68:71], v[68:71], v[184:187]
    ds_read_b128 v[152:155], v193 offset:49152
    global_load_dwordx4 v[100:103], v192, s[32:33] sc1
    v_add_u32 v192, 132096, v192
    s_waitcnt vmcnt(19) lgkmcnt(5)
    v_mfma_f32_16x16x32_bf16 v[40:43], v[180:183], v[68:71], v[40:43]
    ds_read_b128 v[128:131], v193 offset:43008
    v_mov_b32 v188, v74
    v_mfma_f32_16x16x32_bf16 v[16:19], v[156:159], v[68:71], v[16:19]
    ds_read_b128 v[132:135], v193 offset:44032
    v_mov_b32_e64 v189, v75
    v_mfma_f32_16x16x32_bf16 v[20:23], v[160:163], v[68:71], v[20:23]
    ds_read_b128 v[136:139], v193 offset:45056
    v_mov_b32_dpp v74, v72 row_ror:8 row_mask:0xf bank_mask:0x3
    global_load_lds_dwordx4 v228, s[32:33] offset:2048 sc1
    s_waitcnt lgkmcnt(4)
    v_mfma_f32_16x16x32_bf16 v[24:27], v[164:167], v[68:71], v[24:27]
    ds_read_b128 v[140:143], v193 offset:46080
    v_mov_b32_dpp v75, v73 row_ror:8 row_mask:0xf bank_mask:0x3
    global_load_lds_dwordx4 v228, s[32:33] offset:3072 sc1
    s_add_u32 s58, s58, 16384
    v_add_u32 v228, 16384, v228
    v_mfma_f32_16x16x32_bf16 v[28:31], v[168:171], v[68:71], v[28:31]
    ds_read_b128 v[144:147], v193 offset:47104
    v_mov_b32_dpp v72, v188 row_ror:8 row_mask:0xf bank_mask:0xc
    global_load_dword v44, v45, s[32:33] sc1
    v_mfma_f32_16x16x32_bf16 v[32:35], v[172:175], v[68:71], v[32:35]
    ds_read_b128 v[148:151], v193 offset:48128
    v_mov_b32_dpp v73, v189 row_ror:8 row_mask:0xf bank_mask:0xc
    v_lshlrev_b32 v5, 2, v5
    v_mfma_f32_16x16x32_bf16 v[36:39], v[176:179], v[68:71], v[36:39]
    v_lshlrev_b32_e64 v6, 2, v12
    v_mfma_f32_16x16x32_bf16 v[184:187], v[72:75], v[72:75], v[184:187]
    ds_read_b128 v[180:183], v193 offset:56320
    global_load_dwordx4 v[104:107], v192, s[32:33] sc1
    v_add_u32 v192, 132096, v192
    s_waitcnt vmcnt(22) lgkmcnt(5)
    v_mfma_f32_16x16x32_bf16 v[40:43], v[152:155], v[72:75], v[40:43]
    ds_read_b128 v[156:159], v193 offset:50176
    v_mov_b32 v188, v78
    v_mfma_f32_16x16x32_bf16 v[16:19], v[128:131], v[72:75], v[16:19]
    ds_read_b128 v[160:163], v193 offset:51200
    v_mov_b32_e64 v189, v79
    v_mfma_f32_16x16x32_bf16 v[20:23], v[132:135], v[72:75], v[20:23]
    ds_read_b128 v[164:167], v193 offset:52224
    v_mov_b32_dpp v78, v76 row_ror:8 row_mask:0xf bank_mask:0x3
    s_waitcnt lgkmcnt(4)
    v_mfma_f32_16x16x32_bf16 v[24:27], v[136:139], v[72:75], v[24:27]
    ds_read_b128 v[168:171], v193 offset:53248
    v_mov_b32_dpp v79, v77 row_ror:8 row_mask:0xf bank_mask:0x3
    v_mfma_f32_16x16x32_bf16 v[28:31], v[140:143], v[72:75], v[28:31]
    ds_read_b128 v[172:175], v193 offset:54272
    v_mov_b32_dpp v76, v188 row_ror:8 row_mask:0xf bank_mask:0xc
    v_mfma_f32_16x16x32_bf16 v[32:35], v[144:147], v[72:75], v[32:35]
    ds_read_b128 v[176:179], v193 offset:55296
    v_mov_b32_dpp v77, v189 row_ror:8 row_mask:0xf bank_mask:0xc
    v_add_u32 v6, 192, v6
    v_mfma_f32_16x16x32_bf16 v[36:39], v[148:151], v[72:75], v[36:39]
    v_lshl_add_u32 v14, v1, 4, s6
    v_mfma_f32_16x16x32_bf16 v[184:187], v[76:79], v[76:79], v[184:187]
    ds_read_b128 v[152:155], v193 offset:63488
    global_load_dwordx4 v[108:111], v192, s[32:33] sc1
    v_add_u32 v192, 132096, v192
    s_waitcnt vmcnt(20) lgkmcnt(5)
    v_mfma_f32_16x16x32_bf16 v[40:43], v[180:183], v[76:79], v[40:43]
    ds_read_b128 v[128:131], v193 offset:57344
    v_mov_b32_e64 v188, v82
    v_mfma_f32_16x16x32_bf16 v[16:19], v[156:159], v[76:79], v[16:19]
    ds_read_b128 v[132:135], v193 offset:58368
    v_mov_b32_e64 v189, v83
    v_mfma_f32_16x16x32_bf16 v[20:23], v[160:163], v[76:79], v[20:23]
    ds_read_b128 v[136:139], v193 offset:59392
    v_mov_b32_dpp v82, v80 row_ror:8 row_mask:0xf bank_mask:0x3
    s_waitcnt lgkmcnt(4)
    v_mfma_f32_16x16x32_bf16 v[24:27], v[164:167], v[76:79], v[24:27]
    ds_read_b128 v[140:143], v193 offset:60416
    v_mov_b32_dpp v83, v81 row_ror:8 row_mask:0xf bank_mask:0x3
    v_mfma_f32_16x16x32_bf16 v[28:31], v[168:171], v[76:79], v[28:31]
    ds_read_b128 v[144:147], v193 offset:61440
    v_mov_b32_dpp v80, v188 row_ror:8 row_mask:0xf bank_mask:0xc
    v_mfma_f32_16x16x32_bf16 v[32:35], v[172:175], v[76:79], v[32:35]
    ds_read_b128 v[148:151], v193 offset:62464
    v_mov_b32_dpp v81, v189 row_ror:8 row_mask:0xf bank_mask:0xc
    v_lshl_add_u32 v15, v1, 3, s7
    v_mfma_f32_16x16x32_bf16 v[36:39], v[176:179], v[76:79], v[36:39]
    v_mov_b32 v226, s8
    v_mfma_f32_16x16x32_bf16 v[184:187], v[80:83], v[80:83], v[184:187]
    ds_read_b128 v[180:183], v194 offset:6144
    global_load_dwordx4 v[112:115], v192, s[32:33] sc1
    v_add_u32 v192, 132096, v192
    s_waitcnt vmcnt(18) lgkmcnt(5)
    v_mfma_f32_16x16x32_bf16 v[40:43], v[152:155], v[80:83], v[40:43]
    ds_read_b128 v[156:159], v194 offset:0
    v_mov_b32 v188, v86
    v_mfma_f32_16x16x32_bf16 v[16:19], v[128:131], v[80:83], v[16:19]
    ds_read_b128 v[160:163], v194 offset:1024
    v_mov_b32_e64 v189, v87
    v_mfma_f32_16x16x32_bf16 v[20:23], v[132:135], v[80:83], v[20:23]
    ds_read_b128 v[164:167], v194 offset:2048
    v_mov_b32_dpp v86, v84 row_ror:8 row_mask:0xf bank_mask:0x3
    s_waitcnt lgkmcnt(4)
    v_mfma_f32_16x16x32_bf16 v[24:27], v[136:139], v[80:83], v[24:27]
    ds_read_b128 v[168:171], v194 offset:3072
    v_mov_b32_dpp v87, v85 row_ror:8 row_mask:0xf bank_mask:0x3
    v_mfma_f32_16x16x32_bf16 v[28:31], v[140:143], v[80:83], v[28:31]
    ds_read_b128 v[172:175], v194 offset:4096
    v_mov_b32_dpp v84, v188 row_ror:8 row_mask:0xf bank_mask:0xc
    v_mfma_f32_16x16x32_bf16 v[32:35], v[144:147], v[80:83], v[32:35]
    ds_read_b128 v[176:179], v194 offset:5120
    v_mov_b32_dpp v85, v189 row_ror:8 row_mask:0xf bank_mask:0xc
    v_mfma_f32_16x16x32_bf16 v[36:39], v[148:151], v[80:83], v[36:39]
    v_mov_b32 v227, s37
    v_mfma_f32_16x16x32_bf16 v[184:187], v[84:87], v[84:87], v[184:187]
    ds_read_b128 v[152:155], v194 offset:13312
    global_load_dwordx4 v[116:119], v192, s[32:33] sc1
    v_add_u32 v192, 132096, v192
    s_waitcnt vmcnt(16) lgkmcnt(5)
    v_mfma_f32_16x16x32_bf16 v[40:43], v[180:183], v[84:87], v[40:43]
    ds_read_b128 v[128:131], v194 offset:7168
    v_mov_b32 v188, v90
    v_mfma_f32_16x16x32_bf16 v[16:19], v[156:159], v[84:87], v[16:19]
    ds_read_b128 v[132:135], v194 offset:8192
    v_mov_b32_e64 v189, v91
    v_mfma_f32_16x16x32_bf16 v[20:23], v[160:163], v[84:87], v[20:23]
    ds_read_b128 v[136:139], v194 offset:9216
    v_mov_b32_dpp v90, v88 row_ror:8 row_mask:0xf bank_mask:0x3
    s_waitcnt lgkmcnt(4)
    v_mfma_f32_16x16x32_bf16 v[24:27], v[164:167], v[84:87], v[24:27]
    ds_read_b128 v[140:143], v194 offset:10240
    v_mov_b32_dpp v91, v89 row_ror:8 row_mask:0xf bank_mask:0x3
    v_mfma_f32_16x16x32_bf16 v[28:31], v[168:171], v[84:87], v[28:31]
    ds_read_b128 v[144:147], v194 offset:11264
    v_mov_b32_dpp v88, v188 row_ror:8 row_mask:0xf bank_mask:0xc
    v_mfma_f32_16x16x32_bf16 v[32:35], v[172:175], v[84:87], v[32:35]
    ds_read_b128 v[148:151], v194 offset:12288
    v_mov_b32_dpp v89, v189 row_ror:8 row_mask:0xf bank_mask:0xc
    v_mfma_f32_16x16x32_bf16 v[36:39], v[176:179], v[84:87], v[36:39]
    s_nop 0
    v_mfma_f32_16x16x32_bf16 v[184:187], v[88:91], v[88:91], v[184:187]
    ds_read_b128 v[180:183], v194 offset:20480
    global_load_dwordx4 v[120:123], v192, s[32:33] sc1
    v_add_u32 v192, 132096, v192
    s_waitcnt vmcnt(14) lgkmcnt(5)
    v_mfma_f32_16x16x32_bf16 v[40:43], v[152:155], v[88:91], v[40:43]
    ds_read_b128 v[156:159], v194 offset:14336
    v_mov_b32 v188, v94
    v_mfma_f32_16x16x32_bf16 v[16:19], v[128:131], v[88:91], v[16:19]
    ds_read_b128 v[160:163], v194 offset:15360
    v_mov_b32_e64 v189, v95
    v_mfma_f32_16x16x32_bf16 v[20:23], v[132:135], v[88:91], v[20:23]
    ds_read_b128 v[164:167], v194 offset:16384
    v_mov_b32_dpp v94, v92 row_ror:8 row_mask:0xf bank_mask:0x3
    s_waitcnt lgkmcnt(4)
    v_mfma_f32_16x16x32_bf16 v[24:27], v[136:139], v[88:91], v[24:27]
    ds_read_b128 v[168:171], v194 offset:17408
    v_mov_b32_dpp v95, v93 row_ror:8 row_mask:0xf bank_mask:0x3
    v_mfma_f32_16x16x32_bf16 v[28:31], v[140:143], v[88:91], v[28:31]
    ds_read_b128 v[172:175], v194 offset:18432
    v_mov_b32_dpp v92, v188 row_ror:8 row_mask:0xf bank_mask:0xc
    v_mfma_f32_16x16x32_bf16 v[32:35], v[144:147], v[88:91], v[32:35]
    ds_read_b128 v[176:179], v194 offset:19456
    v_mov_b32_dpp v93, v189 row_ror:8 row_mask:0xf bank_mask:0xc
    v_mfma_f32_16x16x32_bf16 v[36:39], v[148:151], v[88:91], v[36:39]
    s_nop 0
    v_mfma_f32_16x16x32_bf16 v[184:187], v[92:95], v[92:95], v[184:187]
    ds_read_b128 v[152:155], v194 offset:27648
    global_load_dwordx4 v[124:127], v192, s[32:33] sc1
    s_waitcnt vmcnt(12) lgkmcnt(5)
    v_mfma_f32_16x16x32_bf16 v[40:43], v[180:183], v[92:95], v[40:43]
    ds_read_b128 v[128:131], v194 offset:21504
    v_mov_b32 v188, v98
    v_mfma_f32_16x16x32_bf16 v[16:19], v[156:159], v[92:95], v[16:19]
    ds_read_b128 v[132:135], v194 offset:22528
    v_mov_b32_e64 v189, v99
    v_mfma_f32_16x16x32_bf16 v[20:23], v[160:163], v[92:95], v[20:23]
    ds_read_b128 v[136:139], v194 offset:23552
    v_mov_b32_dpp v98, v96 row_ror:8 row_mask:0xf bank_mask:0x3
    s_waitcnt lgkmcnt(4)
    v_mfma_f32_16x16x32_bf16 v[24:27], v[164:167], v[92:95], v[24:27]
    ds_read_b128 v[140:143], v194 offset:24576
    v_mov_b32_dpp v99, v97 row_ror:8 row_mask:0xf bank_mask:0x3
    v_mfma_f32_16x16x32_bf16 v[28:31], v[168:171], v[92:95], v[28:31]
    ds_read_b128 v[144:147], v194 offset:25600
    v_mov_b32_dpp v96, v188 row_ror:8 row_mask:0xf bank_mask:0xc
    v_mfma_f32_16x16x32_bf16 v[32:35], v[172:175], v[92:95], v[32:35]
    ds_read_b128 v[148:151], v194 offset:26624
    v_mov_b32_dpp v97, v189 row_ror:8 row_mask:0xf bank_mask:0xc
    v_mfma_f32_16x16x32_bf16 v[36:39], v[176:179], v[92:95], v[36:39]
    s_waitcnt vmcnt(6)
    v_cmp_ne_u32 vcc, s37, v44
    s_nop 1
    s_cbranch_vccnz L_fw2all_retry_28
L_fw2all_back_29:
    s_barrier
    v_mfma_f32_16x16x32_bf16 v[184:187], v[96:99], v[96:99], v[184:187]
    ds_read_b128 v[180:183], v194 offset:34816
    v_add_u32 v46, 0x8000, v46
    s_waitcnt vmcnt(9) lgkmcnt(5)
    v_mfma_f32_16x16x32_bf16 v[40:43], v[152:155], v[96:99], v[40:43]
    ds_read_b128 v[156:159], v194 offset:28672
    v_mov_b32 v188, v102
    v_mfma_f32_16x16x32_bf16 v[16:19], v[128:131], v[96:99], v[16:19]
    ds_read_b128 v[160:163], v194 offset:29696
    v_mov_b32_e64 v189, v103
    v_mfma_f32_16x16x32_bf16 v[20:23], v[132:135], v[96:99], v[20:23]
    ds_read_b128 v[164:167], v194 offset:30720
    v_mov_b32_dpp v102, v100 row_ror:8 row_mask:0xf bank_mask:0x3
    s_waitcnt lgkmcnt(4)
    v_mfma_f32_16x16x32_bf16 v[24:27], v[136:139], v[96:99], v[24:27]
    ds_read_b128 v[168:171], v194 offset:31744
    v_mov_b32_dpp v103, v101 row_ror:8 row_mask:0xf bank_mask:0x3
    v_mfma_f32_16x16x32_bf16 v[28:31], v[140:143], v[96:99], v[28:31]
    ds_read_b128 v[172:175], v194 offset:32768
    v_mov_b32_dpp v100, v188 row_ror:8 row_mask:0xf bank_mask:0xc
    v_subrev_u32 v192, 2501632, v192
    v_mfma_f32_16x16x32_bf16 v[32:35], v[144:147], v[96:99], v[32:35]
    ds_read_b128 v[176:179], v194 offset:33792
    v_mov_b32_dpp v101, v189 row_ror:8 row_mask:0xf bank_mask:0xc
    global_load_dwordx4 a[148:151], v230, s[32:33] offset:1024 sc1
    v_mfma_f32_16x16x32_bf16 v[36:39], v[148:151], v[96:99], v[36:39]
    global_load_dwordx4 a[152:155], v230, s[32:33] offset:2048 sc1
    v_mfma_f32_16x16x32_bf16 v[184:187], v[100:103], v[100:103], v[184:187]
    ds_read_b128 v[152:155], v194 offset:41984
    global_load_dwordx4 a[156:159], v230, s[32:33] offset:3072 sc1
    v_add_u32 v230, 8192, v230
    s_waitcnt vmcnt(8) lgkmcnt(5)
    v_mfma_f32_16x16x32_bf16 v[40:43], v[180:183], v[100:103], v[40:43]
    ds_read_b128 v[128:131], v194 offset:35840
    v_mov_b32_e64 v188, v106
    v_mfma_f32_16x16x32_bf16 v[16:19], v[156:159], v[100:103], v[16:19]
    ds_read_b128 v[132:135], v194 offset:36864
    v_mov_b32_e64 v189, v107
    v_mfma_f32_16x16x32_bf16 v[20:23], v[160:163], v[100:103], v[20:23]
    ds_read_b128 v[136:139], v194 offset:37888
    v_mov_b32_dpp v106, v104 row_ror:8 row_mask:0xf bank_mask:0x3
    s_waitcnt lgkmcnt(4)
    v_mfma_f32_16x16x32_bf16 v[24:27], v[164:167], v[100:103], v[24:27]
    ds_read_b128 v[140:143], v194 offset:38912
    v_mov_b32_dpp v107, v105 row_ror:8 row_mask:0xf bank_mask:0x3
    v_mfma_f32_16x16x32_bf16 v[28:31], v[168:171], v[100:103], v[28:31]
    ds_read_b128 v[144:147], v194 offset:39936
    v_mov_b32_dpp v104, v188 row_ror:8 row_mask:0xf bank_mask:0xc
    v_mfma_f32_16x16x32_bf16 v[32:35], v[172:175], v[100:103], v[32:35]
    ds_read_b128 v[148:151], v194 offset:40960
    v_mov_b32_dpp v105, v189 row_ror:8 row_mask:0xf bank_mask:0xc
    v_mfma_f32_16x16x32_bf16 v[36:39], v[176:179], v[100:103], v[36:39]
    global_load_dwordx4 a[160:163], v230, s[32:33] offset:-4096 sc1
    v_mfma_f32_16x16x32_bf16 v[184:187], v[104:107], v[104:107], v[184:187]
    ds_read_b128 v[180:183], v194 offset:49152
    global_load_dwordx4 a[164:167], v230, s[32:33] offset:-3072 sc1
    s_waitcnt vmcnt(9) lgkmcnt(5)
    v_mfma_f32_16x16x32_bf16 v[40:43], v[152:155], v[104:107], v[40:43]
    ds_read_b128 v[156:159], v194 offset:43008
    v_mov_b32_e64 v188, v110
    v_mfma_f32_16x16x32_bf16 v[16:19], v[128:131], v[104:107], v[16:19]
    ds_read_b128 v[160:163], v194 offset:44032
    v_mov_b32_e64 v189, v111
    v_mfma_f32_16x16x32_bf16 v[20:23], v[132:135], v[104:107], v[20:23]
    ds_read_b128 v[164:167], v194 offset:45056
    v_mov_b32_dpp v110, v108 row_ror:8 row_mask:0xf bank_mask:0x3
    s_waitcnt lgkmcnt(4)
    v_mfma_f32_16x16x32_bf16 v[24:27], v[136:139], v[104:107], v[24:27]
    ds_read_b128 v[168:171], v194 offset:46080
    v_mov_b32_dpp v111, v109 row_ror:8 row_mask:0xf bank_mask:0x3
    v_mfma_f32_16x16x32_bf16 v[28:31], v[140:143], v[104:107], v[28:31]
    ds_read_b128 v[172:175], v194 offset:47104
    v_mov_b32_dpp v108, v188 row_ror:8 row_mask:0xf bank_mask:0xc
    v_mfma_f32_16x16x32_bf16 v[32:35], v[144:147], v[104:107], v[32:35]
    ds_read_b128 v[176:179], v194 offset:48128
    v_mov_b32_dpp v109, v189 row_ror:8 row_mask:0xf bank_mask:0xc
    v_mfma_f32_16x16x32_bf16 v[36:39], v[148:151], v[104:107], v[36:39]
    global_load_dwordx4 a[168:171], v230, s[32:33] offset:-2048 sc1
    v_mfma_f32_16x16x32_bf16 v[184:187], v[108:111], v[108:111], v[184:187]
    ds_read_b128 v[152:155], v194 offset:56320
    global_load_dwordx4 a[172:175], v230, s[32:33] offset:-1024 sc1
    s_waitcnt vmcnt(10) lgkmcnt(5)
    v_mfma_f32_16x16x32_bf16 v[40:43], v[180:183], v[108:111], v[40:43]
    ds_read_b128 v[128:131], v194 offset:50176
    v_mov_b32_e64 v188, v114
    v_mfma_f32_16x16x32_bf16 v[16:19], v[156:159], v[108:111], v[16:19]
    ds_read_b128 v[132:135], v194 offset:51200
    v_mov_b32_e64 v189, v115
    v_mfma_f32_16x16x32_bf16 v[20:23], v[160:163], v[108:111], v[20:23]
    ds_read_b128 v[136:139], v194 offset:52224
    v_mov_b32_dpp v114, v112 row_ror:8 row_mask:0xf bank_mask:0x3
    s_waitcnt lgkmcnt(4)
    v_mfma_f32_16x16x32_bf16 v[24:27], v[164:167], v[108:111], v[24:27]
    ds_read_b128 v[140:143], v194 offset:53248
    v_mov_b32_dpp v115, v113 row_ror:8 row_mask:0xf bank_mask:0x3
    v_mfma_f32_16x16x32_bf16 v[28:31], v[168:171], v[108:111], v[28:31]
    ds_read_b128 v[144:147], v194 offset:54272
    v_mov_b32_dpp v112, v188 row_ror:8 row_mask:0xf bank_mask:0xc
    v_mfma_f32_16x16x32_bf16 v[32:35], v[172:175], v[108:111], v[32:35]
    ds_read_b128 v[148:151], v194 offset:55296
    v_mov_b32_dpp v113, v189 row_ror:8 row_mask:0xf bank_mask:0xc
    v_mfma_f32_16x16x32_bf16 v[36:39], v[176:179], v[108:111], v[36:39]
    global_load_dwordx4 a[176:179], v230, s[32:33] offset:0 sc1
    v_mfma_f32_16x16x32_bf16 v[184:187], v[112:115], v[112:115], v[184:187]
    ds_read_b128 v[180:183], v194 offset:63488
    global_load_dwordx4 a[180:183], v230, s[32:33] offset:1024 sc1
    s_waitcnt vmcnt(11) lgkmcnt(5)
    v_mfma_f32_16x16x32_bf16 v[40:43], v[152:155], v[112:115], v[40:43]
    ds_read_b128 v[156:159], v194 offset:57344
    v_mov_b32_e64 v188, v118
    v_mfma_f32_16x16x32_bf16 v[16:19], v[128:131], v[112:115], v[16:19]
    ds_read_b128 v[160:163], v194 offset:58368
    v_mov_b32_e64 v189, v119
    v_mfma_f32_16x16x32_bf16 v[20:23], v[132:135], v[112:115], v[20:23]
    ds_read_b128 v[164:167], v194 offset:59392
    v_mov_b32_dpp v118, v116 row_ror:8 row_mask:0xf bank_mask:0x3
    s_waitcnt lgkmcnt(4)
    v_mfma_f32_16x16x32_bf16 v[24:27], v[136:139], v[112:115], v[24:27]
    ds_read_b128 v[168:171], v194 offset:60416
    v_mov_b32_dpp v119, v117 row_ror:8 row_mask:0xf bank_mask:0x3
    v_mfma_f32_16x16x32_bf16 v[28:31], v[140:143], v[112:115], v[28:31]
    ds_read_b128 v[172:175], v194 offset:61440
    v_mov_b32_dpp v116, v188 row_ror:8 row_mask:0xf bank_mask:0xc
    v_mfma_f32_16x16x32_bf16 v[32:35], v[144:147], v[112:115], v[32:35]
    ds_read_b128 v[176:179], v194 offset:62464
    v_mov_b32_dpp v117, v189 row_ror:8 row_mask:0xf bank_mask:0xc
    v_mfma_f32_16x16x32_bf16 v[36:39], v[148:151], v[112:115], v[36:39]
    s_nop 0
    v_mfma_f32_16x16x32_bf16 v[184:187], v[116:119], v[116:119], v[184:187]
    ds_read_b128 v[152:155], v195 offset:6144
    global_load_dwordx4 a[184:187], v230, s[32:33] offset:2048 sc1
    s_waitcnt vmcnt(11) lgkmcnt(5)
    v_mfma_f32_16x16x32_bf16 v[40:43], v[180:183], v[116:119], v[40:43]
    ds_read_b128 v[128:131], v195 offset:0
    v_mov_b32 v188, v122
    v_mfma_f32_16x16x32_bf16 v[16:19], v[156:159], v[116:119], v[16:19]
    ds_read_b128 v[132:135], v195 offset:1024
    v_mov_b32_e64 v189, v123
    v_mfma_f32_16x16x32_bf16 v[20:23], v[160:163], v[116:119], v[20:23]
    ds_read_b128 v[136:139], v195 offset:2048
    v_mov_b32_dpp v122, v120 row_ror:8 row_mask:0xf bank_mask:0x3
    s_waitcnt lgkmcnt(4)
    v_mfma_f32_16x16x32_bf16 v[24:27], v[164:167], v[116:119], v[24:27]
    ds_read_b128 v[140:143], v195 offset:3072
    v_mov_b32_dpp v123, v121 row_ror:8 row_mask:0xf bank_mask:0x3
    v_mfma_f32_16x16x32_bf16 v[28:31], v[168:171], v[116:119], v[28:31]
    ds_read_b128 v[144:147], v195 offset:4096
    v_mov_b32_dpp v120, v188 row_ror:8 row_mask:0xf bank_mask:0xc
    v_mfma_f32_16x16x32_bf16 v[32:35], v[172:175], v[116:119], v[32:35]
    ds_read_b128 v[148:151], v195 offset:5120
    v_mov_b32_dpp v121, v189 row_ror:8 row_mask:0xf bank_mask:0xc
    v_mfma_f32_16x16x32_bf16 v[36:39], v[176:179], v[116:119], v[36:39]
    s_nop 0
    v_mfma_f32_16x16x32_bf16 v[184:187], v[120:123], v[120:123], v[184:187]
    ds_read_b128 v[180:183], v195 offset:13312
    global_load_dword v47, v46, s[32:33] sc1
    s_waitcnt vmcnt(11) lgkmcnt(5)
    v_mfma_f32_16x16x32_bf16 v[40:43], v[152:155], v[120:123], v[40:43]
    ds_read_b128 v[156:159], v195 offset:7168
    v_mov_b32 v188, v126
    v_mfma_f32_16x16x32_bf16 v[16:19], v[128:131], v[120:123], v[16:19]
    ds_read_b128 v[160:163], v195 offset:8192
    v_mov_b32_e64 v189, v127
    v_mfma_f32_16x16x32_bf16 v[20:23], v[132:135], v[120:123], v[20:23]
    ds_read_b128 v[164:167], v195 offset:9216
    v_mov_b32_dpp v126, v124 row_ror:8 row_mask:0xf bank_mask:0x3
    s_waitcnt lgkmcnt(4)
    v_mfma_f32_16x16x32_bf16 v[24:27], v[136:139], v[120:123], v[24:27]
    ds_read_b128 v[168:171], v195 offset:10240
    v_mov_b32_dpp v127, v125 row_ror:8 row_mask:0xf bank_mask:0x3
    v_mfma_f32_16x16x32_bf16 v[28:31], v[140:143], v[120:123], v[28:31]
    ds_read_b128 v[172:175], v195 offset:11264
    v_mov_b32_dpp v124, v188 row_ror:8 row_mask:0xf bank_mask:0xc
    v_mfma_f32_16x16x32_bf16 v[32:35], v[144:147], v[120:123], v[32:35]
    ds_read_b128 v[176:179], v195 offset:12288
    v_mov_b32_dpp v125, v189 row_ror:8 row_mask:0xf bank_mask:0xc
    v_mfma_f32_16x16x32_bf16 v[36:39], v[148:151], v[120:123], v[36:39]
    s_nop 0
    v_mfma_f32_16x16x32_bf16 v[184:187], v[124:127], v[124:127], v[184:187]
    ds_read_b128 v[128:131], v3 offset:448
    s_waitcnt lgkmcnt(5)
    v_mfma_f32_16x16x32_bf16 v[40:43], v[180:183], v[124:127], v[40:43]
    ds_read_b128 v[132:135], v3 offset:512
    v_mfma_f32_16x16x32_bf16 v[16:19], v[156:159], v[124:127], v[16:19]
    ds_read_b128 v[136:139], v3 offset:576
    v_mfma_f32_16x16x32_bf16 v[20:23], v[160:163], v[124:127], v[20:23]
    ds_read_b128 v[140:143], v3 offset:640
    s_waitcnt lgkmcnt(4)
    v_mfma_f32_16x16x32_bf16 v[24:27], v[164:167], v[124:127], v[24:27]
    ds_read_b128 v[144:147], v3 offset:704
    v_mfma_f32_16x16x32_bf16 v[28:31], v[168:171], v[124:127], v[28:31]
    ds_read_b128 v[148:151], v3 offset:768
    v_mfma_f32_16x16x32_bf16 v[32:35], v[172:175], v[124:127], v[32:35]
    ds_read_b128 v[152:155], v3 offset:832
    v_mfma_f32_16x16x32_bf16 v[36:39], v[176:179], v[124:127], v[36:39]
    ds_read_b128 v[156:159], v3 offset:0
    ds_read_b128 v[160:163], v3 offset:64
    ds_read_b128 v[164:167], v3 offset:128
    ds_read_b128 v[168:171], v3 offset:192
    ds_read_b128 v[172:175], v3 offset:256
    ds_read_b128 v[176:179], v3 offset:320
    ds_read_b128 v[180:183], v3 offset:384
    v_mov_b32_e64 v4, v184
    v_cndmask_b32_e64 v4, v4, v185, s[88:89]
    v_cndmask_b32_e64 v4, v4, v186, s[90:91]
    v_cndmask_b32_e64 v4, v4, v187, s[92:93]
    ds_bpermute_b32 v8, v6, v40
    ds_bpermute_b32 v9, v5, v4
    s_waitcnt lgkmcnt(0)
    v_mul_f32 v8, 0x3acccccd, v8
    v_mul_f32 v9, 0x3acccccd, v9
    v_fma_f32 v9, -v8, v8, v9
    v_max_f32 v9, 0, v9
    v_cvt_pk_bf16_f32 v8, v9, v8
    v_lshlrev_b32_e64 v9, 16, v8
    v_and_b32 v8, 0xffff0000, v8
    v_add_f32 v9, 0x3727c5ac, v9
    v_cvt_pk_bf16_f32 v9, v9, v9
    v_lshlrev_b32 v9, 16, v9
    v_sqrt_f32_e64 v9, v9
    s_nop 0
    v_cvt_pk_bf16_f32 v9, v9, v9
    v_lshlrev_b32 v9, 16, v9
    v_rcp_f32_e64 v10, v9
    s_nop 0
    v_mul_f32 v11, -v8, v10
    v_mul_f32 v10, 0xbfb8aa3b, v10
    v_pk_fma_f32 v[128:129], v[128:129], v[10:11], v[156:157] op_sel:[0,1,0] op_sel_hi:[1,1,1]
    v_pk_fma_f32 v[130:131], v[130:131], v[10:11], v[158:159] op_sel:[0,1,0] op_sel_hi:[1,1,1]
    v_pk_fma_f32 v[16:17], v[16:17], v[10:11], v[128:129] op_sel_hi:[1,0,1]
    v_pk_fma_f32 v[18:19], v[18:19], v[10:11], v[130:131] op_sel_hi:[1,0,1]
    v_exp_f32 v128, v16
    v_exp_f32 v129, v17
    v_exp_f32 v130, v18
    v_exp_f32 v131, v19
    v_pk_add_f32 v[128:129], v[128:129], 1.0 op_sel_hi:[1,0]
    v_pk_add_f32 v[130:131], v[130:131], 1.0 op_sel_hi:[1,0]
    v_rcp_f32 v128, v128
    v_rcp_f32 v129, v129
    v_rcp_f32 v130, v130
    v_rcp_f32 v131, v131
    v_pk_mul_f32 v[16:17], v[16:17], v[128:129]
    v_pk_mul_f32 v[18:19], v[18:19], v[130:131]
    v_cvt_pk_bf16_f32 v196, v16, v17
    v_cvt_pk_bf16_f32 v197, v18, v19
    v_pk_fma_f32 v[132:133], v[132:133], v[10:11], v[160:161] op_sel:[0,1,0] op_sel_hi:[1,1,1]
    v_pk_fma_f32 v[134:135], v[134:135], v[10:11], v[162:163] op_sel:[0,1,0] op_sel_hi:[1,1,1]
    v_pk_fma_f32 v[20:21], v[20:21], v[10:11], v[132:133] op_sel_hi:[1,0,1]
    v_pk_fma_f32 v[22:23], v[22:23], v[10:11], v[134:135] op_sel_hi:[1,0,1]
    v_exp_f32 v132, v20
    v_exp_f32 v133, v21
    v_exp_f32 v134, v22
    v_exp_f32 v135, v23
    v_pk_add_f32 v[132:133], v[132:133], 1.0 op_sel_hi:[1,0]
    v_pk_add_f32 v[134:135], v[134:135], 1.0 op_sel_hi:[1,0]
    v_rcp_f32 v132, v132
    v_rcp_f32 v133, v133
    v_rcp_f32 v134, v134
    v_rcp_f32 v135, v135
    v_pk_mul_f32 v[20:21], v[20:21], v[132:133]
    v_pk_mul_f32 v[22:23], v[22:23], v[134:135]
    v_cvt_pk_bf16_f32 v198, v20, v21
    v_cvt_pk_bf16_f32 v199, v22, v23
    global_store_dwordx4 v14, v[196:199], s[32:33] offset:0 sc1
    s_waitcnt vmcnt(1)
    v_cmp_ne_u32 vcc, s60, v47
    s_nop 1
    s_mov_b64 s[54:55], vcc
    s_cmp_lg_u64 s[54:55], 0
    s_cbranch_scc1 L_late_30
    global_load_dwordx4 v[48:51], v192, s[32:33] sc1
    v_add_u32 v192, 132096, v192
    global_load_dwordx4 v[52:55], v192, s[32:33] sc1
    v_add_u32 v192, 132096, v192
    global_load_dwordx4 v[56:59], v192, s[32:33] sc1
    v_add_u32 v192, 132096, v192
L_late_30:
    v_cmp_lt_u32 vcc, 47, v1
    v_pk_fma_f32 v[136:137], v[136:137], v[10:11], v[164:165] op_sel:[0,1,0] op_sel_hi:[1,1,1]
    v_pk_fma_f32 v[138:139], v[138:139], v[10:11], v[166:167] op_sel:[0,1,0] op_sel_hi:[1,1,1]
    v_pk_fma_f32 v[24:25], v[24:25], v[10:11], v[136:137] op_sel_hi:[1,0,1]
    v_pk_fma_f32 v[26:27], v[26:27], v[10:11], v[138:139] op_sel_hi:[1,0,1]
    v_exp_f32 v136, v24
    v_exp_f32 v137, v25
    v_exp_f32 v138, v26
    v_exp_f32_e64 v139, v27
    v_pk_add_f32 v[136:137], v[136:137], 1.0 op_sel_hi:[1,0]
    v_pk_add_f32 v[138:139], v[138:139], 1.0 op_sel_hi:[1,0]
    v_rcp_f32 v136, v136
    v_rcp_f32 v137, v137
    v_rcp_f32 v138, v138
    v_rcp_f32 v139, v139
    v_pk_mul_f32 v[24:25], v[24:25], v[136:137]
    v_pk_mul_f32 v[26:27], v[26:27], v[138:139]
    v_cvt_pk_bf16_f32 v200, v24, v25
    v_cvt_pk_bf16_f32 v201, v26, v27
    s_cmp_lg_u64 s[54:55], 0
    s_cbranch_scc1 L_late_31
    global_load_dwordx4 v[60:63], v192, s[32:33] sc1
    v_add_u32 v192, 132096, v192
    global_load_dwordx4 v[64:67], v192, s[32:33] sc1
    v_add_u32 v192, 132096, v192
L_late_31:
    v_pk_fma_f32 v[140:141], v[140:141], v[10:11], v[168:169] op_sel:[0,1,0] op_sel_hi:[1,1,1]
    v_pk_fma_f32 v[142:143], v[142:143], v[10:11], v[170:171] op_sel:[0,1,0] op_sel_hi:[1,1,1]
    v_pk_fma_f32 v[28:29], v[28:29], v[10:11], v[140:141] op_sel_hi:[1,0,1]
    v_pk_fma_f32 v[30:31], v[30:31], v[10:11], v[142:143] op_sel_hi:[1,0,1]
    v_exp_f32 v140, v28
    v_exp_f32 v141, v29
    v_exp_f32 v142, v30
    v_exp_f32 v143, v31
    v_pk_add_f32 v[140:141], v[140:141], 1.0 op_sel_hi:[1,0]
    v_pk_add_f32 v[142:143], v[142:143], 1.0 op_sel_hi:[1,0]
    v_rcp_f32 v140, v140
    v_rcp_f32 v141, v141
    v_rcp_f32 v142, v142
    v_rcp_f32 v143, v143
    v_pk_mul_f32 v[28:29], v[28:29], v[140:141]
    v_pk_mul_f32 v[30:31], v[30:31], v[142:143]
    v_cvt_pk_bf16_f32 v202, v28, v29
    v_cvt_pk_bf16_f32 v203, v30, v31
    global_store_dwordx4 v14, v[200:203], s[32:33] offset:1024 sc1
    s_cmp_lg_u64 s[54:55], 0
    s_cbranch_scc1 L_late_32
    global_load_dwordx4 v[68:71], v192, s[32:33] sc1
    v_add_u32 v192, 132096, v192
    global_load_dwordx4 v[72:75], v192, s[32:33] sc1
    v_add_u32 v192, 132096, v192
L_late_32:
    v_pk_fma_f32 v[144:145], v[144:145], v[10:11], v[172:173] op_sel:[0,1,0] op_sel_hi:[1,1,1]
    v_pk_fma_f32 v[146:147], v[146:147], v[10:11], v[174:175] op_sel:[0,1,0] op_sel_hi:[1,1,1]
    v_pk_fma_f32 v[32:33], v[32:33], v[10:11], v[144:145] op_sel_hi:[1,0,1]
    v_pk_fma_f32 v[34:35], v[34:35], v[10:11], v[146:147] op_sel_hi:[1,0,1]
    v_exp_f32 v144, v32
    v_exp_f32 v145, v33
    v_exp_f32 v146, v34
    v_exp_f32 v147, v35
    v_pk_add_f32 v[144:145], v[144:145], 1.0 op_sel_hi:[1,0]
    v_pk_add_f32 v[146:147], v[146:147], 1.0 op_sel_hi:[1,0]
    v_rcp_f32 v144, v144
    v_rcp_f32 v145, v145
    v_rcp_f32 v146, v146
    v_rcp_f32 v147, v147
    v_pk_mul_f32 v[32:33], v[32:33], v[144:145]
    v_pk_mul_f32 v[34:35], v[34:35], v[146:147]
    v_cvt_pk_bf16_f32 v204, v32, v33
    v_cvt_pk_bf16_f32 v205, v34, v35
    s_cmp_lg_u64 s[54:55], 0
    s_cbranch_scc1 L_late_33
    global_load_dwordx4 v[76:79], v192, s[32:33] sc1
    v_add_u32 v192, 132096, v192
L_late_33:
    v_pk_fma_f32 v[148:149], v[148:149], v[10:11], v[176:177] op_sel:[0,1,0] op_sel_hi:[1,1,1]
    v_pk_fma_f32 v[150:151], v[150:151], v[10:11], v[178:179] op_sel:[0,1,0] op_sel_hi:[1,1,1]
    v_pk_fma_f32 v[36:37], v[36:37], v[10:11], v[148:149] op_sel_hi:[1,0,1]
    v_pk_fma_f32 v[38:39], v[38:39], v[10:11], v[150:151] op_sel_hi:[1,0,1]
    v_exp_f32 v148, v36
    v_exp_f32 v149, v37
    v_exp_f32 v150, v38
    v_exp_f32 v151, v39
    v_pk_add_f32 v[148:149], v[148:149], 1.0 op_sel_hi:[1,0]
    v_pk_add_f32 v[150:151], v[150:151], 1.0 op_sel_hi:[1,0]
    v_rcp_f32 v148, v148
    v_rcp_f32 v149, v149
    v_rcp_f32 v150, v150
    v_rcp_f32 v151, v151
    v_pk_mul_f32 v[36:37], v[36:37], v[148:149]
    v_pk_mul_f32 v[38:39], v[38:39], v[150:151]
    v_cvt_pk_bf16_f32 v206, v36, v37
    v_cvt_pk_bf16_f32 v207, v38, v39
    global_store_dwordx4 v14, v[204:207], s[32:33] offset:2048 sc1
    s_cmp_lg_u64 s[54:55], 0
    s_cbranch_scc1 L_late_34
    global_load_dwordx4 v[80:83], v192, s[32:33] sc1
    v_add_u32 v192, 132096, v192
L_late_34:
    v_pk_fma_f32 v[152:153], v[152:153], v[10:11], v[180:181] op_sel:[0,1,0] op_sel_hi:[1,1,1]
    v_pk_fma_f32 v[154:155], v[154:155], v[10:11], v[182:183] op_sel:[0,1,0] op_sel_hi:[1,1,1]
    v_pk_fma_f32 v[40:41], v[40:41], v[10:11], v[152:153] op_sel_hi:[1,0,1]
    v_pk_fma_f32 v[42:43], v[42:43], v[10:11], v[154:155] op_sel_hi:[1,0,1]
    v_exp_f32 v152, v40
    v_exp_f32 v153, v41
    v_exp_f32 v154, v42
    v_exp_f32 v155, v43
    v_pk_add_f32 v[152:153], v[152:153], 1.0 op_sel_hi:[1,0]
    v_pk_add_f32 v[154:155], v[154:155], 1.0 op_sel_hi:[1,0]
    v_rcp_f32 v152, v152
    v_rcp_f32 v153, v153
    v_rcp_f32 v154, v154
    v_rcp_f32 v155, v155
    v_pk_mul_f32 v[40:41], v[40:41], v[152:153]
    v_pk_mul_f32 v[42:43], v[42:43], v[154:155]
    v_cvt_pk_bf16_f32 v208, v40, v41
    v_cvt_pk_bf16_f32 v209, v42, v43
    v_cndmask_b32_e64 v208, v208, 0, vcc
    v_cndmask_b32_e64 v209, v209, 0, vcc
    global_store_dwordx2 v15, v[208:209], s[32:33] sc1
    s_mov_b32 s87, 0
    s_cmp_lg_u64 s[54:55], 0
    s_cbranch_scc1 L_L_g1_1_slow_35
L_L_g1_1_join_36:
    ds_read_b128 v[152:155], v193 offset:6144
    ds_read_b128 v[128:131], v193 offset:0
    ds_read_b128 v[132:135], v193 offset:1024
    ds_read_b128 v[136:139], v193 offset:2048
    ds_read_b128 v[140:143], v193 offset:3072
    ds_read_b128 v[144:147], v193 offset:4096
    ds_read_b128 v[148:151], v193 offset:5120
    s_waitcnt vmcnt(11)
    v_mov_b32 v188, v50
    v_mov_b32 v189, v51
    v_mov_b32_dpp v50, v48 row_ror:8 row_mask:0xf bank_mask:0x3
    v_mov_b32_dpp v51, v49 row_ror:8 row_mask:0xf bank_mask:0x3
    v_mov_b32_dpp v48, v188 row_ror:8 row_mask:0xf bank_mask:0xc
    v_mov_b32_dpp v49, v189 row_ror:8 row_mask:0xf bank_mask:0xc
    s_nop 1
    v_mfma_f32_16x16x32_bf16 v[184:187], v[48:51], v[48:51], 0
    ds_read_b128 v[180:183], v193 offset:13312
    global_load_dwordx4 v[84:87], v192, s[32:33] sc1
    v_add_u32 v192, 132096, v192
    s_waitcnt vmcnt(11) lgkmcnt(5)
    v_mfma_f32_16x16x32_bf16 v[40:43], v[152:155], v[48:51], 0
    ds_read_b128 v[156:159], v193 offset:7168
    v_mov_b32_e64 v188, v54
    v_mfma_f32_16x16x32_bf16 v[16:19], v[128:131], v[48:51], 0
    ds_read_b128 v[160:163], v193 offset:8192
    v_mov_b32_e64 v189, v55
    v_mfma_f32_16x16x32_bf16 v[20:23], v[132:135], v[48:51], 0
    ds_read_b128 v[164:167], v193 offset:9216
    v_mov_b32_dpp v54, v52 row_ror:8 row_mask:0xf bank_mask:0x3
    s_waitcnt lgkmcnt(4)
    v_mfma_f32_16x16x32_bf16 v[24:27], v[136:139], v[48:51], 0
    ds_read_b128 v[168:171], v193 offset:10240
    v_mov_b32_dpp v55, v53 row_ror:8 row_mask:0xf bank_mask:0x3
    v_mfma_f32_16x16x32_bf16 v[28:31], v[140:143], v[48:51], 0
    ds_read_b128 v[172:175], v193 offset:11264
    v_mov_b32_dpp v52, v188 row_ror:8 row_mask:0xf bank_mask:0xc
    v_mfma_f32_16x16x32_bf16 v[32:35], v[144:147], v[48:51], 0
    ds_read_b128 v[176:179], v193 offset:12288
    v_mov_b32_dpp v53, v189 row_ror:8 row_mask:0xf bank_mask:0xc
    v_mfma_f32_16x16x32_bf16 v[36:39], v[148:151], v[48:51], 0
    global_load_dwordx4 a[188:191], v230, s[32:33] offset:3072 sc1
    v_add_u32 v230, 8192, v230
    v_mfma_f32_16x16x32_bf16 v[184:187], v[52:55], v[52:55], v[184:187]
    ds_read_b128 v[152:155], v193 offset:20480
    global_load_dwordx4 v[88:91], v192, s[32:33] sc1
    v_add_u32 v192, 132096, v192
    s_waitcnt vmcnt(12) lgkmcnt(5)
    v_mfma_f32_16x16x32_bf16 v[40:43], v[180:183], v[52:55], v[40:43]
    ds_read_b128 v[128:131], v193 offset:14336
    v_mov_b32_e64 v188, v58
    v_mfma_f32_16x16x32_bf16 v[16:19], v[156:159], v[52:55], v[16:19]
    ds_read_b128 v[132:135], v193 offset:15360
    v_mov_b32_e64 v189, v59
    v_mfma_f32_16x16x32_bf16 v[20:23], v[160:163], v[52:55], v[20:23]
    ds_read_b128 v[136:139], v193 offset:16384
    v_mov_b32_dpp v58, v56 row_ror:8 row_mask:0xf bank_mask:0x3
    s_waitcnt lgkmcnt(4)
    v_mfma_f32_16x16x32_bf16 v[24:27], v[164:167], v[52:55], v[24:27]
    ds_read_b128 v[140:143], v193 offset:17408
    v_mov_b32_dpp v59, v57 row_ror:8 row_mask:0xf bank_mask:0x3
    v_mfma_f32_16x16x32_bf16 v[28:31], v[168:171], v[52:55], v[28:31]
    ds_read_b128 v[144:147], v193 offset:18432
    v_mov_b32_dpp v56, v188 row_ror:8 row_mask:0xf bank_mask:0xc
    v_mfma_f32_16x16x32_bf16 v[32:35], v[172:175], v[52:55], v[32:35]
    ds_read_b128 v[148:151], v193 offset:19456
    v_mov_b32_dpp v57, v189 row_ror:8 row_mask:0xf bank_mask:0xc
    v_mfma_f32_16x16x32_bf16 v[36:39], v[176:179], v[52:55], v[36:39]
    global_load_dwordx4 a[192:195], v230, s[32:33] offset:-4096 sc1
    v_mfma_f32_16x16x32_bf16 v[184:187], v[56:59], v[56:59], v[184:187]
    ds_read_b128 v[180:183], v193 offset:27648
    global_load_dwordx4 v[92:95], v192, s[32:33] sc1
    v_add_u32 v192, 132096, v192
    s_waitcnt vmcnt(13) lgkmcnt(5)
    v_mfma_f32_16x16x32_bf16 v[40:43], v[152:155], v[56:59], v[40:43]
    ds_read_b128 v[156:159], v193 offset:21504
    v_mov_b32_e64 v188, v62
    v_mfma_f32_16x16x32_bf16 v[16:19], v[128:131], v[56:59], v[16:19]
    ds_read_b128 v[160:163], v193 offset:22528
    v_mov_b32_e64 v189, v63
    v_mfma_f32_16x16x32_bf16 v[20:23], v[132:135], v[56:59], v[20:23]
    ds_read_b128 v[164:167], v193 offset:23552
    v_mov_b32_dpp v62, v60 row_ror:8 row_mask:0xf bank_mask:0x3
    s_waitcnt lgkmcnt(4)
    v_mfma_f32_16x16x32_bf16 v[24:27], v[136:139], v[56:59], v[24:27]
    ds_read_b128 v[168:171], v193 offset:24576
    v_mov_b32_dpp v63, v61 row_ror:8 row_mask:0xf bank_mask:0x3
    v_mfma_f32_16x16x32_bf16 v[28:31], v[140:143], v[56:59], v[28:31]
    ds_read_b128 v[172:175], v193 offset:25600
    v_mov_b32_dpp v60, v188 row_ror:8 row_mask:0xf bank_mask:0xc
    v_mfma_f32_16x16x32_bf16 v[32:35], v[144:147], v[56:59], v[32:35]
    ds_read_b128 v[176:179], v193 offset:26624
    v_mov_b32_dpp v61, v189 row_ror:8 row_mask:0xf bank_mask:0xc
    v_mfma_f32_16x16x32_bf16 v[36:39], v[148:151], v[56:59], v[36:39]
    global_load_dwordx4 a[196:199], v230, s[32:33] offset:-3072 sc1
    v_mfma_f32_16x16x32_bf16 v[184:187], v[60:63], v[60:63], v[184:187]
    ds_read_b128 v[152:155], v193 offset:34816
    global_load_dwordx4 v[96:99], v192, s[32:33] sc1
    v_add_u32 v192, 132096, v192
    s_waitcnt vmcnt(14) lgkmcnt(5)
    v_mfma_f32_16x16x32_bf16 v[40:43], v[180:183], v[60:63], v[40:43]
    ds_read_b128 v[128:131], v193 offset:28672
    v_mov_b32_e64 v188, v66
    v_mfma_f32_16x16x32_bf16 v[16:19], v[156:159], v[60:63], v[16:19]
    ds_read_b128 v[132:135], v193 offset:29696
    v_mov_b32_e64 v189, v67
    v_mfma_f32_16x16x32_bf16 v[20:23], v[160:163], v[60:63], v[20:23]
    ds_read_b128 v[136:139], v193 offset:30720
    v_mov_b32_dpp v66, v64 row_ror:8 row_mask:0xf bank_mask:0x3
    s_waitcnt lgkmcnt(4)
    v_mfma_f32_16x16x32_bf16 v[24:27], v[164:167], v[60:63], v[24:27]
    ds_read_b128 v[140:143], v193 offset:31744
    v_mov_b32_dpp v67, v65 row_ror:8 row_mask:0xf bank_mask:0x3
    v_mfma_f32_16x16x32_bf16 v[28:31], v[168:171], v[60:63], v[28:31]
    ds_read_b128 v[144:147], v193 offset:32768
    v_mov_b32_dpp v64, v188 row_ror:8 row_mask:0xf bank_mask:0xc
    v_mfma_f32_16x16x32_bf16 v[32:35], v[172:175], v[60:63], v[32:35]
    ds_read_b128 v[148:151], v193 offset:33792
    v_mov_b32_dpp v65, v189 row_ror:8 row_mask:0xf bank_mask:0xc
    v_mfma_f32_16x16x32_bf16 v[36:39], v[176:179], v[60:63], v[36:39]
    global_load_dwordx4 a[200:203], v230, s[32:33] offset:-2048 sc1
    v_mfma_f32_16x16x32_bf16 v[184:187], v[64:67], v[64:67], v[184:187]
    ds_read_b128 v[180:183], v193 offset:41984
    global_load_dwordx4 v[100:103], v192, s[32:33] sc1
    v_add_u32 v192, 132096, v192
    s_waitcnt vmcnt(14) lgkmcnt(5)
    v_mfma_f32_16x16x32_bf16 v[40:43], v[152:155], v[64:67], v[40:43]
    ds_read_b128 v[156:159], v193 offset:35840
    v_mov_b32_e64 v188, v70
    v_mfma_f32_16x16x32_bf16 v[16:19], v[128:131], v[64:67], v[16:19]
    ds_read_b128 v[160:163], v193 offset:36864
    v_mov_b32_e64 v189, v71
    v_mfma_f32_16x16x32_bf16 v[20:23], v[132:135], v[64:67], v[20:23]
    ds_read_b128 v[164:167], v193 offset:37888
    v_mov_b32_dpp v70, v68 row_ror:8 row_mask:0xf bank_mask:0x3
    s_waitcnt lgkmcnt(4)
    v_mfma_f32_16x16x32_bf16 v[24:27], v[136:139], v[64:67], v[24:27]
    ds_read_b128 v[168:171], v193 offset:38912
    v_mov_b32_dpp v71, v69 row_ror:8 row_mask:0xf bank_mask:0x3
    v_mfma_f32_16x16x32_bf16 v[28:31], v[140:143], v[64:67], v[28:31]
    ds_read_b128 v[172:175], v193 offset:39936
    v_mov_b32_dpp v68, v188 row_ror:8 row_mask:0xf bank_mask:0xc
    v_mfma_f32_16x16x32_bf16 v[32:35], v[144:147], v[64:67], v[32:35]
    ds_read_b128 v[176:179], v193 offset:40960
    v_mov_b32_dpp v69, v189 row_ror:8 row_mask:0xf bank_mask:0xc
    v_mfma_f32_16x16x32_bf16 v[36:39], v[148:151], v[64:67], v[36:39]
    global_load_dwordx4 a[204:207], v230, s[32:33] offset:-1024 sc1
    v_mfma_f32_16x16x32_bf16 v[184:187], v[68:71], v[68:71], v[184:187]
    ds_read_b128 v[152:155], v193 offset:49152
    global_load_dwordx4 v[104:107], v192, s[32:33] sc1
    v_add_u32 v192, 132096, v192
    s_waitcnt vmcnt(15) lgkmcnt(5)
    v_mfma_f32_16x16x32_bf16 v[40:43], v[180:183], v[68:71], v[40:43]
    ds_read_b128 v[128:131], v193 offset:43008
    v_mov_b32_e64 v188, v74
    v_mfma_f32_16x16x32_bf16 v[16:19], v[156:159], v[68:71], v[16:19]
    ds_read_b128 v[132:135], v193 offset:44032
    v_mov_b32_e64 v189, v75
    v_mfma_f32_16x16x32_bf16 v[20:23], v[160:163], v[68:71], v[20:23]
    ds_read_b128 v[136:139], v193 offset:45056
    v_mov_b32_dpp v74, v72 row_ror:8 row_mask:0xf bank_mask:0x3
    s_waitcnt lgkmcnt(4)
    v_mfma_f32_16x16x32_bf16 v[24:27], v[164:167], v[68:71], v[24:27]
    ds_read_b128 v[140:143], v193 offset:46080
    v_mov_b32_dpp v75, v73 row_ror:8 row_mask:0xf bank_mask:0x3
    v_mfma_f32_16x16x32_bf16 v[28:31], v[168:171], v[68:71], v[28:31]
    ds_read_b128 v[144:147], v193 offset:47104
    v_mov_b32_dpp v72, v188 row_ror:8 row_mask:0xf bank_mask:0xc
    v_mfma_f32_16x16x32_bf16 v[32:35], v[172:175], v[68:71], v[32:35]
    ds_read_b128 v[148:151], v193 offset:48128
    v_mov_b32_dpp v73, v189 row_ror:8 row_mask:0xf bank_mask:0xc
    global_load_dwordx4 a[208:211], v230, s[32:33] offset:0 sc1
    v_mfma_f32_16x16x32_bf16 v[36:39], v[176:179], v[68:71], v[36:39]
    s_cmp_lg_u32 s87, 0
    s_cbranch_scc1 L_pubd_37
    s_waitcnt vmcnt(12)
    s_mov_b64 exec, 0x1
    global_store_dword v226, v227, s[32:33] sc1
    s_mov_b64 exec, -1
    s_mov_b32 s87, 1
L_pubd_37:
    v_mfma_f32_16x16x32_bf16 v[184:187], v[72:75], v[72:75], v[184:187]
    ds_read_b128 v[180:183], v193 offset:56320
    global_load_dwordx4 v[108:111], v192, s[32:33] sc1
    v_add_u32 v192, 132096, v192
    s_waitcnt vmcnt(16) lgkmcnt(5)
    v_mfma_f32_16x16x32_bf16 v[40:43], v[152:155], v[72:75], v[40:43]
    ds_read_b128 v[156:159], v193 offset:50176
    v_mov_b32_e64 v188, v78
    v_mfma_f32_16x16x32_bf16 v[16:19], v[128:131], v[72:75], v[16:19]
    ds_read_b128 v[160:163], v193 offset:51200
    v_mov_b32_e64 v189, v79
    v_mfma_f32_16x16x32_bf16 v[20:23], v[132:135], v[72:75], v[20:23]
    ds_read_b128 v[164:167], v193 offset:52224
    v_mov_b32_dpp v78, v76 row_ror:8 row_mask:0xf bank_mask:0x3
    s_waitcnt lgkmcnt(4)
    v_mfma_f32_16x16x32_bf16 v[24:27], v[136:139], v[72:75], v[24:27]
    ds_read_b128 v[168:171], v193 offset:53248
    v_mov_b32_dpp v79, v77 row_ror:8 row_mask:0xf bank_mask:0x3
    v_mfma_f32_16x16x32_bf16 v[28:31], v[140:143], v[72:75], v[28:31]
    ds_read_b128 v[172:175], v193 offset:54272
    v_mov_b32_dpp v76, v188 row_ror:8 row_mask:0xf bank_mask:0xc
    global_load_dwordx4 a[212:215], v230, s[32:33] offset:1024 sc1
    v_mfma_f32_16x16x32_bf16 v[32:35], v[144:147], v[72:75], v[32:35]
    ds_read_b128 v[176:179], v193 offset:55296
    v_mov_b32_dpp v77, v189 row_ror:8 row_mask:0xf bank_mask:0xc
    v_add_u32 v14, 3678208, v14
    v_mfma_f32_16x16x32_bf16 v[36:39], v[148:151], v[72:75], v[36:39]
    v_add_u32 v15, 3678208, v15
    v_mfma_f32_16x16x32_bf16 v[184:187], v[76:79], v[76:79], v[184:187]
    ds_read_b128 v[152:155], v193 offset:63488
    global_load_dwordx4 v[112:115], v192, s[32:33] sc1
    v_add_u32 v192, 132096, v192
    s_waitcnt vmcnt(16) lgkmcnt(5)
    v_mfma_f32_16x16x32_bf16 v[40:43], v[180:183], v[76:79], v[40:43]
    ds_read_b128 v[128:131], v193 offset:57344
    v_mov_b32_e64 v188, v82
    v_mfma_f32_16x16x32_bf16 v[16:19], v[156:159], v[76:79], v[16:19]
    ds_read_b128 v[132:135], v193 offset:58368
    v_mov_b32_e64 v189, v83
    v_mfma_f32_16x16x32_bf16 v[20:23], v[160:163], v[76:79], v[20:23]
    ds_read_b128 v[136:139], v193 offset:59392
    v_mov_b32_dpp v82, v80 row_ror:8 row_mask:0xf bank_mask:0x3
    s_waitcnt lgkmcnt(4)
    v_mfma_f32_16x16x32_bf16 v[24:27], v[164:167], v[76:79], v[24:27]
    ds_read_b128 v[140:143], v193 offset:60416
    v_mov_b32_dpp v83, v81 row_ror:8 row_mask:0xf bank_mask:0x3
    v_mfma_f32_16x16x32_bf16 v[28:31], v[168:171], v[76:79], v[28:31]
    ds_read_b128 v[144:147], v193 offset:61440
    v_mov_b32_dpp v80, v188 row_ror:8 row_mask:0xf bank_mask:0xc
    v_mfma_f32_16x16x32_bf16 v[32:35], v[172:175], v[76:79], v[32:35]
    ds_read_b128 v[148:151], v193 offset:62464
    v_mov_b32_dpp v81, v189 row_ror:8 row_mask:0xf bank_mask:0xc
    global_load_dwordx4 a[216:219], v230, s[32:33] offset:2048 sc1
    v_mfma_f32_16x16x32_bf16 v[36:39], v[176:179], v[76:79], v[36:39]
    v_add_u32 v226, 0x2000, v226
    v_mfma_f32_16x16x32_bf16 v[184:187], v[80:83], v[80:83], v[184:187]
    ds_read_b128 v[180:183], v194 offset:6144
    global_load_dwordx4 v[116:119], v192, s[32:33] sc1
    v_add_u32 v192, 132096, v192
    s_waitcnt vmcnt(16) lgkmcnt(5)
    v_mfma_f32_16x16x32_bf16 v[40:43], v[152:155], v[80:83], v[40:43]
    ds_read_b128 v[156:159], v194 offset:0
    v_mov_b32_e64 v188, v86
    v_mfma_f32_16x16x32_bf16 v[16:19], v[128:131], v[80:83], v[16:19]
    ds_read_b128 v[160:163], v194 offset:1024
    v_mov_b32_e64 v189, v87
    v_mfma_f32_16x16x32_bf16 v[20:23], v[132:135], v[80:83], v[20:23]
    ds_read_b128 v[164:167], v194 offset:2048
    v_mov_b32_dpp v86, v84 row_ror:8 row_mask:0xf bank_mask:0x3
    s_waitcnt lgkmcnt(4)
    v_mfma_f32_16x16x32_bf16 v[24:27], v[136:139], v[80:83], v[24:27]
    ds_read_b128 v[168:171], v194 offset:3072
    v_mov_b32_dpp v87, v85 row_ror:8 row_mask:0xf bank_mask:0x3
    v_mfma_f32_16x16x32_bf16 v[28:31], v[140:143], v[80:83], v[28:31]
    ds_read_b128 v[172:175], v194 offset:4096
    v_mov_b32_dpp v84, v188 row_ror:8 row_mask:0xf bank_mask:0xc
    v_mfma_f32_16x16x32_bf16 v[32:35], v[144:147], v[80:83], v[32:35]
    ds_read_b128 v[176:179], v194 offset:5120
    v_mov_b32_dpp v85, v189 row_ror:8 row_mask:0xf bank_mask:0xc
    v_mfma_f32_16x16x32_bf16 v[36:39], v[148:151], v[80:83], v[36:39]
    global_load_dwordx4 a[220:223], v230, s[32:33] offset:3072 sc1
    v_add_u32 v230, 8192, v230
    v_mfma_f32_16x16x32_bf16 v[184:187], v[84:87], v[84:87], v[184:187]
    ds_read_b128 v[152:155], v194 offset:13312
    global_load_dwordx4 v[120:123], v192, s[32:33] sc1
    v_add_u32 v192, 132096, v192
    s_waitcnt vmcnt(16) lgkmcnt(5)
    v_mfma_f32_16x16x32_bf16 v[40:43], v[180:183], v[84:87], v[40:43]
    ds_read_b128 v[128:131], v194 offset:7168
    v_mov_b32_e64 v188, v90
    v_mfma_f32_16x16x32_bf16 v[16:19], v[156:159], v[84:87], v[16:19]
    ds_read_b128 v[132:135], v194 offset:8192
    v_mov_b32_e64 v189, v91
    v_mfma_f32_16x16x32_bf16 v[20:23], v[160:163], v[84:87], v[20:23]
    ds_read_b128 v[136:139], v194 offset:9216
    v_mov_b32_dpp v90, v88 row_ror:8 row_mask:0xf bank_mask:0x3
    s_waitcnt lgkmcnt(4)
    v_mfma_f32_16x16x32_bf16 v[24:27], v[164:167], v[84:87], v[24:27]
    ds_read_b128 v[140:143], v194 offset:10240
    v_mov_b32_dpp v91, v89 row_ror:8 row_mask:0xf bank_mask:0x3
    v_mfma_f32_16x16x32_bf16 v[28:31], v[168:171], v[84:87], v[28:31]
    ds_read_b128 v[144:147], v194 offset:11264
    v_mov_b32_dpp v88, v188 row_ror:8 row_mask:0xf bank_mask:0xc
    v_mfma_f32_16x16x32_bf16 v[32:35], v[172:175], v[84:87], v[32:35]
    ds_read_b128 v[148:151], v194 offset:12288
    v_mov_b32_dpp v89, v189 row_ror:8 row_mask:0xf bank_mask:0xc
    v_mfma_f32_16x16x32_bf16 v[36:39], v[176:179], v[84:87], v[36:39]
    global_load_dwordx4 a[224:227], v230, s[32:33] offset:-4096 sc1
    v_mfma_f32_16x16x32_bf16 v[184:187], v[88:91], v[88:91], v[184:187]
    ds_read_b128 v[180:183], v194 offset:20480
    global_load_dwordx4 v[124:127], v192, s[32:33] sc1
    s_waitcnt vmcnt(16) lgkmcnt(5)
    v_mfma_f32_16x16x32_bf16 v[40:43], v[152:155], v[88:91], v[40:43]
    ds_read_b128 v[156:159], v194 offset:14336
    v_mov_b32_e64 v188, v94
    v_mfma_f32_16x16x32_bf16 v[16:19], v[128:131], v[88:91], v[16:19]
    ds_read_b128 v[160:163], v194 offset:15360
    v_mov_b32_e64 v189, v95
    v_mfma_f32_16x16x32_bf16 v[20:23], v[132:135], v[88:91], v[20:23]
    ds_read_b128 v[164:167], v194 offset:16384
    v_mov_b32_dpp v94, v92 row_ror:8 row_mask:0xf bank_mask:0x3
    s_waitcnt lgkmcnt(4)
    v_mfma_f32_16x16x32_bf16 v[24:27], v[136:139], v[88:91], v[24:27]
    ds_read_b128 v[168:171], v194 offset:17408
    v_mov_b32_dpp v95, v93 row_ror:8 row_mask:0xf bank_mask:0x3
    v_mfma_f32_16x16x32_bf16 v[28:31], v[140:143], v[88:91], v[28:31]
    ds_read_b128 v[172:175], v194 offset:18432
    v_mov_b32_dpp v92, v188 row_ror:8 row_mask:0xf bank_mask:0xc
    v_mfma_f32_16x16x32_bf16 v[32:35], v[144:147], v[88:91], v[32:35]
    ds_read_b128 v[176:179], v194 offset:19456
    v_mov_b32_dpp v93, v189 row_ror:8 row_mask:0xf bank_mask:0xc
    v_mfma_f32_16x16x32_bf16 v[36:39], v[148:151], v[88:91], v[36:39]
    global_load_dwordx4 a[228:231], v230, s[32:33] offset:-3072 sc1
    v_mfma_f32_16x16x32_bf16 v[184:187], v[92:95], v[92:95], v[184:187]
    ds_read_b128 v[152:155], v194 offset:27648
    v_bfe_u32 v218, v1, 2, 1
    s_waitcnt vmcnt(15) lgkmcnt(5)
    v_mfma_f32_16x16x32_bf16 v[40:43], v[180:183], v[92:95], v[40:43]
    ds_read_b128 v[128:131], v194 offset:21504
    v_mov_b32_e64 v188, v98
    v_mfma_f32_16x16x32_bf16 v[16:19], v[156:159], v[92:95], v[16:19]
    ds_read_b128 v[132:135], v194 offset:22528
    v_mov_b32_e64 v189, v99
    v_mfma_f32_16x16x32_bf16 v[20:23], v[160:163], v[92:95], v[20:23]
    ds_read_b128 v[136:139], v194 offset:23552
    v_mov_b32_dpp v98, v96 row_ror:8 row_mask:0xf bank_mask:0x3
    s_waitcnt lgkmcnt(4)
    v_mfma_f32_16x16x32_bf16 v[24:27], v[164:167], v[92:95], v[24:27]
    ds_read_b128 v[140:143], v194 offset:24576
    v_mov_b32_dpp v99, v97 row_ror:8 row_mask:0xf bank_mask:0x3
    v_lshlrev_b32 v218, 5, v218
    v_mfma_f32_16x16x32_bf16 v[28:31], v[168:171], v[92:95], v[28:31]
    ds_read_b128 v[144:147], v194 offset:25600
    v_mov_b32_dpp v96, v188 row_ror:8 row_mask:0xf bank_mask:0xc
    v_and_or_b32 v218, v1, 3, v218
    v_mfma_f32_16x16x32_bf16 v[32:35], v[172:175], v[92:95], v[32:35]
    ds_read_b128 v[148:151], v194 offset:26624
    v_mov_b32_dpp v97, v189 row_ror:8 row_mask:0xf bank_mask:0xc
    global_load_dwordx4 a[232:235], v230, s[32:33] offset:-2048 sc1
    v_mfma_f32_16x16x32_bf16 v[36:39], v[176:179], v[92:95], v[36:39]
    global_load_dwordx4 a[236:239], v230, s[32:33] offset:-1024 sc1
    v_mfma_f32_16x16x32_bf16 v[184:187], v[96:99], v[96:99], v[184:187]
    ds_read_b128 v[180:183], v194 offset:34816
    v_lshl_add_u32 v218, v218, 2, s9
    s_waitcnt vmcnt(15) lgkmcnt(5)
    v_mfma_f32_16x16x32_bf16 v[40:43], v[152:155], v[96:99], v[40:43]
    ds_read_b128 v[156:159], v194 offset:28672
    v_mov_b32 v188, v102
    v_mfma_f32_16x16x32_bf16 v[16:19], v[128:131], v[96:99], v[16:19]
    ds_read_b128 v[160:163], v194 offset:29696
    v_mov_b32_e64 v189, v103
    v_mfma_f32_16x16x32_bf16 v[20:23], v[132:135], v[96:99], v[20:23]
    ds_read_b128 v[164:167], v194 offset:30720
    v_mov_b32_dpp v102, v100 row_ror:8 row_mask:0xf bank_mask:0x3
    s_waitcnt lgkmcnt(4)
    v_mfma_f32_16x16x32_bf16 v[24:27], v[136:139], v[96:99], v[24:27]
    ds_read_b128 v[168:171], v194 offset:31744
    v_mov_b32_dpp v103, v101 row_ror:8 row_mask:0xf bank_mask:0x3
    v_lshl_add_u32 v212, v1, 4, s10
    v_mfma_f32_16x16x32_bf16 v[28:31], v[140:143], v[96:99], v[28:31]
    ds_read_b128 v[172:175], v194 offset:32768
    v_mov_b32_dpp v100, v188 row_ror:8 row_mask:0xf bank_mask:0xc
    v_add_u32 v213, 8192, v212
    v_mfma_f32_16x16x32_bf16 v[32:35], v[144:147], v[96:99], v[32:35]
    ds_read_b128 v[176:179], v194 offset:33792
    v_mov_b32_dpp v101, v189 row_ror:8 row_mask:0xf bank_mask:0xc
    global_load_dwordx4 a[240:243], v230, s[32:33] offset:0 sc1
    v_mfma_f32_16x16x32_bf16 v[36:39], v[148:151], v[96:99], v[36:39]
    global_load_dwordx4 a[244:247], v230, s[32:33] offset:1024 sc1
    v_mfma_f32_16x16x32_bf16 v[184:187], v[100:103], v[100:103], v[184:187]
    ds_read_b128 v[152:155], v194 offset:41984
    v_lshl_add_u32 v216, v1, 3, s12
    s_waitcnt vmcnt(15) lgkmcnt(5)
    v_mfma_f32_16x16x32_bf16 v[40:43], v[180:183], v[100:103], v[40:43]
    ds_read_b128 v[128:131], v194 offset:35840
    v_mov_b32_e64 v188, v106
    v_mfma_f32_16x16x32_bf16 v[16:19], v[156:159], v[100:103], v[16:19]
    ds_read_b128 v[132:135], v194 offset:36864
    v_mov_b32_e64 v189, v107
    v_mfma_f32_16x16x32_bf16 v[20:23], v[160:163], v[100:103], v[20:23]
    ds_read_b128 v[136:139], v194 offset:37888
    v_mov_b32_dpp v106, v104 row_ror:8 row_mask:0xf bank_mask:0x3
    s_waitcnt lgkmcnt(4)
    v_mfma_f32_16x16x32_bf16 v[24:27], v[164:167], v[100:103], v[24:27]
    ds_read_b128 v[140:143], v194 offset:38912
    v_mov_b32_dpp v107, v105 row_ror:8 row_mask:0xf bank_mask:0x3
    v_lshl_add_u32 v214, v1, 4, s11
    v_mfma_f32_16x16x32_bf16 v[28:31], v[168:171], v[100:103], v[28:31]
    ds_read_b128 v[144:147], v194 offset:39936
    v_mov_b32_dpp v104, v188 row_ror:8 row_mask:0xf bank_mask:0xc
    v_add_u32 v215, 8192, v214
    v_mfma_f32_16x16x32_bf16 v[32:35], v[172:175], v[100:103], v[32:35]
    ds_read_b128 v[148:151], v194 offset:40960
    v_mov_b32_dpp v105, v189 row_ror:8 row_mask:0xf bank_mask:0xc
    global_load_dwordx4 a[248:251], v230, s[32:33] offset:2048 sc1
    v_mfma_f32_16x16x32_bf16 v[36:39], v[176:179], v[100:103], v[36:39]
    global_load_dwordx4 a[252:255], v230, s[32:33] offset:3072 sc1
    v_add_u32 v230, 8192, v230
    v_mfma_f32_16x16x32_bf16 v[184:187], v[104:107], v[104:107], v[184:187]
    ds_read_b128 v[180:183], v194 offset:49152
    v_lshl_add_u32 v217, v1, 3, s13
    s_waitcnt vmcnt(15) lgkmcnt(5)
    v_mfma_f32_16x16x32_bf16 v[40:43], v[152:155], v[104:107], v[40:43]
    ds_read_b128 v[156:159], v194 offset:43008
    v_mov_b32_e64 v188, v110
    v_mfma_f32_16x16x32_bf16 v[16:19], v[128:131], v[104:107], v[16:19]
    ds_read_b128 v[160:163], v194 offset:44032
    v_mov_b32_e64 v189, v111
    v_mfma_f32_16x16x32_bf16 v[20:23], v[132:135], v[104:107], v[20:23]
    ds_read_b128 v[164:167], v194 offset:45056
    v_mov_b32_dpp v110, v108 row_ror:8 row_mask:0xf bank_mask:0x3
    s_waitcnt lgkmcnt(4)
    v_mfma_f32_16x16x32_bf16 v[24:27], v[136:139], v[104:107], v[24:27]
    ds_read_b128 v[168:171], v194 offset:46080
    v_mov_b32_dpp v111, v109 row_ror:8 row_mask:0xf bank_mask:0x3
    v_mfma_f32_16x16x32_bf16 v[28:31], v[140:143], v[104:107], v[28:31]
    ds_read_b128 v[172:175], v194 offset:47104
    v_mov_b32_dpp v108, v188 row_ror:8 row_mask:0xf bank_mask:0xc
    v_mfma_f32_16x16x32_bf16 v[32:35], v[144:147], v[104:107], v[32:35]
    ds_read_b128 v[176:179], v194 offset:48128
    v_mov_b32_dpp v109, v189 row_ror:8 row_mask:0xf bank_mask:0xc
    global_load_dwordx4 v[232:235], v230, s[32:33] offset:-4096 sc1
    v_mfma_f32_16x16x32_bf16 v[36:39], v[148:151], v[104:107], v[36:39]
    global_load_dwordx4 v[236:239], v230, s[32:33] offset:-3072 sc1
    v_mfma_f32_16x16x32_bf16 v[184:187], v[108:111], v[108:111], v[184:187]
    ds_read_b128 v[152:155], v194 offset:56320
    global_load_dwordx4 v[240:243], v230, s[32:33] offset:-2048 sc1
    s_waitcnt vmcnt(16) lgkmcnt(5)
    v_mfma_f32_16x16x32_bf16 v[40:43], v[180:183], v[108:111], v[40:43]
    ds_read_b128 v[128:131], v194 offset:50176
    v_mov_b32_e64 v188, v114
    v_mfma_f32_16x16x32_bf16 v[16:19], v[156:159], v[108:111], v[16:19]
    ds_read_b128 v[132:135], v194 offset:51200
    v_mov_b32_e64 v189, v115
    v_mfma_f32_16x16x32_bf16 v[20:23], v[160:163], v[108:111], v[20:23]
    ds_read_b128 v[136:139], v194 offset:52224
    v_mov_b32_dpp v114, v112 row_ror:8 row_mask:0xf bank_mask:0x3
    s_waitcnt lgkmcnt(4)
    v_mfma_f32_16x16x32_bf16 v[24:27], v[164:167], v[108:111], v[24:27]
    ds_read_b128 v[140:143], v194 offset:53248
    v_mov_b32_dpp v115, v113 row_ror:8 row_mask:0xf bank_mask:0x3
    v_mfma_f32_16x16x32_bf16 v[28:31], v[168:171], v[108:111], v[28:31]
    ds_read_b128 v[144:147], v194 offset:54272
    v_mov_b32_dpp v112, v188 row_ror:8 row_mask:0xf bank_mask:0xc
    v_mfma_f32_16x16x32_bf16 v[32:35], v[172:175], v[108:111], v[32:35]
    ds_read_b128 v[148:151], v194 offset:55296
    v_mov_b32_dpp v113, v189 row_ror:8 row_mask:0xf bank_mask:0xc
    v_mfma_f32_16x16x32_bf16 v[36:39], v[176:179], v[108:111], v[36:39]
    global_load_dwordx4 v[244:247], v230, s[32:33] offset:-1024 sc1
    v_mfma_f32_16x16x32_bf16 v[184:187], v[112:115], v[112:115], v[184:187]
    ds_read_b128 v[180:183], v194 offset:63488
    global_load_dwordx4 v[248:251], v230, s[32:33] offset:0 sc1
    s_waitcnt vmcnt(16) lgkmcnt(5)
    v_mfma_f32_16x16x32_bf16 v[40:43], v[152:155], v[112:115], v[40:43]
    ds_read_b128 v[156:159], v194 offset:57344
    v_mov_b32_e64 v188, v118
    v_mfma_f32_16x16x32_bf16 v[16:19], v[128:131], v[112:115], v[16:19]
    ds_read_b128 v[160:163], v194 offset:58368
    v_mov_b32_e64 v189, v119
    v_mfma_f32_16x16x32_bf16 v[20:23], v[132:135], v[112:115], v[20:23]
    ds_read_b128 v[164:167], v194 offset:59392
    v_mov_b32_dpp v118, v116 row_ror:8 row_mask:0xf bank_mask:0x3
    s_waitcnt lgkmcnt(4)
    v_mfma_f32_16x16x32_bf16 v[24:27], v[136:139], v[112:115], v[24:27]
    ds_read_b128 v[168:171], v194 offset:60416
    v_mov_b32_dpp v119, v117 row_ror:8 row_mask:0xf bank_mask:0x3
    v_mfma_f32_16x16x32_bf16 v[28:31], v[140:143], v[112:115], v[28:31]
    ds_read_b128 v[172:175], v194 offset:61440
    v_mov_b32_dpp v116, v188 row_ror:8 row_mask:0xf bank_mask:0xc
    v_mfma_f32_16x16x32_bf16 v[32:35], v[144:147], v[112:115], v[32:35]
    ds_read_b128 v[176:179], v194 offset:62464
    v_mov_b32_dpp v117, v189 row_ror:8 row_mask:0xf bank_mask:0xc
    v_mfma_f32_16x16x32_bf16 v[36:39], v[148:151], v[112:115], v[36:39]
    s_nop 0
    v_mfma_f32_16x16x32_bf16 v[184:187], v[116:119], v[116:119], v[184:187]
    ds_read_b128 v[152:155], v195 offset:6144
    global_load_dwordx4 v[252:255], v230, s[32:33] offset:1024 sc1
    s_waitcnt vmcnt(15) lgkmcnt(5)
    v_mfma_f32_16x16x32_bf16 v[40:43], v[180:183], v[116:119], v[40:43]
    ds_read_b128 v[128:131], v195 offset:0
    v_mov_b32 v188, v122
    v_mfma_f32_16x16x32_bf16 v[16:19], v[156:159], v[116:119], v[16:19]
    ds_read_b128 v[132:135], v195 offset:1024
    v_mov_b32_e64 v189, v123
    v_mfma_f32_16x16x32_bf16 v[20:23], v[160:163], v[116:119], v[20:23]
    ds_read_b128 v[136:139], v195 offset:2048
    v_mov_b32_dpp v122, v120 row_ror:8 row_mask:0xf bank_mask:0x3
    s_waitcnt lgkmcnt(4)
    v_mfma_f32_16x16x32_bf16 v[24:27], v[164:167], v[116:119], v[24:27]
    ds_read_b128 v[140:143], v195 offset:3072
    v_mov_b32_dpp v123, v121 row_ror:8 row_mask:0xf bank_mask:0x3
    v_mfma_f32_16x16x32_bf16 v[28:31], v[168:171], v[116:119], v[28:31]
    ds_read_b128 v[144:147], v195 offset:4096
    v_mov_b32_dpp v120, v188 row_ror:8 row_mask:0xf bank_mask:0xc
    v_mfma_f32_16x16x32_bf16 v[32:35], v[172:175], v[116:119], v[32:35]
    ds_read_b128 v[148:151], v195 offset:5120
    v_mov_b32_dpp v121, v189 row_ror:8 row_mask:0xf bank_mask:0xc
    v_mfma_f32_16x16x32_bf16 v[36:39], v[176:179], v[116:119], v[36:39]
    s_nop 0
    v_mfma_f32_16x16x32_bf16 v[184:187], v[120:123], v[120:123], v[184:187]
    ds_read_b128 v[180:183], v195 offset:13312
    global_load_dword v219, v218, s[32:33] sc1
    s_waitcnt vmcnt(14) lgkmcnt(5)
    v_mfma_f32_16x16x32_bf16 v[40:43], v[152:155], v[120:123], v[40:43]
    ds_read_b128 v[156:159], v195 offset:7168
    v_mov_b32 v188, v126
    v_mfma_f32_16x16x32_bf16 v[16:19], v[128:131], v[120:123], v[16:19]
    ds_read_b128 v[160:163], v195 offset:8192
    v_mov_b32_e64 v189, v127
    v_mfma_f32_16x16x32_bf16 v[20:23], v[132:135], v[120:123], v[20:23]
    ds_read_b128 v[164:167], v195 offset:9216
    v_mov_b32_dpp v126, v124 row_ror:8 row_mask:0xf bank_mask:0x3
    s_waitcnt lgkmcnt(4)
    v_mfma_f32_16x16x32_bf16 v[24:27], v[136:139], v[120:123], v[24:27]
    ds_read_b128 v[168:171], v195 offset:10240
    v_mov_b32_dpp v127, v125 row_ror:8 row_mask:0xf bank_mask:0x3
    v_mfma_f32_16x16x32_bf16 v[28:31], v[140:143], v[120:123], v[28:31]
    ds_read_b128 v[172:175], v195 offset:11264
    v_mov_b32_dpp v124, v188 row_ror:8 row_mask:0xf bank_mask:0xc
    v_mfma_f32_16x16x32_bf16 v[32:35], v[144:147], v[120:123], v[32:35]
    ds_read_b128 v[176:179], v195 offset:12288
    v_mov_b32_dpp v125, v189 row_ror:8 row_mask:0xf bank_mask:0xc
    v_mfma_f32_16x16x32_bf16 v[36:39], v[148:151], v[120:123], v[36:39]
    s_nop 0
    v_mfma_f32_16x16x32_bf16 v[184:187], v[124:127], v[124:127], v[184:187]
    ds_read_b128 v[128:131], v3 offset:448
    s_waitcnt lgkmcnt(5)
    v_mfma_f32_16x16x32_bf16 v[40:43], v[180:183], v[124:127], v[40:43]
    ds_read_b128 v[132:135], v3 offset:512
    v_mfma_f32_16x16x32_bf16 v[16:19], v[156:159], v[124:127], v[16:19]
    ds_read_b128 v[136:139], v3 offset:576
    v_mfma_f32_16x16x32_bf16 v[20:23], v[160:163], v[124:127], v[20:23]
    ds_read_b128 v[140:143], v3 offset:640
    s_waitcnt lgkmcnt(4)
    v_mfma_f32_16x16x32_bf16 v[24:27], v[164:167], v[124:127], v[24:27]
    ds_read_b128 v[144:147], v3 offset:704
    v_mfma_f32_16x16x32_bf16 v[28:31], v[168:171], v[124:127], v[28:31]
    ds_read_b128 v[148:151], v3 offset:768
    v_mfma_f32_16x16x32_bf16 v[32:35], v[172:175], v[124:127], v[32:35]
    ds_read_b128 v[152:155], v3 offset:832
    v_mfma_f32_16x16x32_bf16 v[36:39], v[176:179], v[124:127], v[36:39]
    ds_read_b128 v[156:159], v3 offset:0
    ds_read_b128 v[160:163], v3 offset:64
    ds_read_b128 v[164:167], v3 offset:128
    ds_read_b128 v[168:171], v3 offset:192
    ds_read_b128 v[172:175], v3 offset:256
    ds_read_b128 v[176:179], v3 offset:320
    ds_read_b128 v[180:183], v3 offset:384
    v_mov_b32_e64 v4, v184
    v_cndmask_b32_e64 v4, v4, v185, s[88:89]
    v_cndmask_b32_e64 v4, v4, v186, s[90:91]
    v_cndmask_b32_e64 v4, v4, v187, s[92:93]
    ds_bpermute_b32 v8, v6, v40
    ds_bpermute_b32 v9, v5, v4
    s_waitcnt lgkmcnt(0)
    v_mul_f32 v8, 0x3acccccd, v8
    v_mul_f32 v9, 0x3acccccd, v9
    v_fma_f32 v9, -v8, v8, v9
    v_max_f32 v9, 0, v9
    v_cvt_pk_bf16_f32 v8, v9, v8
    v_lshlrev_b32_e64 v9, 16, v8
    v_and_b32 v8, 0xffff0000, v8
    v_add_f32 v9, 0x3727c5ac, v9
    v_cvt_pk_bf16_f32 v9, v9, v9
    v_lshlrev_b32 v9, 16, v9
    v_sqrt_f32_e64 v9, v9
    s_nop 0
    v_cvt_pk_bf16_f32 v9, v9, v9
    v_lshlrev_b32 v9, 16, v9
    v_rcp_f32_e64 v10, v9
    s_nop 0
    v_mul_f32 v11, -v8, v10
    v_mul_f32 v10, 0xbfb8aa3b, v10
    v_pk_fma_f32 v[128:129], v[128:129], v[10:11], v[156:157] op_sel:[0,1,0] op_sel_hi:[1,1,1]
    v_pk_fma_f32 v[130:131], v[130:131], v[10:11], v[158:159] op_sel:[0,1,0] op_sel_hi:[1,1,1]
    v_pk_fma_f32 v[16:17], v[16:17], v[10:11], v[128:129] op_sel_hi:[1,0,1]
    v_pk_fma_f32 v[18:19], v[18:19], v[10:11], v[130:131] op_sel_hi:[1,0,1]
    v_exp_f32 v128, v16
    v_exp_f32 v129, v17
    v_exp_f32 v130, v18
    v_exp_f32 v131, v19
    v_pk_add_f32 v[128:129], v[128:129], 1.0 op_sel_hi:[1,0]
    v_pk_add_f32 v[130:131], v[130:131], 1.0 op_sel_hi:[1,0]
    v_rcp_f32 v128, v128
    v_rcp_f32 v129, v129
    v_rcp_f32 v130, v130
    v_rcp_f32 v131, v131
    v_pk_mul_f32 v[16:17], v[16:17], v[128:129]
    v_pk_mul_f32 v[18:19], v[18:19], v[130:131]
    v_cvt_pk_bf16_f32 v196, v16, v17
    v_cvt_pk_bf16_f32 v197, v18, v19
    v_pk_fma_f32 v[132:133], v[132:133], v[10:11], v[160:161] op_sel:[0,1,0] op_sel_hi:[1,1,1]
    v_pk_fma_f32 v[134:135], v[134:135], v[10:11], v[162:163] op_sel:[0,1,0] op_sel_hi:[1,1,1]
    v_pk_fma_f32 v[20:21], v[20:21], v[10:11], v[132:133] op_sel_hi:[1,0,1]
    v_pk_fma_f32 v[22:23], v[22:23], v[10:11], v[134:135] op_sel_hi:[1,0,1]
    v_exp_f32 v132, v20
    v_exp_f32 v133, v21
    v_exp_f32 v134, v22
    v_exp_f32 v135, v23
    v_pk_add_f32 v[132:133], v[132:133], 1.0 op_sel_hi:[1,0]
    v_pk_add_f32 v[134:135], v[134:135], 1.0 op_sel_hi:[1,0]
    v_rcp_f32 v132, v132
    v_rcp_f32 v133, v133
    v_rcp_f32 v134, v134
    v_rcp_f32 v135, v135
    v_pk_mul_f32 v[20:21], v[20:21], v[132:133]
    v_pk_mul_f32 v[22:23], v[22:23], v[134:135]
    v_cvt_pk_bf16_f32 v198, v20, v21
    v_cvt_pk_bf16_f32 v199, v22, v23
    global_store_dwordx4 v14, v[196:199], s[32:33] offset:0 sc1
    s_waitcnt vmcnt(1)
    v_cmp_ne_u32 vcc, s37, v219
    s_nop 1
    s_mov_b64 s[54:55], vcc
    s_cmp_lg_u64 s[54:55], 0
    s_cbranch_scc1 L_late_38
    global_load_dwordx4 v[48:51], v214, s[32:33] offset:-4096 sc1
    global_load_dwordx4 v[52:55], v214, s[32:33] offset:-3072 sc1
    global_load_dwordx4 v[56:59], v214, s[32:33] offset:-2048 sc1
L_late_38:
    v_cmp_lt_u32 vcc, 47, v1
    v_pk_fma_f32 v[136:137], v[136:137], v[10:11], v[164:165] op_sel:[0,1,0] op_sel_hi:[1,1,1]
    v_pk_fma_f32 v[138:139], v[138:139], v[10:11], v[166:167] op_sel:[0,1,0] op_sel_hi:[1,1,1]
    v_pk_fma_f32 v[24:25], v[24:25], v[10:11], v[136:137] op_sel_hi:[1,0,1]
    v_pk_fma_f32 v[26:27], v[26:27], v[10:11], v[138:139] op_sel_hi:[1,0,1]
    v_exp_f32 v136, v24
    v_exp_f32 v137, v25
    v_exp_f32 v138, v26
    v_exp_f32_e64 v139, v27
    v_pk_add_f32 v[136:137], v[136:137], 1.0 op_sel_hi:[1,0]
    v_pk_add_f32 v[138:139], v[138:139], 1.0 op_sel_hi:[1,0]
    v_rcp_f32 v136, v136
    v_rcp_f32 v137, v137
    v_rcp_f32 v138, v138
    v_rcp_f32 v139, v139
    v_pk_mul_f32 v[24:25], v[24:25], v[136:137]
    v_pk_mul_f32 v[26:27], v[26:27], v[138:139]
    v_cvt_pk_bf16_f32 v200, v24, v25
    v_cvt_pk_bf16_f32 v201, v26, v27
    s_cmp_lg_u64 s[54:55], 0
    s_cbranch_scc1 L_late_39
    global_load_dwordx4 v[60:63], v214, s[32:33] offset:-1024 sc1
    global_load_dwordx4 v[64:67], v214, s[32:33] offset:0 sc1
    global_load_dwordx4 v[68:71], v214, s[32:33] offset:1024 sc1
L_late_39:
    v_pk_fma_f32 v[140:141], v[140:141], v[10:11], v[168:169] op_sel:[0,1,0] op_sel_hi:[1,1,1]
    v_pk_fma_f32 v[142:143], v[142:143], v[10:11], v[170:171] op_sel:[0,1,0] op_sel_hi:[1,1,1]
    v_pk_fma_f32 v[28:29], v[28:29], v[10:11], v[140:141] op_sel_hi:[1,0,1]
    v_pk_fma_f32 v[30:31], v[30:31], v[10:11], v[142:143] op_sel_hi:[1,0,1]
    v_exp_f32 v140, v28
    v_exp_f32 v141, v29
    v_exp_f32 v142, v30
    v_exp_f32 v143, v31
    v_pk_add_f32 v[140:141], v[140:141], 1.0 op_sel_hi:[1,0]
    v_pk_add_f32 v[142:143], v[142:143], 1.0 op_sel_hi:[1,0]
    v_rcp_f32 v140, v140
    v_rcp_f32 v141, v141
    v_rcp_f32 v142, v142
    v_rcp_f32 v143, v143
    v_pk_mul_f32 v[28:29], v[28:29], v[140:141]
    v_pk_mul_f32 v[30:31], v[30:31], v[142:143]
    v_cvt_pk_bf16_f32 v202, v28, v29
    v_cvt_pk_bf16_f32 v203, v30, v31
    global_store_dwordx4 v14, v[200:203], s[32:33] offset:1024 sc1
    s_cmp_lg_u64 s[54:55], 0
    s_cbranch_scc1 L_late_40
    global_load_dwordx4 v[72:75], v214, s[32:33] offset:2048 sc1
    global_load_dwordx4 v[76:79], v214, s[32:33] offset:3072 sc1
    global_load_dwordx4 v[80:83], v215, s[32:33] offset:-4096 sc1
L_late_40:
    v_pk_fma_f32 v[144:145], v[144:145], v[10:11], v[172:173] op_sel:[0,1,0] op_sel_hi:[1,1,1]
    v_pk_fma_f32 v[146:147], v[146:147], v[10:11], v[174:175] op_sel:[0,1,0] op_sel_hi:[1,1,1]
    v_pk_fma_f32 v[32:33], v[32:33], v[10:11], v[144:145] op_sel_hi:[1,0,1]
    v_pk_fma_f32 v[34:35], v[34:35], v[10:11], v[146:147] op_sel_hi:[1,0,1]
    v_exp_f32 v144, v32
    v_exp_f32 v145, v33
    v_exp_f32 v146, v34
    v_exp_f32 v147, v35
    v_pk_add_f32 v[144:145], v[144:145], 1.0 op_sel_hi:[1,0]
    v_pk_add_f32 v[146:147], v[146:147], 1.0 op_sel_hi:[1,0]
    v_rcp_f32 v144, v144
    v_rcp_f32 v145, v145
    v_rcp_f32 v146, v146
    v_rcp_f32 v147, v147
    v_pk_mul_f32 v[32:33], v[32:33], v[144:145]
    v_pk_mul_f32 v[34:35], v[34:35], v[146:147]
    v_cvt_pk_bf16_f32 v204, v32, v33
    v_cvt_pk_bf16_f32 v205, v34, v35
    s_cmp_lg_u64 s[54:55], 0
    s_cbranch_scc1 L_late_41
    global_load_dwordx4 v[84:87], v215, s[32:33] offset:-3072 sc1
    global_load_dwordx4 v[88:91], v215, s[32:33] offset:-2048 sc1
    global_load_dwordx4 v[92:95], v215, s[32:33] offset:-1024 sc1
L_late_41:
    v_pk_fma_f32 v[148:149], v[148:149], v[10:11], v[176:177] op_sel:[0,1,0] op_sel_hi:[1,1,1]
    v_pk_fma_f32 v[150:151], v[150:151], v[10:11], v[178:179] op_sel:[0,1,0] op_sel_hi:[1,1,1]
    v_pk_fma_f32 v[36:37], v[36:37], v[10:11], v[148:149] op_sel_hi:[1,0,1]
    v_pk_fma_f32 v[38:39], v[38:39], v[10:11], v[150:151] op_sel_hi:[1,0,1]
    v_exp_f32 v148, v36
    v_exp_f32 v149, v37
    v_exp_f32 v150, v38
    v_exp_f32 v151, v39
    v_pk_add_f32 v[148:149], v[148:149], 1.0 op_sel_hi:[1,0]
    v_pk_add_f32 v[150:151], v[150:151], 1.0 op_sel_hi:[1,0]
    v_rcp_f32 v148, v148
    v_rcp_f32 v149, v149
    v_rcp_f32 v150, v150
    v_rcp_f32 v151, v151
    v_pk_mul_f32 v[36:37], v[36:37], v[148:149]
    v_pk_mul_f32 v[38:39], v[38:39], v[150:151]
    v_cvt_pk_bf16_f32 v206, v36, v37
    v_cvt_pk_bf16_f32 v207, v38, v39
    global_store_dwordx4 v14, v[204:207], s[32:33] offset:2048 sc1
    s_cmp_lg_u64 s[54:55], 0
    s_cbranch_scc1 L_late_42
    global_load_dwordx2 v[96:97], v217, s[32:33] offset:0 sc1
    global_load_dwordx2 v[98:99], v217, s[32:33] offset:512 sc1
    global_load_dwordx2 v[100:101], v217, s[32:33] offset:1024 sc1
    global_load_dwordx2 v[102:103], v217, s[32:33] offset:1536 sc1
L_late_42:
    v_pk_fma_f32 v[152:153], v[152:153], v[10:11], v[180:181] op_sel:[0,1,0] op_sel_hi:[1,1,1]
    v_pk_fma_f32 v[154:155], v[154:155], v[10:11], v[182:183] op_sel:[0,1,0] op_sel_hi:[1,1,1]
    v_pk_fma_f32 v[40:41], v[40:41], v[10:11], v[152:153] op_sel_hi:[1,0,1]
    v_pk_fma_f32 v[42:43], v[42:43], v[10:11], v[154:155] op_sel_hi:[1,0,1]
    v_exp_f32 v152, v40
    v_exp_f32 v153, v41
    v_exp_f32 v154, v42
    v_exp_f32 v155, v43
    v_pk_add_f32 v[152:153], v[152:153], 1.0 op_sel_hi:[1,0]
    v_pk_add_f32 v[154:155], v[154:155], 1.0 op_sel_hi:[1,0]
    v_rcp_f32 v152, v152
    v_rcp_f32 v153, v153
    v_rcp_f32 v154, v154
    v_rcp_f32 v155, v155
    v_pk_mul_f32 v[40:41], v[40:41], v[152:153]
    v_pk_mul_f32 v[42:43], v[42:43], v[154:155]
    v_cvt_pk_bf16_f32 v208, v40, v41
    v_cvt_pk_bf16_f32 v209, v42, v43
    v_cndmask_b32_e64 v208, v208, 0, vcc
    v_cndmask_b32_e64 v209, v209, 0, vcc
    global_store_dwordx2 v15, v[208:209], s[32:33] sc1
    s_mov_b32 s87, 0
    s_cmp_lg_u64 s[54:55], 0
    s_cbranch_scc1 L_L_g2_0_slow_43
L_L_g2_0_join_44:
    s_waitcnt vmcnt(18)
    v_mfma_f32_16x16x32_bf16 v[148:151], a[0:3], v[48:51], 0
    global_load_dwordx4 v[104:107], v212, s[32:33] offset:-4096 sc1
    v_mfma_f32_16x16x32_bf16 v[152:155], a[4:7], v[48:51], 0
    v_mfma_f32_16x16x32_bf16 v[156:159], a[8:11], v[48:51], 0
    v_mfma_f32_16x16x32_bf16 v[160:163], a[12:15], v[48:51], 0
    v_mfma_f32_16x16x32_bf16 v[164:167], a[16:19], v[48:51], 0
    s_waitcnt vmcnt(18)
    v_mfma_f32_16x16x32_bf16 v[148:151], a[20:23], v[52:55], v[148:151]
    global_load_dwordx4 v[108:111], v212, s[32:33] offset:-3072 sc1
    v_mfma_f32_16x16x32_bf16 v[152:155], a[24:27], v[52:55], v[152:155]
    s_add_u32 s61, s42, 0
    s_and_b32 s62, s34, 1
    v_mfma_f32_16x16x32_bf16 v[156:159], a[28:31], v[52:55], v[156:159]
    s_lshr_b32 s63, s34, 1
    v_and_b32_e64 v12, 7, v1
    v_mfma_f32_16x16x32_bf16 v[160:163], a[32:35], v[52:55], v[160:163]
    v_bfe_u32 v13, v1, 3, 1
    v_lshl_add_u32 v12, v12, 1, v13
    v_mfma_f32_16x16x32_bf16 v[164:167], a[36:39], v[52:55], v[164:167]
    s_lshl_b32 s44, s61, 5
    s_lshl_b32 s45, s62, 4
    s_waitcnt vmcnt(18)
    v_mfma_f32_16x16x32_bf16 v[148:151], a[40:43], v[56:59], v[148:151]
    global_load_dwordx4 v[112:115], v212, s[32:33] offset:-2048 sc1
    v_mfma_f32_16x16x32_bf16 v[152:155], a[44:47], v[56:59], v[152:155]
    s_add_u32 s44, s44, s45
    v_add_u32_e64 v12, s44, v12
    v_mfma_f32_16x16x32_bf16 v[156:159], a[48:51], v[56:59], v[156:159]
    v_lshrrev_b32 v13, 4, v1
    s_lshl_b32 s44, s41, 4
    v_mfma_f32_16x16x32_bf16 v[160:163], a[52:55], v[56:59], v[160:163]
    s_lshl_b32 s45, s63, 3
    s_add_u32 s45, s45, s44
    v_mfma_f32_16x16x32_bf16 v[164:167], a[56:59], v[56:59], v[164:167]
    v_lshl_add_u32 v14, v13, 1, s45
    v_mul_u32_u24 v14, 16512, v14
    s_waitcnt vmcnt(18)
    v_mfma_f32_16x16x32_bf16 v[148:151], a[60:63], v[60:63], v[148:151]
    global_load_dwordx4 v[116:119], v212, s[32:33] offset:-1024 sc1
    v_mfma_f32_16x16x32_bf16 v[152:155], a[64:67], v[60:63], v[152:155]
    v_lshl_add_u32 v14, v12, 3, v14
    v_add_u32 v14, 3375104, v14
    v_mfma_f32_16x16x32_bf16 v[156:159], a[68:71], v[60:63], v[156:159]
    v_add_u32 v15, 16512, v14
    s_lshl_b32 s44, s41, 2
    v_mfma_f32_16x16x32_bf16 v[160:163], a[72:75], v[60:63], v[160:163]
    s_add_u32 s44, s44, 128
    v_add_u32_e64 v10, s44, v13
    v_mfma_f32_16x16x32_bf16 v[164:167], a[76:79], v[60:63], v[164:167]
    v_mul_u32_u24 v10, 16512, v10
    v_lshl_add_u32 v10, v12, 3, v10
    s_waitcnt vmcnt(18)
    v_mfma_f32_16x16x32_bf16 v[148:151], a[80:83], v[64:67], v[148:151]
    global_load_dwordx4 v[120:123], v212, s[32:33] offset:0 sc1
    v_mfma_f32_16x16x32_bf16 v[152:155], a[84:87], v[64:67], v[152:155]
    v_add_u32 v10, 3375104, v10
    global_load_dwordx2 v[168:169], v14, s[32:33] sc1
    v_mfma_f32_16x16x32_bf16 v[156:159], a[88:91], v[64:67], v[156:159]
    global_load_dwordx2 v[170:171], v15, s[32:33] sc1
    global_load_dwordx2 v[172:173], v10, s[32:33] sc1
    v_mfma_f32_16x16x32_bf16 v[160:163], a[92:95], v[64:67], v[160:163]
    v_mul_u32_u24 v12, 1280, v12
    s_lshl_b32 s44, s41, 7
    v_mfma_f32_16x16x32_bf16 v[164:167], a[96:99], v[64:67], v[164:167]
    s_lshl_b32 s45, s63, 6
    s_add_u32 s44, s44, s45
    s_waitcnt vmcnt(21)
    v_mfma_f32_16x16x32_bf16 v[148:151], a[100:103], v[68:71], v[148:151]
    global_load_dwordx4 v[124:127], v212, s[32:33] offset:1024 sc1
    v_mfma_f32_16x16x32_bf16 v[152:155], a[104:107], v[68:71], v[152:155]
    v_lshl_add_u32 v222, v13, 4, v12
    v_mfma_f32_16x16x32_bf16 v[156:159], a[108:111], v[68:71], v[156:159]
    v_add_u32 v222, s44, v222
    v_mfma_f32_16x16x32_bf16 v[160:163], a[112:115], v[68:71], v[160:163]
    s_lshl_b32 s44, s41, 5
    v_mfma_f32_16x16x32_bf16 v[164:167], a[116:119], v[68:71], v[164:167]
    v_lshl_add_u32 v223, v13, 3, v12
    s_cmp_lg_u32 s87, 0
    s_cbranch_scc1 L_pubd_45
    s_waitcnt vmcnt(9)
    s_mov_b64 exec, 0x1
    global_store_dword v226, v227, s[32:33] sc1
    s_mov_b64 exec, -1
    s_mov_b32 s87, 1
L_pubd_45:
    s_waitcnt vmcnt(20)
    v_mfma_f32_16x16x32_bf16 v[148:151], a[120:123], v[72:75], v[148:151]
    global_load_dwordx4 v[16:19], v212, s[32:33] offset:2048 sc1
    v_mfma_f32_16x16x32_bf16 v[152:155], a[124:127], v[72:75], v[152:155]
    v_add_u32_e64 v223, s44, v223
    v_mfma_f32_16x16x32_bf16 v[156:159], a[128:131], v[72:75], v[156:159]
    s_lshl_b32 s44, s63, 7
    v_mfma_f32_16x16x32_bf16 v[160:163], a[132:135], v[72:75], v[160:163]
    s_add_u32 s44, s44, 163520
    v_mfma_f32_16x16x32_bf16 v[164:167], a[136:139], v[72:75], v[164:167]
    v_lshl_add_u32 v8, v13, 5, s44
    s_waitcnt vmcnt(20)
    v_mfma_f32_16x16x32_bf16 v[148:151], a[140:143], v[76:79], v[148:151]
    global_load_dwordx4 v[20:23], v212, s[32:33] offset:3072 sc1
    v_mfma_f32_16x16x32_bf16 v[152:155], a[144:147], v[76:79], v[152:155]
    v_lshlrev_b32_e64 v9, 4, v13
    v_mfma_f32_16x16x32_bf16 v[156:159], a[148:151], v[76:79], v[156:159]
    v_add_u32 v9, 163776, v9
    v_mfma_f32_16x16x32_bf16 v[160:163], a[152:155], v[76:79], v[160:163]
    ds_read_b128 v[184:187], v8
    v_mfma_f32_16x16x32_bf16 v[164:167], a[156:159], v[76:79], v[164:167]
    ds_read_b128 v[188:191], v8 offset:16
    s_waitcnt vmcnt(20)
    v_mfma_f32_16x16x32_bf16 v[148:151], a[160:163], v[80:83], v[148:151]
    global_load_dwordx4 v[24:27], v213, s[32:33] offset:-4096 sc1
    v_mfma_f32_16x16x32_bf16 v[152:155], a[164:167], v[80:83], v[152:155]
    ds_read_b128 v[192:195], v9
    v_mfma_f32_16x16x32_bf16 v[156:159], a[168:171], v[80:83], v[156:159]
    v_lshlrev_b32 v9, 4, v1
    v_mfma_f32_16x16x32_bf16 v[160:163], a[172:175], v[80:83], v[160:163]
    s_xor_b32 s44, s34, 1
    v_mfma_f32_16x16x32_bf16 v[164:167], a[176:179], v[80:83], v[164:167]
    s_mul_i32 s44, s44, 6144
    s_waitcnt vmcnt(20)
    v_mfma_f32_16x16x32_bf16 v[148:151], a[180:183], v[84:87], v[148:151]
    global_load_dwordx4 v[28:31], v213, s[32:33] offset:-3072 sc1
    v_mfma_f32_16x16x32_bf16 v[152:155], a[184:187], v[84:87], v[152:155]
    s_add_u32 s44, s44, 0
    v_mfma_f32_16x16x32_bf16 v[156:159], a[188:191], v[84:87], v[156:159]
    v_add_u32 v2, s44, v9
    v_mfma_f32_16x16x32_bf16 v[160:163], a[192:195], v[84:87], v[160:163]
    s_xor_b32 s44, s34, 2
    v_mfma_f32_16x16x32_bf16 v[164:167], a[196:199], v[84:87], v[164:167]
    s_mul_i32 s44, s44, 6144
    s_waitcnt vmcnt(20)
    v_mfma_f32_16x16x32_bf16 v[148:151], a[200:203], v[88:91], v[148:151]
    global_load_dwordx4 v[32:35], v213, s[32:33] offset:-2048 sc1
    v_mfma_f32_16x16x32_bf16 v[152:155], a[204:207], v[88:91], v[152:155]
    s_add_u32 s44, s44, 2048
    v_mfma_f32_16x16x32_bf16 v[156:159], a[208:211], v[88:91], v[156:159]
    v_add_u32_e64 v3, s44, v9
    v_mfma_f32_16x16x32_bf16 v[160:163], a[212:215], v[88:91], v[160:163]
    s_xor_b32 s44, s34, 3
    v_mfma_f32_16x16x32_bf16 v[164:167], a[216:219], v[88:91], v[164:167]
    s_mul_i32 s44, s44, 6144
    s_waitcnt vmcnt(20)
    v_mfma_f32_16x16x32_bf16 v[148:151], a[220:223], v[92:95], v[148:151]
    global_load_dwordx4 v[36:39], v213, s[32:33] offset:-1024 sc1
    v_mfma_f32_16x16x32_bf16 v[152:155], a[224:227], v[92:95], v[152:155]
    s_add_u32 s44, s44, 4096
    v_mfma_f32_16x16x32_bf16 v[156:159], a[228:231], v[92:95], v[156:159]
    v_add_u32_e64 v4, s44, v9
    v_mfma_f32_16x16x32_bf16 v[160:163], a[232:235], v[92:95], v[160:163]
    s_mul_i32 s44, s34, 6144
    v_mfma_f32_16x16x32_bf16 v[164:167], a[236:239], v[92:95], v[164:167]
    s_add_u32 s44, s44, 0
    s_waitcnt vmcnt(18)
    v_mfma_f32_16x16x32_bf16 v[148:151], a[240:243], v[96:99], v[148:151]
    global_load_dwordx2 v[40:41], v216, s[32:33] offset:0 sc1
    global_load_dwordx2 v[42:43], v216, s[32:33] offset:512 sc1
    v_mfma_f32_16x16x32_bf16 v[152:155], a[244:247], v[96:99], v[152:155]
    v_add_u32_e64 v5, s44, v9
    v_mfma_f32_16x16x32_bf16 v[156:159], a[248:251], v[96:99], v[156:159]
    s_lshl_b32 s44, s62, 12
    v_mfma_f32_16x16x32_bf16 v[160:163], a[252:255], v[96:99], v[160:163]
    s_add_u32 s44, s44, 24576
    v_mfma_f32_16x16x32_bf16 v[164:167], v[232:235], v[96:99], v[164:167]
    v_add_u32_e64 v8, s44, v9
    s_waitcnt vmcnt(18)
    v_mfma_f32_16x16x32_bf16 v[148:151], v[236:239], v[100:103], v[148:151]
    global_load_dwordx2 v[44:45], v216, s[32:33] offset:1024 sc1
    global_load_dwordx2 v[46:47], v216, s[32:33] offset:1536 sc1
    v_mfma_f32_16x16x32_bf16 v[152:155], v[240:243], v[100:103], v[152:155]
    s_lshl_b32 s45, s34, 10
    v_mfma_f32_16x16x32_bf16 v[156:159], v[244:247], v[100:103], v[156:159]
    v_add_u32 v6, s45, v8
    v_mfma_f32_16x16x32_bf16 v[160:163], v[248:251], v[100:103], v[160:163]
    v_xor_b32 v7, 4096, v6
    v_mfma_f32_16x16x32_bf16 v[164:167], v[252:255], v[100:103], v[164:167]
    s_waitcnt vmcnt(18)
    v_mfma_f32_16x16x32_bf16 v[128:131], a[0:3], v[104:107], 0
    v_mfma_f32_16x16x32_bf16 v[132:135], a[4:7], v[104:107], 0
    v_mfma_f32_16x16x32_bf16 v[136:139], a[8:11], v[104:107], 0
    v_mfma_f32_16x16x32_bf16 v[140:143], a[12:15], v[104:107], 0
    v_mfma_f32_16x16x32_bf16 v[144:147], a[16:19], v[104:107], 0
    s_waitcnt vmcnt(17)
    s_barrier
    v_mfma_f32_16x16x32_bf16 v[128:131], a[20:23], v[108:111], v[128:131]
    v_mfma_f32_16x16x32_bf16 v[132:135], a[24:27], v[108:111], v[132:135]
    v_add_u32 v218, 0x2000, v218
    v_mfma_f32_16x16x32_bf16 v[136:139], a[28:31], v[108:111], v[136:139]
    ds_write_b128 v2, v[148:151] offset:0
    v_mfma_f32_16x16x32_bf16 v[140:143], a[32:35], v[108:111], v[140:143]
    v_add_u32 v212, 3678208, v212
    v_mfma_f32_16x16x32_bf16 v[144:147], a[36:39], v[108:111], v[144:147]
    v_add_u32 v213, 3678208, v213
    s_waitcnt vmcnt(16)
    v_mfma_f32_16x16x32_bf16 v[128:131], a[40:43], v[112:115], v[128:131]
    v_mfma_f32_16x16x32_bf16 v[132:135], a[44:47], v[112:115], v[132:135]
    v_add_u32 v214, 3678208, v214
    v_mfma_f32_16x16x32_bf16 v[136:139], a[48:51], v[112:115], v[136:139]
    ds_write_b128 v2, v[152:155] offset:1024
    v_mfma_f32_16x16x32_bf16 v[140:143], a[52:55], v[112:115], v[140:143]
    v_add_u32 v215, 3678208, v215
    v_mfma_f32_16x16x32_bf16 v[144:147], a[56:59], v[112:115], v[144:147]
    v_add_u32 v216, 3678208, v216
    s_waitcnt vmcnt(15)
    v_mfma_f32_16x16x32_bf16 v[128:131], a[60:63], v[116:119], v[128:131]
    v_mfma_f32_16x16x32_bf16 v[132:135], a[64:67], v[116:119], v[132:135]
    v_add_u32 v217, 3678208, v217
    v_mfma_f32_16x16x32_bf16 v[136:139], a[68:71], v[116:119], v[136:139]
    ds_write_b128 v4, v[156:159] offset:0
    v_mfma_f32_16x16x32_bf16 v[140:143], a[72:75], v[116:119], v[140:143]
    v_mfma_f32_16x16x32_bf16 v[144:147], a[76:79], v[116:119], v[144:147]
    s_waitcnt vmcnt(14)
    v_mfma_f32_16x16x32_bf16 v[128:131], a[80:83], v[120:123], v[128:131]
    v_mfma_f32_16x16x32_bf16 v[132:135], a[84:87], v[120:123], v[132:135]
    v_mfma_f32_16x16x32_bf16 v[136:139], a[88:91], v[120:123], v[136:139]
    ds_write_b128 v4, v[160:163] offset:1024
    v_mfma_f32_16x16x32_bf16 v[140:143], a[92:95], v[120:123], v[140:143]
    v_mfma_f32_16x16x32_bf16 v[144:147], a[96:99], v[120:123], v[144:147]
    s_waitcnt vmcnt(10)
    v_mfma_f32_16x16x32_bf16 v[128:131], a[100:103], v[124:127], v[128:131]
    v_mfma_f32_16x16x32_bf16 v[132:135], a[104:107], v[124:127], v[132:135]
    v_mfma_f32_16x16x32_bf16 v[136:139], a[108:111], v[124:127], v[136:139]
    ds_write_b128 v7, v[164:167] offset:0
    v_mfma_f32_16x16x32_bf16 v[140:143], a[112:115], v[124:127], v[140:143]
    v_mfma_f32_16x16x32_bf16 v[144:147], a[116:119], v[124:127], v[144:147]
    s_waitcnt vmcnt(9)
    v_mfma_f32_16x16x32_bf16 v[128:131], a[120:123], v[16:19], v[128:131]
    v_mfma_f32_16x16x32_bf16 v[132:135], a[124:127], v[16:19], v[132:135]
    v_mfma_f32_16x16x32_bf16 v[136:139], a[128:131], v[16:19], v[136:139]
    v_mfma_f32_16x16x32_bf16 v[140:143], a[132:135], v[16:19], v[140:143]
    v_mfma_f32_16x16x32_bf16 v[144:147], a[136:139], v[16:19], v[144:147]
    s_waitcnt vmcnt(8)
    v_mfma_f32_16x16x32_bf16 v[128:131], a[140:143], v[20:23], v[128:131]
    v_mfma_f32_16x16x32_bf16 v[132:135], a[144:147], v[20:23], v[132:135]
    v_mfma_f32_16x16x32_bf16 v[136:139], a[148:151], v[20:23], v[136:139]
    v_mfma_f32_16x16x32_bf16 v[140:143], a[152:155], v[20:23], v[140:143]
    v_mfma_f32_16x16x32_bf16 v[144:147], a[156:159], v[20:23], v[144:147]
    s_waitcnt vmcnt(7)
    v_mfma_f32_16x16x32_bf16 v[128:131], a[160:163], v[24:27], v[128:131]
    v_mfma_f32_16x16x32_bf16 v[132:135], a[164:167], v[24:27], v[132:135]
    v_mfma_f32_16x16x32_bf16 v[136:139], a[168:171], v[24:27], v[136:139]
    v_mfma_f32_16x16x32_bf16 v[140:143], a[172:175], v[24:27], v[140:143]
    v_mfma_f32_16x16x32_bf16 v[144:147], a[176:179], v[24:27], v[144:147]
    global_load_dword v219, v218, s[32:33] sc1
    s_waitcnt vmcnt(7)
    v_mfma_f32_16x16x32_bf16 v[128:131], a[180:183], v[28:31], v[128:131]
    v_mfma_f32_16x16x32_bf16 v[132:135], a[184:187], v[28:31], v[132:135]
    v_mfma_f32_16x16x32_bf16 v[136:139], a[188:191], v[28:31], v[136:139]
    v_mfma_f32_16x16x32_bf16 v[140:143], a[192:195], v[28:31], v[140:143]
    v_mfma_f32_16x16x32_bf16 v[144:147], a[196:199], v[28:31], v[144:147]
    s_waitcnt vmcnt(1)
    v_mfma_f32_16x16x32_bf16 v[128:131], a[200:203], v[32:35], v[128:131]
    v_mfma_f32_16x16x32_bf16 v[132:135], a[204:207], v[32:35], v[132:135]
    v_mfma_f32_16x16x32_bf16 v[136:139], a[208:211], v[32:35], v[136:139]
    v_mfma_f32_16x16x32_bf16 v[140:143], a[212:215], v[32:35], v[140:143]
    v_mfma_f32_16x16x32_bf16 v[144:147], a[216:219], v[32:35], v[144:147]
    s_waitcnt vmcnt(12)
    s_waitcnt vmcnt(0)
    v_cmp_ne_u32 vcc, s37, v219
    s_nop 1
    s_mov_b64 s[54:55], vcc
    s_cmp_lg_u64 s[54:55], 0
    s_cbranch_scc1 L_late_46
    global_load_dwordx4 v[48:51], v214, s[32:33] offset:-4096 sc1
    global_load_dwordx4 v[52:55], v214, s[32:33] offset:-3072 sc1
L_late_46:
    v_mfma_f32_16x16x32_bf16 v[128:131], a[220:223], v[36:39], v[128:131]
    v_mfma_f32_16x16x32_bf16 v[132:135], a[224:227], v[36:39], v[132:135]
    v_mfma_f32_16x16x32_bf16 v[136:139], a[228:231], v[36:39], v[136:139]
    v_mfma_f32_16x16x32_bf16 v[140:143], a[232:235], v[36:39], v[140:143]
    v_mfma_f32_16x16x32_bf16 v[144:147], a[236:239], v[36:39], v[144:147]
    s_cmp_lg_u64 s[54:55], 0
    s_cbranch_scc1 L_late_47
    global_load_dwordx4 v[56:59], v214, s[32:33] offset:-2048 sc1
    global_load_dwordx4 v[60:63], v214, s[32:33] offset:-1024 sc1
L_late_47:
    v_mfma_f32_16x16x32_bf16 v[128:131], a[240:243], v[40:43], v[128:131]
    v_mfma_f32_16x16x32_bf16 v[132:135], a[244:247], v[40:43], v[132:135]
    v_mfma_f32_16x16x32_bf16 v[136:139], a[248:251], v[40:43], v[136:139]
    v_mfma_f32_16x16x32_bf16 v[140:143], a[252:255], v[40:43], v[140:143]
    v_mfma_f32_16x16x32_bf16 v[144:147], v[232:235], v[40:43], v[144:147]
    s_cmp_lg_u64 s[54:55], 0
    s_cbranch_scc1 L_late_48
    global_load_dwordx4 v[64:67], v214, s[32:33] offset:0 sc1
    global_load_dwordx4 v[68:71], v214, s[32:33] offset:1024 sc1
L_late_48:
    v_mfma_f32_16x16x32_bf16 v[128:131], v[236:239], v[44:47], v[128:131]
    v_mfma_f32_16x16x32_bf16 v[132:135], v[240:243], v[44:47], v[132:135]
    v_mfma_f32_16x16x32_bf16 v[136:139], v[244:247], v[44:47], v[136:139]
    v_mfma_f32_16x16x32_bf16 v[140:143], v[248:251], v[44:47], v[140:143]
    v_mfma_f32_16x16x32_bf16 v[144:147], v[252:255], v[44:47], v[144:147]
    s_cmp_lg_u64 s[54:55], 0
    s_cbranch_scc1 L_late_49
    global_load_dwordx4 v[72:75], v214, s[32:33] offset:2048 sc1
    global_load_dwordx4 v[76:79], v214, s[32:33] offset:3072 sc1
L_late_49:
    s_nop 3
    ds_write_b128 v3, v[136:139] offset:0
    ds_write_b128 v3, v[140:143] offset:1024
    ds_write_b128 v6, v[144:147]
    s_mov_b32 s87, 0
    s_cmp_lg_u64 s[54:55], 0
    s_cbranch_scc1 L_L_g2_1_slow_50
L_L_g2_1_join_51:
    s_waitcnt vmcnt(7)
    v_mfma_f32_16x16x32_bf16 v[148:151], a[0:3], v[48:51], 0
    global_load_dwordx4 v[80:83], v215, s[32:33] offset:-4096 sc1
    v_mfma_f32_16x16x32_bf16 v[152:155], a[4:7], v[48:51], 0
    v_mfma_f32_16x16x32_bf16 v[156:159], a[8:11], v[48:51], 0
    v_mfma_f32_16x16x32_bf16 v[160:163], a[12:15], v[48:51], 0
    v_mfma_f32_16x16x32_bf16 v[164:167], a[16:19], v[48:51], 0
    s_waitcnt vmcnt(7)
    v_mfma_f32_16x16x32_bf16 v[148:151], a[20:23], v[52:55], v[148:151]
    global_load_dwordx4 v[84:87], v215, s[32:33] offset:-3072 sc1
    v_mfma_f32_16x16x32_bf16 v[152:155], a[24:27], v[52:55], v[152:155]
    s_waitcnt lgkmcnt(0)
    s_barrier
    ds_read_b128 v[136:139], v5 offset:0
    v_mfma_f32_16x16x32_bf16 v[156:159], a[28:31], v[52:55], v[156:159]
    ds_read_b128 v[140:143], v5 offset:2048
    ds_read_b128 v[144:147], v5 offset:4096
    v_mfma_f32_16x16x32_bf16 v[160:163], a[32:35], v[52:55], v[160:163]
    ds_read_b128 v[196:199], v8 offset:0
    ds_read_b128 v[200:203], v8 offset:1024
    v_mfma_f32_16x16x32_bf16 v[164:167], a[36:39], v[52:55], v[164:167]
    ds_read_b128 v[204:207], v8 offset:2048
    ds_read_b128 v[208:211], v8 offset:3072
    s_waitcnt vmcnt(7)
    v_mfma_f32_16x16x32_bf16 v[148:151], a[40:43], v[56:59], v[148:151]
    global_load_dwordx4 v[88:91], v215, s[32:33] offset:-2048 sc1
    v_mfma_f32_16x16x32_bf16 v[152:155], a[44:47], v[56:59], v[152:155]
    s_waitcnt lgkmcnt(4)
    v_add_f32 v136, v136, v140
    v_mfma_f32_16x16x32_bf16 v[156:159], a[48:51], v[56:59], v[156:159]
    v_add_f32 v128, v128, v144
    v_add_f32 v137, v137, v141
    v_mfma_f32_16x16x32_bf16 v[160:163], a[52:55], v[56:59], v[160:163]
    v_add_f32 v129, v129, v145
    v_add_f32 v138, v138, v142
    v_mfma_f32_16x16x32_bf16 v[164:167], a[56:59], v[56:59], v[164:167]
    v_add_f32 v130, v130, v146
    v_add_f32_e64 v139, v139, v143
    s_waitcnt vmcnt(7)
    v_mfma_f32_16x16x32_bf16 v[148:151], a[60:63], v[60:63], v[148:151]
    global_load_dwordx4 v[92:95], v215, s[32:33] offset:-1024 sc1
    v_mfma_f32_16x16x32_bf16 v[152:155], a[64:67], v[60:63], v[152:155]
    v_add_f32 v131, v131, v147
    v_add_f32 v128, v128, v136
    v_mfma_f32_16x16x32_bf16 v[156:159], a[68:71], v[60:63], v[156:159]
    v_add_f32 v129, v129, v137
    v_add_f32 v130, v130, v138
    v_mfma_f32_16x16x32_bf16 v[160:163], a[72:75], v[60:63], v[160:163]
    v_add_f32_e64 v131, v131, v139
    ds_read_b128 v[136:139], v5 offset:1024
    v_mfma_f32_16x16x32_bf16 v[164:167], a[76:79], v[60:63], v[164:167]
    ds_read_b128 v[140:143], v5 offset:3072
    ds_read_b128 v[144:147], v5 offset:5120
    s_waitcnt vmcnt(7)
    v_mfma_f32_16x16x32_bf16 v[148:151], a[80:83], v[64:67], v[148:151]
    global_load_dwordx2 v[96:97], v217, s[32:33] offset:0 sc1
    global_load_dwordx2 v[98:99], v217, s[32:33] offset:512 sc1
    v_mfma_f32_16x16x32_bf16 v[152:155], a[84:87], v[64:67], v[152:155]
    v_lshlrev_b32 v12, 16, v168
    v_and_b32 v13, 0xffff0000, v168
    v_mfma_f32_16x16x32_bf16 v[156:159], a[88:91], v[64:67], v[156:159]
    v_fmac_f32 v12, v128, v184
    v_fmac_f32 v13, v129, v185
    v_mfma_f32_16x16x32_bf16 v[160:163], a[92:95], v[64:67], v[160:163]
    v_cvt_pk_bf16_f32 v174, v12, v13
    v_lshlrev_b32_e64 v12, 16, v169
    v_mfma_f32_16x16x32_bf16 v[164:167], a[96:99], v[64:67], v[164:167]
    v_and_b32 v13, 0xffff0000, v169
    v_fmac_f32 v12, v130, v186
    s_waitcnt vmcnt(8)
    v_mfma_f32_16x16x32_bf16 v[148:151], a[100:103], v[68:71], v[148:151]
    global_load_dwordx2 v[100:101], v217, s[32:33] offset:1024 sc1
    global_load_dwordx2 v[102:103], v217, s[32:33] offset:1536 sc1
    v_mfma_f32_16x16x32_bf16 v[152:155], a[104:107], v[68:71], v[152:155]
    v_fmac_f32_e64 v13, v131, v187
    v_cvt_pk_bf16_f32 v175, v12, v13
    v_mfma_f32_16x16x32_bf16 v[156:159], a[108:111], v[68:71], v[156:159]
    s_waitcnt lgkmcnt(3)
    v_add_f32 v200, v200, v204
    v_mfma_f32_16x16x32_bf16 v[160:163], a[112:115], v[68:71], v[160:163]
    v_add_f32 v196, v196, v208
    v_add_f32 v201, v201, v205
    v_mfma_f32_16x16x32_bf16 v[164:167], a[116:119], v[68:71], v[164:167]
    v_add_f32 v197, v197, v209
    v_add_f32_e64 v202, v202, v206
    s_waitcnt vmcnt(9)
    v_mfma_f32_16x16x32_bf16 v[148:151], a[120:123], v[72:75], v[148:151]
    global_load_dwordx4 v[104:107], v212, s[32:33] offset:-4096 sc1
    v_mfma_f32_16x16x32_bf16 v[152:155], a[124:127], v[72:75], v[152:155]
    v_add_f32 v198, v198, v210
    v_add_f32 v203, v203, v207
    v_mfma_f32_16x16x32_bf16 v[156:159], a[128:131], v[72:75], v[156:159]
    v_add_f32 v199, v199, v211
    v_add_f32 v196, v196, v200
    v_mfma_f32_16x16x32_bf16 v[160:163], a[132:135], v[72:75], v[160:163]
    v_add_f32 v197, v197, v201
    v_add_f32 v198, v198, v202
    v_mfma_f32_16x16x32_bf16 v[164:167], a[136:139], v[72:75], v[164:167]
    v_add_f32 v199, v199, v203
    v_lshlrev_b32_e64 v12, 16, v172
    s_waitcnt vmcnt(9)
    v_mfma_f32_16x16x32_bf16 v[148:151], a[140:143], v[76:79], v[148:151]
    global_load_dwordx4 v[108:111], v212, s[32:33] offset:-3072 sc1
    v_mfma_f32_16x16x32_bf16 v[152:155], a[144:147], v[76:79], v[152:155]
    v_and_b32 v13, 0xffff0000, v172
    v_fmac_f32_e64 v12, v196, v192
    v_mfma_f32_16x16x32_bf16 v[156:159], a[148:151], v[76:79], v[156:159]
    v_fmac_f32_e64 v13, v197, v193
    v_cvt_pk_bf16_f32 v178, v12, v13
    v_mfma_f32_16x16x32_bf16 v[160:163], a[152:155], v[76:79], v[160:163]
    v_lshlrev_b32_e64 v12, 16, v173
    v_and_b32 v13, 0xffff0000, v173
    v_mfma_f32_16x16x32_bf16 v[164:167], a[156:159], v[76:79], v[164:167]
    v_fmac_f32 v12, v198, v194
    v_fmac_f32_e64 v13, v199, v195
    s_waitcnt vmcnt(9)
    v_mfma_f32_16x16x32_bf16 v[148:151], a[160:163], v[80:83], v[148:151]
    global_load_dwordx4 v[112:115], v212, s[32:33] offset:-2048 sc1
    v_mfma_f32_16x16x32_bf16 v[152:155], a[164:167], v[80:83], v[152:155]
    v_cvt_pk_bf16_f32 v179, v12, v13
    s_waitcnt lgkmcnt(0)
    v_mfma_f32_16x16x32_bf16 v[156:159], a[168:171], v[80:83], v[156:159]
    v_add_f32 v136, v136, v140
    v_add_f32_e64 v132, v132, v144
    v_mfma_f32_16x16x32_bf16 v[160:163], a[172:175], v[80:83], v[160:163]
    v_add_f32 v137, v137, v141
    v_add_f32 v133, v133, v145
    v_mfma_f32_16x16x32_bf16 v[164:167], a[176:179], v[80:83], v[164:167]
    v_add_f32 v138, v138, v142
    v_add_f32_e64 v134, v134, v146
    s_waitcnt vmcnt(9)
    v_mfma_f32_16x16x32_bf16 v[148:151], a[180:183], v[84:87], v[148:151]
    global_load_dwordx4 v[116:119], v212, s[32:33] offset:-1024 sc1
    v_mfma_f32_16x16x32_bf16 v[152:155], a[184:187], v[84:87], v[152:155]
    v_add_f32 v139, v139, v143
    v_add_f32 v135, v135, v147
    v_mfma_f32_16x16x32_bf16 v[156:159], a[188:191], v[84:87], v[156:159]
    v_add_f32 v132, v132, v136
    v_add_f32 v133, v133, v137
    v_mfma_f32_16x16x32_bf16 v[160:163], a[192:195], v[84:87], v[160:163]
    v_add_f32 v134, v134, v138
    v_add_f32 v135, v135, v139
    v_mfma_f32_16x16x32_bf16 v[164:167], a[196:199], v[84:87], v[164:167]
    v_lshlrev_b32_e64 v12, 16, v170
    v_and_b32 v13, 0xffff0000, v170
    s_waitcnt vmcnt(9)
    v_mfma_f32_16x16x32_bf16 v[148:151], a[200:203], v[88:91], v[148:151]
    global_load_dwordx4 v[120:123], v212, s[32:33] offset:0 sc1
    v_mfma_f32_16x16x32_bf16 v[152:155], a[204:207], v[88:91], v[152:155]
    v_fmac_f32 v12, v132, v188
    v_fmac_f32_e64 v13, v133, v189
    v_mfma_f32_16x16x32_bf16 v[156:159], a[208:211], v[88:91], v[156:159]
    v_cvt_pk_bf16_f32 v176, v12, v13
    v_lshlrev_b32_e64 v12, 16, v171
    v_mfma_f32_16x16x32_bf16 v[160:163], a[212:215], v[88:91], v[160:163]
    v_and_b32 v13, 0xffff0000, v171
    v_fmac_f32_e64 v12, v134, v190
    v_mfma_f32_16x16x32_bf16 v[164:167], a[216:219], v[88:91], v[164:167]
    v_fmac_f32_e64 v13, v135, v191
    v_cvt_pk_bf16_f32 v177, v12, v13
    s_waitcnt vmcnt(9)
    v_mfma_f32_16x16x32_bf16 v[148:151], a[220:223], v[92:95], v[148:151]
    global_load_dwordx4 v[124:127], v212, s[32:33] offset:1024 sc1
    v_mfma_f32_16x16x32_bf16 v[152:155], a[224:227], v[92:95], v[152:155]
    v_add_u32 v14, 8192, v14
    v_add_u32 v15, 8192, v15
    v_mfma_f32_16x16x32_bf16 v[156:159], a[228:231], v[92:95], v[156:159]
    v_add_u32 v10, 8192, v10
    global_load_dwordx2 v[168:169], v14, s[32:33] sc1
    v_mfma_f32_16x16x32_bf16 v[160:163], a[232:235], v[92:95], v[160:163]
    global_load_dwordx2 v[170:171], v15, s[32:33] sc1
    global_load_dwordx2 v[172:173], v10, s[32:33] sc1
    v_mfma_f32_16x16x32_bf16 v[164:167], a[236:239], v[92:95], v[164:167]
    s_waitcnt vmcnt(11)
    v_mfma_f32_16x16x32_bf16 v[148:151], a[240:243], v[96:99], v[148:151]
    global_load_dwordx4 v[16:19], v212, s[32:33] offset:2048 sc1
    v_mfma_f32_16x16x32_bf16 v[152:155], a[244:247], v[96:99], v[152:155]
    v_mfma_f32_16x16x32_bf16 v[156:159], a[248:251], v[96:99], v[156:159]
    v_mfma_f32_16x16x32_bf16 v[160:163], a[252:255], v[96:99], v[160:163]
    v_mfma_f32_16x16x32_bf16 v[164:167], v[232:235], v[96:99], v[164:167]
    s_waitcnt vmcnt(10)
    v_mfma_f32_16x16x32_bf16 v[148:151], v[236:239], v[100:103], v[148:151]
    global_load_dwordx4 v[20:23], v212, s[32:33] offset:3072 sc1
    v_mfma_f32_16x16x32_bf16 v[152:155], v[240:243], v[100:103], v[152:155]
    v_mfma_f32_16x16x32_bf16 v[156:159], v[244:247], v[100:103], v[156:159]
    v_mfma_f32_16x16x32_bf16 v[160:163], v[248:251], v[100:103], v[160:163]
    v_mfma_f32_16x16x32_bf16 v[164:167], v[252:255], v[100:103], v[164:167]
    s_waitcnt vmcnt(10)
    v_mfma_f32_16x16x32_bf16 v[128:131], a[0:3], v[104:107], 0
    global_load_dwordx4 v[24:27], v213, s[32:33] offset:-4096 sc1
    v_mfma_f32_16x16x32_bf16 v[132:135], a[4:7], v[104:107], 0
    v_mfma_f32_16x16x32_bf16 v[136:139], a[8:11], v[104:107], 0
    v_mfma_f32_16x16x32_bf16 v[140:143], a[12:15], v[104:107], 0
    v_mfma_f32_16x16x32_bf16 v[144:147], a[16:19], v[104:107], 0
    s_waitcnt vmcnt(10)
    s_barrier
    v_mfma_f32_16x16x32_bf16 v[128:131], a[20:23], v[108:111], v[128:131]
    global_load_dwordx4 v[28:31], v213, s[32:33] offset:-3072 sc1
    v_mfma_f32_16x16x32_bf16 v[132:135], a[24:27], v[108:111], v[132:135]
    v_mfma_f32_16x16x32_bf16 v[136:139], a[28:31], v[108:111], v[136:139]
    ds_write_b128 v2, v[148:151] offset:0
    v_mfma_f32_16x16x32_bf16 v[140:143], a[32:35], v[108:111], v[140:143]
    v_mfma_f32_16x16x32_bf16 v[144:147], a[36:39], v[108:111], v[144:147]
    s_waitcnt vmcnt(10)
    v_mfma_f32_16x16x32_bf16 v[128:131], a[40:43], v[112:115], v[128:131]
    global_load_dwordx4 v[32:35], v213, s[32:33] offset:-2048 sc1
    v_mfma_f32_16x16x32_bf16 v[132:135], a[44:47], v[112:115], v[132:135]
    v_mfma_f32_16x16x32_bf16 v[136:139], a[48:51], v[112:115], v[136:139]
    ds_write_b128 v2, v[152:155] offset:1024
    v_mfma_f32_16x16x32_bf16 v[140:143], a[52:55], v[112:115], v[140:143]
    v_mfma_f32_16x16x32_bf16 v[144:147], a[56:59], v[112:115], v[144:147]
    s_waitcnt vmcnt(10)
    v_mfma_f32_16x16x32_bf16 v[128:131], a[60:63], v[116:119], v[128:131]
    global_load_dwordx4 v[36:39], v213, s[32:33] offset:-1024 sc1
    v_mfma_f32_16x16x32_bf16 v[132:135], a[64:67], v[116:119], v[132:135]
    v_mfma_f32_16x16x32_bf16 v[136:139], a[68:71], v[116:119], v[136:139]
    ds_write_b128 v4, v[156:159] offset:0
    v_mfma_f32_16x16x32_bf16 v[140:143], a[72:75], v[116:119], v[140:143]
    v_mfma_f32_16x16x32_bf16 v[144:147], a[76:79], v[116:119], v[144:147]
    s_waitcnt vmcnt(10)
    v_mfma_f32_16x16x32_bf16 v[128:131], a[80:83], v[120:123], v[128:131]
    global_load_dwordx2 v[40:41], v216, s[32:33] offset:0 sc1
    global_load_dwordx2 v[42:43], v216, s[32:33] offset:512 sc1
    v_mfma_f32_16x16x32_bf16 v[132:135], a[84:87], v[120:123], v[132:135]
    v_mfma_f32_16x16x32_bf16 v[136:139], a[88:91], v[120:123], v[136:139]
    ds_write_b128 v4, v[160:163] offset:1024
    v_mfma_f32_16x16x32_bf16 v[140:143], a[92:95], v[120:123], v[140:143]
    v_mfma_f32_16x16x32_bf16 v[144:147], a[96:99], v[120:123], v[144:147]
    s_waitcnt vmcnt(11)
    v_mfma_f32_16x16x32_bf16 v[128:131], a[100:103], v[124:127], v[128:131]
    global_load_dwordx2 v[44:45], v216, s[32:33] offset:1024 sc1
    global_load_dwordx2 v[46:47], v216, s[32:33] offset:1536 sc1
    v_mfma_f32_16x16x32_bf16 v[132:135], a[104:107], v[124:127], v[132:135]
    v_mfma_f32_16x16x32_bf16 v[136:139], a[108:111], v[124:127], v[136:139]
    ds_write_b128 v7, v[164:167] offset:0
    v_mfma_f32_16x16x32_bf16 v[140:143], a[112:115], v[124:127], v[140:143]
    v_mfma_f32_16x16x32_bf16 v[144:147], a[116:119], v[124:127], v[144:147]
    s_waitcnt vmcnt(9)
    v_mfma_f32_16x16x32_bf16 v[128:131], a[120:123], v[16:19], v[128:131]
    v_mfma_f32_16x16x32_bf16 v[132:135], a[124:127], v[16:19], v[132:135]
    v_mfma_f32_16x16x32_bf16 v[136:139], a[128:131], v[16:19], v[136:139]
    v_mfma_f32_16x16x32_bf16 v[140:143], a[132:135], v[16:19], v[140:143]
    v_mfma_f32_16x16x32_bf16 v[144:147], a[136:139], v[16:19], v[144:147]
    global_store_dwordx4 v222, v[174:177], s[28:29] sc1
    global_store_dwordx2 v223, v[178:179], s[28:29] offset:1024 sc1
    v_add_u32 v222, 1310720, v222
    v_add_u32 v223, 1310720, v223
    s_waitcnt vmcnt(10)
    v_mfma_f32_16x16x32_bf16 v[128:131], a[140:143], v[20:23], v[128:131]
    v_mfma_f32_16x16x32_bf16 v[132:135], a[144:147], v[20:23], v[132:135]
    v_mfma_f32_16x16x32_bf16 v[136:139], a[148:151], v[20:23], v[136:139]
    v_mfma_f32_16x16x32_bf16 v[140:143], a[152:155], v[20:23], v[140:143]
    v_mfma_f32_16x16x32_bf16 v[144:147], a[156:159], v[20:23], v[144:147]
    s_waitcnt vmcnt(9)
    v_mfma_f32_16x16x32_bf16 v[128:131], a[160:163], v[24:27], v[128:131]
    v_mfma_f32_16x16x32_bf16 v[132:135], a[164:167], v[24:27], v[132:135]
    v_mfma_f32_16x16x32_bf16 v[136:139], a[168:171], v[24:27], v[136:139]
    v_mfma_f32_16x16x32_bf16 v[140:143], a[172:175], v[24:27], v[140:143]
    v_mfma_f32_16x16x32_bf16 v[144:147], a[176:179], v[24:27], v[144:147]
    s_or_b32 s44, s2, s34
    s_cmp_lg_u32 s44, 0
    s_cbranch_scc1 L_noep_52
    v_lshlrev_b32_e64 v220, 7, v1
    v_add_u32 v220, 155648, v220
    global_load_dwordx4 v[48:51], v220, s[32:33] offset:0 sc1
    global_load_dwordx4 v[52:55], v220, s[32:33] offset:16 sc1
    global_load_dwordx4 v[56:59], v220, s[32:33] offset:32 sc1
    global_load_dwordx4 v[60:63], v220, s[32:33] offset:48 sc1
L_noep_52:
    s_waitcnt vmcnt(8)
    v_mfma_f32_16x16x32_bf16 v[128:131], a[180:183], v[28:31], v[128:131]
    v_mfma_f32_16x16x32_bf16 v[132:135], a[184:187], v[28:31], v[132:135]
    v_mfma_f32_16x16x32_bf16 v[136:139], a[188:191], v[28:31], v[136:139]
    v_mfma_f32_16x16x32_bf16 v[140:143], a[192:195], v[28:31], v[140:143]
    v_mfma_f32_16x16x32_bf16 v[144:147], a[196:199], v[28:31], v[144:147]
    s_waitcnt vmcnt(7)
    v_mfma_f32_16x16x32_bf16 v[128:131], a[200:203], v[32:35], v[128:131]
    v_mfma_f32_16x16x32_bf16 v[132:135], a[204:207], v[32:35], v[132:135]
    v_mfma_f32_16x16x32_bf16 v[136:139], a[208:211], v[32:35], v[136:139]
    v_mfma_f32_16x16x32_bf16 v[140:143], a[212:215], v[32:35], v[140:143]
    v_mfma_f32_16x16x32_bf16 v[144:147], a[216:219], v[32:35], v[144:147]
    s_waitcnt vmcnt(6)
    v_mfma_f32_16x16x32_bf16 v[128:131], a[220:223], v[36:39], v[128:131]
    v_mfma_f32_16x16x32_bf16 v[132:135], a[224:227], v[36:39], v[132:135]
    v_mfma_f32_16x16x32_bf16 v[136:139], a[228:231], v[36:39], v[136:139]
    v_mfma_f32_16x16x32_bf16 v[140:143], a[232:235], v[36:39], v[140:143]
    v_mfma_f32_16x16x32_bf16 v[144:147], a[236:239], v[36:39], v[144:147]
    s_waitcnt vmcnt(4)
    v_mfma_f32_16x16x32_bf16 v[128:131], a[240:243], v[40:43], v[128:131]
    v_mfma_f32_16x16x32_bf16 v[132:135], a[244:247], v[40:43], v[132:135]
    v_mfma_f32_16x16x32_bf16 v[136:139], a[248:251], v[40:43], v[136:139]
    v_mfma_f32_16x16x32_bf16 v[140:143], a[252:255], v[40:43], v[140:143]
    v_mfma_f32_16x16x32_bf16 v[144:147], v[232:235], v[40:43], v[144:147]
    s_waitcnt vmcnt(2)
    v_mfma_f32_16x16x32_bf16 v[128:131], v[236:239], v[44:47], v[128:131]
    v_mfma_f32_16x16x32_bf16 v[132:135], v[240:243], v[44:47], v[132:135]
    v_mfma_f32_16x16x32_bf16 v[136:139], v[244:247], v[44:47], v[136:139]
    v_mfma_f32_16x16x32_bf16 v[140:143], v[248:251], v[44:47], v[140:143]
    v_mfma_f32_16x16x32_bf16 v[144:147], v[252:255], v[44:47], v[144:147]
    s_nop 5
    ds_write_b128 v3, v[136:139] offset:0
    ds_write_b128 v3, v[140:143] offset:1024
    ds_write_b128 v6, v[144:147]
    s_waitcnt vmcnt(12)
    s_waitcnt lgkmcnt(0)
    s_barrier
    ds_read_b128 v[136:139], v5 offset:0
    ds_read_b128 v[140:143], v5 offset:2048
    ds_read_b128 v[144:147], v5 offset:4096
    ds_read_b128 v[148:151], v5 offset:1024
    ds_read_b128 v[152:155], v5 offset:3072
    ds_read_b128 v[156:159], v5 offset:5120
    ds_read_b128 v[196:199], v8 offset:0
    ds_read_b128 v[200:203], v8 offset:1024
    ds_read_b128 v[204:207], v8 offset:2048
    ds_read_b128 v[208:211], v8 offset:3072
    s_waitcnt lgkmcnt(7)
    v_pk_add_f32 v[128:129], v[128:129], v[136:137]
    v_pk_add_f32 v[140:141], v[140:141], v[144:145]
    v_pk_add_f32 v[130:131], v[130:131], v[138:139]
    v_pk_add_f32 v[142:143], v[142:143], v[146:147]
    v_lshlrev_b32_e64 v136, 16, v168
    v_and_b32 v137, 0xffff0000, v168
    v_pk_add_f32 v[128:129], v[128:129], v[140:141]
    v_lshlrev_b32_e64 v138, 16, v169
    v_and_b32 v139, 0xffff0000, v169
    v_pk_add_f32 v[130:131], v[130:131], v[142:143]
    v_pk_fma_f32 v[128:129], v[128:129], v[184:185], v[136:137]
    v_pk_fma_f32 v[130:131], v[130:131], v[186:187], v[138:139]
    v_cvt_pk_bf16_f32 v160, v128, v129
    v_cvt_pk_bf16_f32 v161, v130, v131
    s_waitcnt lgkmcnt(4)
    v_pk_add_f32 v[132:133], v[132:133], v[148:149]
    v_pk_add_f32 v[152:153], v[152:153], v[156:157]
    v_pk_add_f32 v[134:135], v[134:135], v[150:151]
    v_pk_add_f32 v[154:155], v[154:155], v[158:159]
    v_lshlrev_b32 v148, 16, v170
    v_and_b32 v149, 0xffff0000, v170
    v_pk_add_f32 v[132:133], v[132:133], v[152:153]
    v_lshlrev_b32_e64 v150, 16, v171
    v_and_b32 v151, 0xffff0000, v171
    v_pk_add_f32 v[134:135], v[134:135], v[154:155]
    v_pk_fma_f32 v[132:133], v[132:133], v[188:189], v[148:149]
    v_pk_fma_f32 v[134:135], v[134:135], v[190:191], v[150:151]
    v_cvt_pk_bf16_f32 v162, v132, v133
    v_cvt_pk_bf16_f32 v163, v134, v135
    global_store_dwordx4 v222, v[160:163], s[28:29] sc1
    s_waitcnt lgkmcnt(0)
    v_pk_add_f32 v[196:197], v[196:197], v[200:201]
    v_pk_add_f32 v[204:205], v[204:205], v[208:209]
    v_pk_add_f32 v[198:199], v[198:199], v[202:203]
    v_pk_add_f32 v[206:207], v[206:207], v[210:211]
    v_lshlrev_b32 v200, 16, v172
    v_and_b32 v201, 0xffff0000, v172
    v_pk_add_f32 v[196:197], v[196:197], v[204:205]
    v_lshlrev_b32_e64 v202, 16, v173
    v_and_b32 v203, 0xffff0000, v173
    v_pk_add_f32 v[198:199], v[198:199], v[206:207]
    v_pk_fma_f32 v[196:197], v[196:197], v[192:193], v[200:201]
    v_pk_fma_f32 v[198:199], v[198:199], v[194:195], v[202:203]
    v_cvt_pk_bf16_f32 v164, v196, v197
    v_cvt_pk_bf16_f32 v165, v198, v199
    s_cmp_ge_u32 s34, 2
    s_cbranch_scc1 L_no4_53
    global_store_dwordx2 v223, v[164:165], s[28:29] offset:1024 sc1
L_no4_53:
    s_or_b32 s44, s2, s34
    s_cmp_lg_u32 s44, 0
    s_cbranch_scc1 L_noadv_54
    s_waitcnt vmcnt(2)
    v_xor_b32_e64 v224, s37, v48
    v_bitop3_b32 v224, v224, v49, s37 bitop3:0xf6
    v_bitop3_b32 v224, v224, v50, s37 bitop3:0xf6
    v_bitop3_b32 v224, v224, v51, s37 bitop3:0xf6
    v_bitop3_b32 v224, v224, v52, s37 bitop3:0xf6
    v_bitop3_b32 v224, v224, v53, s37 bitop3:0xf6
    v_bitop3_b32 v224, v224, v54, s37 bitop3:0xf6
    v_bitop3_b32 v224, v224, v55, s37 bitop3:0xf6
    v_bitop3_b32 v224, v224, v56, s37 bitop3:0xf6
    v_bitop3_b32 v224, v224, v57, s37 bitop3:0xf6
    v_bitop3_b32 v224, v224, v58, s37 bitop3:0xf6
    v_bitop3_b32 v224, v224, v59, s37 bitop3:0xf6
    v_bitop3_b32 v224, v224, v60, s37 bitop3:0xf6
    v_bitop3_b32 v224, v224, v61, s37 bitop3:0xf6
    v_bitop3_b32 v224, v224, v62, s37 bitop3:0xf6
    v_bitop3_b32 v224, v224, v63, s37 bitop3:0xf6
    v_cmp_ne_u32 vcc, 0, v224
    s_nop 1
    s_cbranch_vccnz L_ep_retry_55
L_ep_back_56:
    v_mov_b32 v16, 0
    v_mov_b32 v17, s37
    s_mov_b64 exec, 0x1
    global_store_dword v16, v17, s[32:33] sc1
    s_mov_b64 exec, -1
L_noadv_54:
L_end:
L_exit:
    s_endpgm
L_aux:
    s_sub_u32 s38, s2, 160
    s_sub_u32 s59, s38, 60
    s_sub_u32 s44, s38, 16
    s_cmp_ge_u32 s38, 76
    s_cselect_b32 s44, s44, 0xff
    s_cmp_lt_u32 s38, 60
    s_cselect_b32 s61, s38, s44
    s_mov_b32 s80, s20
    s_and_b32 s81, s21, 0xffff
    s_mov_b32 s82, 2211840
    s_mov_b32 s83, 0x20000
    v_and_b32 v12, 3, v1
    v_bfe_u32 v13, v1, 2, 2
    v_lshrrev_b32_e64 v14, 4, v1
    s_cmp_ge_u32 s38, 60
    s_cbranch_scc1 L_aux_w2_57
    s_lshl_b32 s44, s38, 2
    s_add_u32 s44, s44, s34
    s_mul_i32 s45, s44, 1093
    s_lshr_b32 s45, s45, 16
    s_mul_i32 s46, s45, 60
    s_sub_u32 s46, s44, s46
    s_mul_i32 s47, s45, 160
    v_lshrrev_b32_e64 v2, 3, v1
    s_lshl_b32 s48, s47, 1
    v_lshl_add_u32 v3, v1, 2, s48
    global_load_dword v6, v3, s[24:25]
    v_min_u32_e64 v4, 15, v1
    v_lshl_add_u32 v3, v4, 2, s48
    global_load_dword v8, v3, s[24:25] offset:256
    v_add_u32_e64 v2, s47, v2
    v_mul_u32_u24 v2, 7680, v2
    v_and_b32_e64 v3, 7, v1
    v_lshl_add_u32 v2, v3, 4, v2
    s_lshl_b32 s47, s46, 7
    v_add_u32 v2, s47, v2
    global_load_dwordx4 v[100:103], v2, s[26:27]
    v_add_u32 v2, 61440, v2
    global_load_dwordx4 v[104:107], v2, s[26:27]
    v_add_u32 v2, 61440, v2
    global_load_dwordx4 v[108:111], v2, s[26:27]
    v_add_u32 v2, 61440, v2
    global_load_dwordx4 v[112:115], v2, s[26:27]
    v_add_u32 v2, 61440, v2
    global_load_dwordx4 v[116:119], v2, s[26:27]
    v_add_u32 v2, 61440, v2
    global_load_dwordx4 v[120:123], v2, s[26:27]
    v_add_u32 v2, 61440, v2
    global_load_dwordx4 v[124:127], v2, s[26:27]
    v_add_u32 v2, 61440, v2
    global_load_dwordx4 v[128:131], v2, s[26:27]
    v_add_u32 v2, 61440, v2
    global_load_dwordx4 v[132:135], v2, s[26:27]
    v_add_u32 v2, 61440, v2
    global_load_dwordx4 v[136:139], v2, s[26:27]
    v_add_u32 v2, 61440, v2
    global_load_dwordx4 v[140:143], v2, s[26:27]
    v_add_u32 v2, 61440, v2
    global_load_dwordx4 v[144:147], v2, s[26:27]
    v_add_u32 v2, 61440, v2
    global_load_dwordx4 v[148:151], v2, s[26:27]
    v_add_u32 v2, 61440, v2
    global_load_dwordx4 v[152:155], v2, s[26:27]
    v_add_u32 v2, 61440, v2
    global_load_dwordx4 v[156:159], v2, s[26:27]
    v_add_u32 v2, 61440, v2
    global_load_dwordx4 v[160:163], v2, s[26:27]
    v_add_u32 v2, 61440, v2
    global_load_dwordx4 v[164:167], v2, s[26:27]
    v_add_u32 v2, 61440, v2
    global_load_dwordx4 v[168:171], v2, s[26:27]
    v_add_u32 v2, 61440, v2
    global_load_dwordx4 v[172:175], v2, s[26:27]
    v_add_u32 v2, 61440, v2
    global_load_dwordx4 v[176:179], v2, s[26:27]
    s_mul_i32 s45, s45, 30720
    s_lshl_b32 s46, s46, 9
    s_add_u32 s45, s45, s46
    s_add_u32 s58, s45, 311296
    s_waitcnt vmcnt(20)
    v_and_b32 v7, 0xffff0000, v6
    v_lshlrev_b32 v6, 16, v6
    v_and_b32 v9, 0xffff0000, v8
    v_lshlrev_b32_e64 v8, 16, v8
    v_mul_f32 v2, 0xbfb8aa3b, v6
    v_mul_f32 v3, 0xbfb8aa3b, v7
    v_mul_f32 v4, 0xbfb8aa3b, v8
    v_mul_f32 v5, 0xbfb8aa3b, v9
    v_exp_f32 v2, v2
    v_exp_f32 v3, v3
    v_exp_f32 v4, v4
    v_exp_f32 v5, v5
    v_add_f32 v2, 1.0, v2
    v_add_f32 v3, 1.0, v3
    v_add_f32 v4, 1.0, v4
    v_add_f32 v5, 1.0, v5
    v_rcp_f32 v2, v2
    v_rcp_f32 v3, v3
    v_rcp_f32 v4, v4
    v_rcp_f32 v5, v5
    v_mul_f32 v6, v6, v2
    v_mul_f32 v7, v7, v3
    v_mul_f32 v8, v8, v4
    v_mul_f32 v9, v9, v5
    v_cvt_pk_bf16_f32 v6, v6, v7
    v_cvt_pk_bf16_f32 v8, v8, v9
    v_lshrrev_b32 v2, 4, v1
    v_lshlrev_b32 v2, 2, v2
    v_bfe_u32 v3, v1, 3, 1
    v_lshlrev_b32 v3, 4, v3
    v_sub_u32 v3, 16, v3
    ds_bpermute_b32 v184, v2, v6 offset:0
    ds_bpermute_b32 v185, v2, v6 offset:16
    ds_bpermute_b32 v186, v2, v6 offset:32
    ds_bpermute_b32 v187, v2, v6 offset:48
    ds_bpermute_b32 v188, v2, v6 offset:64
    ds_bpermute_b32 v189, v2, v6 offset:80
    ds_bpermute_b32 v190, v2, v6 offset:96
    ds_bpermute_b32 v191, v2, v6 offset:112
    ds_bpermute_b32 v192, v2, v6 offset:128
    ds_bpermute_b32 v193, v2, v6 offset:144
    ds_bpermute_b32 v194, v2, v6 offset:160
    ds_bpermute_b32 v195, v2, v6 offset:176
    ds_bpermute_b32 v196, v2, v6 offset:192
    ds_bpermute_b32 v197, v2, v6 offset:208
    ds_bpermute_b32 v198, v2, v6 offset:224
    ds_bpermute_b32 v199, v2, v6 offset:240
    ds_bpermute_b32 v200, v2, v8 offset:0
    ds_bpermute_b32 v201, v2, v8 offset:16
    ds_bpermute_b32 v202, v2, v8 offset:32
    ds_bpermute_b32 v203, v2, v8 offset:48
    s_waitcnt lgkmcnt(0)
    s_mul_i32 s37, s37, 0x9E3779B1
    s_add_u32 s37, s37, 0x7F4A7C15
    s_add_u32 s60, s37, 20
    v_lshlrev_b32_e64 v184, v3, v184
    v_and_b32 v184, 0xffff0000, v184
    v_lshlrev_b32_e64 v185, v3, v185
    v_and_b32 v185, 0xffff0000, v185
    v_lshlrev_b32_e64 v186, v3, v186
    v_and_b32 v186, 0xffff0000, v186
    v_lshlrev_b32_e64 v187, v3, v187
    v_and_b32 v187, 0xffff0000, v187
    v_lshlrev_b32_e64 v188, v3, v188
    v_and_b32 v188, 0xffff0000, v188
    v_lshlrev_b32_e64 v189, v3, v189
    v_and_b32 v189, 0xffff0000, v189
    v_lshlrev_b32_e64 v190, v3, v190
    v_and_b32 v190, 0xffff0000, v190
    v_lshlrev_b32_e64 v191, v3, v191
    v_and_b32 v191, 0xffff0000, v191
    v_lshlrev_b32_e64 v192, v3, v192
    v_and_b32 v192, 0xffff0000, v192
    v_lshlrev_b32_e64 v193, v3, v193
    v_and_b32 v193, 0xffff0000, v193
    v_lshlrev_b32_e64 v194, v3, v194
    v_and_b32 v194, 0xffff0000, v194
    v_lshlrev_b32_e64 v195, v3, v195
    v_and_b32 v195, 0xffff0000, v195
    v_lshlrev_b32_e64 v196, v3, v196
    v_and_b32 v196, 0xffff0000, v196
    v_lshlrev_b32_e64 v197, v3, v197
    v_and_b32 v197, 0xffff0000, v197
    v_lshlrev_b32_e64 v198, v3, v198
    v_and_b32 v198, 0xffff0000, v198
    v_lshlrev_b32_e64 v199, v3, v199
    v_and_b32 v199, 0xffff0000, v199
    v_lshlrev_b32_e64 v200, v3, v200
    v_and_b32 v200, 0xffff0000, v200
    v_lshlrev_b32_e64 v201, v3, v201
    v_and_b32 v201, 0xffff0000, v201
    v_lshlrev_b32_e64 v202, v3, v202
    v_and_b32 v202, 0xffff0000, v202
    v_lshlrev_b32_e64 v203, v3, v203
    v_and_b32 v203, 0xffff0000, v203
    s_waitcnt vmcnt(19)
    v_lshlrev_b32 v2, 16, v100
    v_and_b32 v3, 0xffff0000, v100
    v_pk_mul_f32 v[208:209], v[2:3], v[184:185] op_sel_hi:[1,0]
    v_lshlrev_b32_e64 v2, 16, v101
    v_and_b32 v3, 0xffff0000, v101
    v_pk_mul_f32 v[210:211], v[2:3], v[184:185] op_sel_hi:[1,0]
    v_lshlrev_b32_e64 v2, 16, v102
    v_and_b32 v3, 0xffff0000, v102
    v_pk_mul_f32 v[212:213], v[2:3], v[184:185] op_sel_hi:[1,0]
    v_lshlrev_b32_e64 v2, 16, v103
    v_and_b32 v3, 0xffff0000, v103
    v_pk_mul_f32 v[214:215], v[2:3], v[184:185] op_sel_hi:[1,0]
    s_waitcnt vmcnt(18)
    v_lshlrev_b32 v2, 16, v104
    v_and_b32 v3, 0xffff0000, v104
    v_pk_fma_f32 v[208:209], v[2:3], v[184:185], v[208:209] op_sel:[0,1,0] op_sel_hi:[1,1,1]
    v_lshlrev_b32_e64 v2, 16, v105
    v_and_b32 v3, 0xffff0000, v105
    v_pk_fma_f32 v[210:211], v[2:3], v[184:185], v[210:211] op_sel:[0,1,0] op_sel_hi:[1,1,1]
    v_lshlrev_b32_e64 v2, 16, v106
    v_and_b32 v3, 0xffff0000, v106
    v_pk_fma_f32 v[212:213], v[2:3], v[184:185], v[212:213] op_sel:[0,1,0] op_sel_hi:[1,1,1]
    v_lshlrev_b32_e64 v2, 16, v107
    v_and_b32 v3, 0xffff0000, v107
    v_pk_fma_f32 v[214:215], v[2:3], v[184:185], v[214:215] op_sel:[0,1,0] op_sel_hi:[1,1,1]
    s_waitcnt vmcnt(17)
    v_lshlrev_b32 v2, 16, v108
    v_and_b32 v3, 0xffff0000, v108
    v_pk_fma_f32 v[208:209], v[2:3], v[186:187], v[208:209] op_sel:[0,0,0] op_sel_hi:[1,0,1]
    v_lshlrev_b32_e64 v2, 16, v109
    v_and_b32 v3, 0xffff0000, v109
    v_pk_fma_f32 v[210:211], v[2:3], v[186:187], v[210:211] op_sel:[0,0,0] op_sel_hi:[1,0,1]
    v_lshlrev_b32_e64 v2, 16, v110
    v_and_b32 v3, 0xffff0000, v110
    v_pk_fma_f32 v[212:213], v[2:3], v[186:187], v[212:213] op_sel:[0,0,0] op_sel_hi:[1,0,1]
    v_lshlrev_b32_e64 v2, 16, v111
    v_and_b32 v3, 0xffff0000, v111
    v_pk_fma_f32 v[214:215], v[2:3], v[186:187], v[214:215] op_sel:[0,0,0] op_sel_hi:[1,0,1]
    s_waitcnt vmcnt(16)
    v_lshlrev_b32 v2, 16, v112
    v_and_b32 v3, 0xffff0000, v112
    v_pk_fma_f32 v[208:209], v[2:3], v[186:187], v[208:209] op_sel:[0,1,0] op_sel_hi:[1,1,1]
    v_lshlrev_b32_e64 v2, 16, v113
    v_and_b32 v3, 0xffff0000, v113
    v_pk_fma_f32 v[210:211], v[2:3], v[186:187], v[210:211] op_sel:[0,1,0] op_sel_hi:[1,1,1]
    v_lshlrev_b32_e64 v2, 16, v114
    v_and_b32 v3, 0xffff0000, v114
    v_pk_fma_f32 v[212:213], v[2:3], v[186:187], v[212:213] op_sel:[0,1,0] op_sel_hi:[1,1,1]
    v_lshlrev_b32_e64 v2, 16, v115
    v_and_b32 v3, 0xffff0000, v115
    v_pk_fma_f32 v[214:215], v[2:3], v[186:187], v[214:215] op_sel:[0,1,0] op_sel_hi:[1,1,1]
    s_waitcnt vmcnt(15)
    v_lshlrev_b32 v2, 16, v116
    v_and_b32 v3, 0xffff0000, v116
    v_pk_fma_f32 v[208:209], v[2:3], v[188:189], v[208:209] op_sel:[0,0,0] op_sel_hi:[1,0,1]
    v_lshlrev_b32_e64 v2, 16, v117
    v_and_b32 v3, 0xffff0000, v117
    v_pk_fma_f32 v[210:211], v[2:3], v[188:189], v[210:211] op_sel:[0,0,0] op_sel_hi:[1,0,1]
    v_lshlrev_b32_e64 v2, 16, v118
    v_and_b32 v3, 0xffff0000, v118
    v_pk_fma_f32 v[212:213], v[2:3], v[188:189], v[212:213] op_sel:[0,0,0] op_sel_hi:[1,0,1]
    v_lshlrev_b32_e64 v2, 16, v119
    v_and_b32 v3, 0xffff0000, v119
    v_pk_fma_f32 v[214:215], v[2:3], v[188:189], v[214:215] op_sel:[0,0,0] op_sel_hi:[1,0,1]
    s_waitcnt vmcnt(14)
    v_lshlrev_b32 v2, 16, v120
    v_and_b32 v3, 0xffff0000, v120
    v_pk_fma_f32 v[208:209], v[2:3], v[188:189], v[208:209] op_sel:[0,1,0] op_sel_hi:[1,1,1]
    v_lshlrev_b32_e64 v2, 16, v121
    v_and_b32 v3, 0xffff0000, v121
    v_pk_fma_f32 v[210:211], v[2:3], v[188:189], v[210:211] op_sel:[0,1,0] op_sel_hi:[1,1,1]
    v_lshlrev_b32_e64 v2, 16, v122
    v_and_b32 v3, 0xffff0000, v122
    v_pk_fma_f32 v[212:213], v[2:3], v[188:189], v[212:213] op_sel:[0,1,0] op_sel_hi:[1,1,1]
    v_lshlrev_b32_e64 v2, 16, v123
    v_and_b32 v3, 0xffff0000, v123
    v_pk_fma_f32 v[214:215], v[2:3], v[188:189], v[214:215] op_sel:[0,1,0] op_sel_hi:[1,1,1]
    s_waitcnt vmcnt(13)
    v_lshlrev_b32 v2, 16, v124
    v_and_b32 v3, 0xffff0000, v124
    v_pk_fma_f32 v[208:209], v[2:3], v[190:191], v[208:209] op_sel:[0,0,0] op_sel_hi:[1,0,1]
    v_lshlrev_b32_e64 v2, 16, v125
    v_and_b32 v3, 0xffff0000, v125
    v_pk_fma_f32 v[210:211], v[2:3], v[190:191], v[210:211] op_sel:[0,0,0] op_sel_hi:[1,0,1]
    v_lshlrev_b32_e64 v2, 16, v126
    v_and_b32 v3, 0xffff0000, v126
    v_pk_fma_f32 v[212:213], v[2:3], v[190:191], v[212:213] op_sel:[0,0,0] op_sel_hi:[1,0,1]
    v_lshlrev_b32_e64 v2, 16, v127
    v_and_b32 v3, 0xffff0000, v127
    v_pk_fma_f32 v[214:215], v[2:3], v[190:191], v[214:215] op_sel:[0,0,0] op_sel_hi:[1,0,1]
    s_waitcnt vmcnt(12)
    v_lshlrev_b32 v2, 16, v128
    v_and_b32 v3, 0xffff0000, v128
    v_pk_fma_f32 v[208:209], v[2:3], v[190:191], v[208:209] op_sel:[0,1,0] op_sel_hi:[1,1,1]
    v_lshlrev_b32_e64 v2, 16, v129
    v_and_b32 v3, 0xffff0000, v129
    v_pk_fma_f32 v[210:211], v[2:3], v[190:191], v[210:211] op_sel:[0,1,0] op_sel_hi:[1,1,1]
    v_lshlrev_b32_e64 v2, 16, v130
    v_and_b32 v3, 0xffff0000, v130
    v_pk_fma_f32 v[212:213], v[2:3], v[190:191], v[212:213] op_sel:[0,1,0] op_sel_hi:[1,1,1]
    v_lshlrev_b32_e64 v2, 16, v131
    v_and_b32 v3, 0xffff0000, v131
    v_pk_fma_f32 v[214:215], v[2:3], v[190:191], v[214:215] op_sel:[0,1,0] op_sel_hi:[1,1,1]
    s_waitcnt vmcnt(11)
    v_lshlrev_b32 v2, 16, v132
    v_and_b32 v3, 0xffff0000, v132
    v_pk_fma_f32 v[208:209], v[2:3], v[192:193], v[208:209] op_sel:[0,0,0] op_sel_hi:[1,0,1]
    v_lshlrev_b32_e64 v2, 16, v133
    v_and_b32 v3, 0xffff0000, v133
    v_pk_fma_f32 v[210:211], v[2:3], v[192:193], v[210:211] op_sel:[0,0,0] op_sel_hi:[1,0,1]
    v_lshlrev_b32_e64 v2, 16, v134
    v_and_b32 v3, 0xffff0000, v134
    v_pk_fma_f32 v[212:213], v[2:3], v[192:193], v[212:213] op_sel:[0,0,0] op_sel_hi:[1,0,1]
    v_lshlrev_b32_e64 v2, 16, v135
    v_and_b32 v3, 0xffff0000, v135
    v_pk_fma_f32 v[214:215], v[2:3], v[192:193], v[214:215] op_sel:[0,0,0] op_sel_hi:[1,0,1]
    s_waitcnt vmcnt(10)
    v_lshlrev_b32 v2, 16, v136
    v_and_b32 v3, 0xffff0000, v136
    v_pk_fma_f32 v[208:209], v[2:3], v[192:193], v[208:209] op_sel:[0,1,0] op_sel_hi:[1,1,1]
    v_lshlrev_b32_e64 v2, 16, v137
    v_and_b32 v3, 0xffff0000, v137
    v_pk_fma_f32 v[210:211], v[2:3], v[192:193], v[210:211] op_sel:[0,1,0] op_sel_hi:[1,1,1]
    v_lshlrev_b32_e64 v2, 16, v138
    v_and_b32 v3, 0xffff0000, v138
    v_pk_fma_f32 v[212:213], v[2:3], v[192:193], v[212:213] op_sel:[0,1,0] op_sel_hi:[1,1,1]
    v_lshlrev_b32_e64 v2, 16, v139
    v_and_b32 v3, 0xffff0000, v139
    v_pk_fma_f32 v[214:215], v[2:3], v[192:193], v[214:215] op_sel:[0,1,0] op_sel_hi:[1,1,1]
    s_waitcnt vmcnt(9)
    v_lshlrev_b32 v2, 16, v140
    v_and_b32 v3, 0xffff0000, v140
    v_pk_fma_f32 v[208:209], v[2:3], v[194:195], v[208:209] op_sel:[0,0,0] op_sel_hi:[1,0,1]
    v_lshlrev_b32_e64 v2, 16, v141
    v_and_b32 v3, 0xffff0000, v141
    v_pk_fma_f32 v[210:211], v[2:3], v[194:195], v[210:211] op_sel:[0,0,0] op_sel_hi:[1,0,1]
    v_lshlrev_b32_e64 v2, 16, v142
    v_and_b32 v3, 0xffff0000, v142
    v_pk_fma_f32 v[212:213], v[2:3], v[194:195], v[212:213] op_sel:[0,0,0] op_sel_hi:[1,0,1]
    v_lshlrev_b32_e64 v2, 16, v143
    v_and_b32 v3, 0xffff0000, v143
    v_pk_fma_f32 v[214:215], v[2:3], v[194:195], v[214:215] op_sel:[0,0,0] op_sel_hi:[1,0,1]
    s_waitcnt vmcnt(8)
    v_lshlrev_b32 v2, 16, v144
    v_and_b32 v3, 0xffff0000, v144
    v_pk_fma_f32 v[208:209], v[2:3], v[194:195], v[208:209] op_sel:[0,1,0] op_sel_hi:[1,1,1]
    v_lshlrev_b32_e64 v2, 16, v145
    v_and_b32 v3, 0xffff0000, v145
    v_pk_fma_f32 v[210:211], v[2:3], v[194:195], v[210:211] op_sel:[0,1,0] op_sel_hi:[1,1,1]
    v_lshlrev_b32_e64 v2, 16, v146
    v_and_b32 v3, 0xffff0000, v146
    v_pk_fma_f32 v[212:213], v[2:3], v[194:195], v[212:213] op_sel:[0,1,0] op_sel_hi:[1,1,1]
    v_lshlrev_b32_e64 v2, 16, v147
    v_and_b32 v3, 0xffff0000, v147
    v_pk_fma_f32 v[214:215], v[2:3], v[194:195], v[214:215] op_sel:[0,1,0] op_sel_hi:[1,1,1]
    s_waitcnt vmcnt(7)
    v_lshlrev_b32 v2, 16, v148
    v_and_b32 v3, 0xffff0000, v148
    v_pk_fma_f32 v[208:209], v[2:3], v[196:197], v[208:209] op_sel:[0,0,0] op_sel_hi:[1,0,1]
    v_lshlrev_b32_e64 v2, 16, v149
    v_and_b32 v3, 0xffff0000, v149
    v_pk_fma_f32 v[210:211], v[2:3], v[196:197], v[210:211] op_sel:[0,0,0] op_sel_hi:[1,0,1]
    v_lshlrev_b32_e64 v2, 16, v150
    v_and_b32 v3, 0xffff0000, v150
    v_pk_fma_f32 v[212:213], v[2:3], v[196:197], v[212:213] op_sel:[0,0,0] op_sel_hi:[1,0,1]
    v_lshlrev_b32_e64 v2, 16, v151
    v_and_b32 v3, 0xffff0000, v151
    v_pk_fma_f32 v[214:215], v[2:3], v[196:197], v[214:215] op_sel:[0,0,0] op_sel_hi:[1,0,1]
    s_waitcnt vmcnt(6)
    v_lshlrev_b32 v2, 16, v152
    v_and_b32 v3, 0xffff0000, v152
    v_pk_fma_f32 v[208:209], v[2:3], v[196:197], v[208:209] op_sel:[0,1,0] op_sel_hi:[1,1,1]
    v_lshlrev_b32_e64 v2, 16, v153
    v_and_b32 v3, 0xffff0000, v153
    v_pk_fma_f32 v[210:211], v[2:3], v[196:197], v[210:211] op_sel:[0,1,0] op_sel_hi:[1,1,1]
    v_lshlrev_b32_e64 v2, 16, v154
    v_and_b32 v3, 0xffff0000, v154
    v_pk_fma_f32 v[212:213], v[2:3], v[196:197], v[212:213] op_sel:[0,1,0] op_sel_hi:[1,1,1]
    v_lshlrev_b32_e64 v2, 16, v155
    v_and_b32 v3, 0xffff0000, v155
    v_pk_fma_f32 v[214:215], v[2:3], v[196:197], v[214:215] op_sel:[0,1,0] op_sel_hi:[1,1,1]
    s_waitcnt vmcnt(5)
    v_lshlrev_b32 v2, 16, v156
    v_and_b32 v3, 0xffff0000, v156
    v_pk_fma_f32 v[208:209], v[2:3], v[198:199], v[208:209] op_sel:[0,0,0] op_sel_hi:[1,0,1]
    v_lshlrev_b32_e64 v2, 16, v157
    v_and_b32 v3, 0xffff0000, v157
    v_pk_fma_f32 v[210:211], v[2:3], v[198:199], v[210:211] op_sel:[0,0,0] op_sel_hi:[1,0,1]
    v_lshlrev_b32_e64 v2, 16, v158
    v_and_b32 v3, 0xffff0000, v158
    v_pk_fma_f32 v[212:213], v[2:3], v[198:199], v[212:213] op_sel:[0,0,0] op_sel_hi:[1,0,1]
    v_lshlrev_b32_e64 v2, 16, v159
    v_and_b32 v3, 0xffff0000, v159
    v_pk_fma_f32 v[214:215], v[2:3], v[198:199], v[214:215] op_sel:[0,0,0] op_sel_hi:[1,0,1]
    s_waitcnt vmcnt(4)
    v_lshlrev_b32 v2, 16, v160
    v_and_b32 v3, 0xffff0000, v160
    v_pk_fma_f32 v[208:209], v[2:3], v[198:199], v[208:209] op_sel:[0,1,0] op_sel_hi:[1,1,1]
    v_lshlrev_b32_e64 v2, 16, v161
    v_and_b32 v3, 0xffff0000, v161
    v_pk_fma_f32 v[210:211], v[2:3], v[198:199], v[210:211] op_sel:[0,1,0] op_sel_hi:[1,1,1]
    v_lshlrev_b32_e64 v2, 16, v162
    v_and_b32 v3, 0xffff0000, v162
    v_pk_fma_f32 v[212:213], v[2:3], v[198:199], v[212:213] op_sel:[0,1,0] op_sel_hi:[1,1,1]
    v_lshlrev_b32_e64 v2, 16, v163
    v_and_b32 v3, 0xffff0000, v163
    v_pk_fma_f32 v[214:215], v[2:3], v[198:199], v[214:215] op_sel:[0,1,0] op_sel_hi:[1,1,1]
    s_waitcnt vmcnt(3)
    v_lshlrev_b32 v2, 16, v164
    v_and_b32 v3, 0xffff0000, v164
    v_pk_fma_f32 v[208:209], v[2:3], v[200:201], v[208:209] op_sel:[0,0,0] op_sel_hi:[1,0,1]
    v_lshlrev_b32_e64 v2, 16, v165
    v_and_b32 v3, 0xffff0000, v165
    v_pk_fma_f32 v[210:211], v[2:3], v[200:201], v[210:211] op_sel:[0,0,0] op_sel_hi:[1,0,1]
    v_lshlrev_b32_e64 v2, 16, v166
    v_and_b32 v3, 0xffff0000, v166
    v_pk_fma_f32 v[212:213], v[2:3], v[200:201], v[212:213] op_sel:[0,0,0] op_sel_hi:[1,0,1]
    v_lshlrev_b32_e64 v2, 16, v167
    v_and_b32 v3, 0xffff0000, v167
    v_pk_fma_f32 v[214:215], v[2:3], v[200:201], v[214:215] op_sel:[0,0,0] op_sel_hi:[1,0,1]
    s_waitcnt vmcnt(2)
    v_lshlrev_b32 v2, 16, v168
    v_and_b32 v3, 0xffff0000, v168
    v_pk_fma_f32 v[208:209], v[2:3], v[200:201], v[208:209] op_sel:[0,1,0] op_sel_hi:[1,1,1]
    v_lshlrev_b32_e64 v2, 16, v169
    v_and_b32 v3, 0xffff0000, v169
    v_pk_fma_f32 v[210:211], v[2:3], v[200:201], v[210:211] op_sel:[0,1,0] op_sel_hi:[1,1,1]
    v_lshlrev_b32_e64 v2, 16, v170
    v_and_b32 v3, 0xffff0000, v170
    v_pk_fma_f32 v[212:213], v[2:3], v[200:201], v[212:213] op_sel:[0,1,0] op_sel_hi:[1,1,1]
    v_lshlrev_b32_e64 v2, 16, v171
    v_and_b32 v3, 0xffff0000, v171
    v_pk_fma_f32 v[214:215], v[2:3], v[200:201], v[214:215] op_sel:[0,1,0] op_sel_hi:[1,1,1]
    s_waitcnt vmcnt(1)
    v_lshlrev_b32 v2, 16, v172
    v_and_b32 v3, 0xffff0000, v172
    v_pk_fma_f32 v[208:209], v[2:3], v[202:203], v[208:209] op_sel:[0,0,0] op_sel_hi:[1,0,1]
    v_lshlrev_b32_e64 v2, 16, v173
    v_and_b32 v3, 0xffff0000, v173
    v_pk_fma_f32 v[210:211], v[2:3], v[202:203], v[210:211] op_sel:[0,0,0] op_sel_hi:[1,0,1]
    v_lshlrev_b32_e64 v2, 16, v174
    v_and_b32 v3, 0xffff0000, v174
    v_pk_fma_f32 v[212:213], v[2:3], v[202:203], v[212:213] op_sel:[0,0,0] op_sel_hi:[1,0,1]
    v_lshlrev_b32_e64 v2, 16, v175
    v_and_b32 v3, 0xffff0000, v175
    v_pk_fma_f32 v[214:215], v[2:3], v[202:203], v[214:215] op_sel:[0,0,0] op_sel_hi:[1,0,1]
    s_waitcnt vmcnt(0)
    v_lshlrev_b32 v2, 16, v176
    v_and_b32 v3, 0xffff0000, v176
    v_pk_fma_f32 v[208:209], v[2:3], v[202:203], v[208:209] op_sel:[0,1,0] op_sel_hi:[1,1,1]
    v_lshlrev_b32_e64 v2, 16, v177
    v_and_b32 v3, 0xffff0000, v177
    v_pk_fma_f32 v[210:211], v[2:3], v[202:203], v[210:211] op_sel:[0,1,0] op_sel_hi:[1,1,1]
    v_lshlrev_b32_e64 v2, 16, v178
    v_and_b32 v3, 0xffff0000, v178
    v_pk_fma_f32 v[212:213], v[2:3], v[202:203], v[212:213] op_sel:[0,1,0] op_sel_hi:[1,1,1]
    v_lshlrev_b32_e64 v2, 16, v179
    v_and_b32 v3, 0xffff0000, v179
    v_pk_fma_f32 v[214:215], v[2:3], v[202:203], v[214:215] op_sel:[0,1,0] op_sel_hi:[1,1,1]
    v_permlane32_swap_b32 v208, v212
    v_permlane32_swap_b32 v209, v213
    v_permlane32_swap_b32 v210, v214
    v_permlane32_swap_b32 v211, v215
    v_add_f32 v208, v208, v212
    v_add_f32 v209, v209, v213
    v_add_f32 v210, v210, v214
    v_add_f32 v211, v211, v215
    s_nop 0
    v_permlane16_swap_b32 v208, v210
    v_permlane16_swap_b32 v209, v211
    v_add_f32 v208, v208, v210
    v_add_f32 v209, v209, v211
    s_nop 0
    v_add_f32_dpp v4, v208, v208 row_ror:8 row_mask:0xf bank_mask:0x3
    s_nop 1
    v_add_f32_dpp v4, v209, v209 row_ror:8 row_mask:0xf bank_mask:0xc
    v_mov_b32 v5, s37
    v_lshl_add_u32 v2, v1, 3, s58
    global_store_dwordx2 v2, v[4:5], s[32:33] sc1
    s_and_b32 s44, s61, 15
    s_mul_i32 s44, s44, 216
    s_lshr_b32 s45, s61, 4
    s_lshl_b32 s45, s45, 2
    s_add_u32 s45, s45, s34
    s_mul_i32 s45, s45, 110592
    s_add_u32 s45, s45, s44
    s_mul_i32 s46, s34, 7168
    v_add_u32 v2, 0, v1
    v_mul_u32_u24 v3, 4682, v2
    v_lshrrev_b32 v3, 16, v3
    v_mul_u32_u24 v4, 14, v3
    v_sub_u32_e64 v2, v2, v4
    v_mul_u32_u24 v3, 3456, v3
    v_lshl_add_u32 v2, v2, 4, v3
    s_add_u32 m0, s46, 81920
    s_nop 0
    buffer_load_dwordx4 v2, s[80:83], s45 offen lds
    v_add_u32 v2, 64, v1
    v_mul_u32_u24 v3, 4682, v2
    v_lshrrev_b32 v3, 16, v3
    v_mul_u32_u24 v4, 14, v3
    v_sub_u32_e64 v2, v2, v4
    v_mul_u32_u24 v3, 3456, v3
    v_lshl_add_u32 v2, v2, 4, v3
    s_add_u32 m0, s46, 82944
    s_nop 0
    buffer_load_dwordx4 v2, s[80:83], s45 offen lds
    v_add_u32 v2, 128, v1
    v_mul_u32_u24 v3, 4682, v2
    v_lshrrev_b32 v3, 16, v3
    v_mul_u32_u24 v4, 14, v3
    v_sub_u32 v2, v2, v4
    v_mul_u32_u24 v3, 3456, v3
    v_lshl_add_u32 v2, v2, 4, v3
    s_add_u32 m0, s46, 83968
    s_nop 0
    buffer_load_dwordx4 v2, s[80:83], s45 offen lds
    v_add_u32 v2, 192, v1
    v_mul_u32_u24 v3, 4682, v2
    v_lshrrev_b32 v3, 16, v3
    v_mul_u32_u24 v4, 14, v3
    v_sub_u32 v2, v2, v4
    v_mul_u32_u24 v3, 3456, v3
    v_lshl_add_u32 v2, v2, 4, v3
    s_add_u32 m0, s46, 84992
    s_nop 0
    buffer_load_dwordx4 v2, s[80:83], s45 offen lds
    v_add_u32 v2, 256, v1
    v_mul_u32_u24 v3, 4682, v2
    v_lshrrev_b32 v3, 16, v3
    v_mul_u32_u24 v4, 14, v3
    v_sub_u32 v2, v2, v4
    v_mul_u32_u24 v3, 3456, v3
    v_lshl_add_u32 v2, v2, 4, v3
    s_add_u32 m0, s46, 86016
    s_nop 0
    buffer_load_dwordx4 v2, s[80:83], s45 offen lds
    v_add_u32 v2, 320, v1
    v_mul_u32_u24 v3, 4682, v2
    v_lshrrev_b32 v3, 16, v3
    v_mul_u32_u24 v4, 14, v3
    v_sub_u32 v2, v2, v4
    v_mul_u32_u24 v3, 3456, v3
    v_lshl_add_u32 v2, v2, 4, v3
    s_add_u32 m0, s46, 87040
    s_nop 0
    buffer_load_dwordx4 v2, s[80:83], s45 offen lds
    v_add_u32 v2, 384, v1
    v_mul_u32_u24 v3, 4682, v2
    v_lshrrev_b32 v3, 16, v3
    v_mul_u32_u24 v4, 14, v3
    v_sub_u32 v2, v2, v4
    v_mul_u32_u24 v3, 3456, v3
    v_lshl_add_u32 v2, v2, 4, v3
    s_add_u32 m0, s46, 88064
    s_nop 0
    buffer_load_dwordx4 v2, s[80:83], s45 offen lds
    s_branch L_aux_j_58
L_aux_w2_57:
    v_mov_b32_e64 v3, 0
    v_mul_u32_u24 v4, 80, v3
    v_sub_u32 v2, v1, v4
    v_add_u32 v2, 0, v2
    v_lshlrev_b32 v4, 2, v3
    v_xor_b32 v2, v2, v4
    v_mul_u32_u24 v3, 1280, v3
    v_lshl_add_u32 v2, v2, 4, v3
    v_add_u32 v20, 256, v2
    v_cmp_le_u32 vcc, 16, v1
    s_nop 1
    v_cndmask_b32_e64 v3, 0, 1, vcc
    v_mul_u32_u24 v4, 80, v3
    v_sub_u32 v2, v1, v4
    v_add_u32 v2, 64, v2
    v_lshlrev_b32 v4, 2, v3
    v_xor_b32 v2, v2, v4
    v_mul_u32_u24 v3, 1280, v3
    v_lshl_add_u32 v2, v2, 4, v3
    v_add_u32 v21, -768, v2
    v_cmp_le_u32 vcc, 32, v1
    s_nop 1
    v_cndmask_b32_e64 v3, 1, 2, vcc
    v_mul_u32_u24 v4, 80, v3
    v_sub_u32_e64 v2, v1, v4
    v_add_u32 v2, 128, v2
    v_lshlrev_b32 v4, 2, v3
    v_xor_b32 v2, v2, v4
    v_mul_u32_u24 v3, 1280, v3
    v_lshl_add_u32 v2, v2, 4, v3
    v_add_u32 v22, -1792, v2
    v_cmp_le_u32 vcc, 48, v1
    s_nop 1
    v_cndmask_b32_e64 v3, 2, 3, vcc
    v_mul_u32_u24 v4, 80, v3
    v_sub_u32_e64 v2, v1, v4
    v_add_u32 v2, 192, v2
    v_lshlrev_b32 v4, 2, v3
    v_xor_b32 v2, v2, v4
    v_mul_u32_u24 v3, 1280, v3
    v_lshl_add_u32 v2, v2, 4, v3
    v_add_u32 v23, -2816, v2
    v_cmp_le_u32 vcc, 64, v1
    v_mov_b32 v3, 3
    v_mul_u32_u24 v4, 80, v3
    v_sub_u32_e64 v2, v1, v4
    v_add_u32 v2, 256, v2
    v_lshlrev_b32 v4, 2, v3
    v_xor_b32 v2, v2, v4
    v_mul_u32_u24 v3, 1280, v3
    v_lshl_add_u32 v2, v2, 4, v3
    v_add_u32 v24, 256, v2
    s_mov_b32 s62, s59
    s_mov_b32 s63, 0
L_raw2_59:
    s_and_b32 s47, s62, 3
    s_lshr_b32 s46, s62, 2
    s_mul_i32 s45, s47, 12
    s_add_u32 s45, s45, s46
    s_lshl_b32 s58, s47, 1
    s_add_u32 s58, s58, s46
    s_add_u32 s58, s58, 36
    s_cmp_lt_u32 s46, 12
    s_cselect_b32 s58, s45, s58
    s_mul_i32 s45, s58, 43
    s_lshr_b32 s45, s45, 7
    s_mul_i32 s46, s45, 3
    s_sub_u32 s46, s58, s46
    s_mul_i32 s45, s45, 108
    s_lshl_b32 s46, s46, 5
    s_add_u32 s48, s45, s46
    s_add_u32 s49, s48, 16
    s_sub_u32 s45, s58, 48
    s_mul_i32 s45, s45, 216
    s_add_u32 s45, s45, 96
    s_add_u32 s46, s45, 108
    s_cmp_ge_u32 s58, 48
    s_cselect_b32 s48, s45, s48
    s_cselect_b32 s49, s46, s49
    s_cselect_b32 s50, 2, 3
    s_lshl_b32 s51, s34, 1
    s_add_u32 s44, s51, 0
    s_and_b32 s45, s44, 3
    s_min_u32 s45, s45, s50
    s_lshl_b32 s45, s45, 2
    s_cmp_ge_u32 s44, 4
    s_cselect_b32 s46, s49, s48
    s_add_u32 s45, s45, s46
    s_mul_i32 s45, s45, 1280
    s_add_u32 s52, s22, s45
    s_addc_u32 s53, s23, 0
    s_sub_u32 s52, s52, 256
    s_subb_u32 s53, s53, 0
    s_mul_i32 s44, s44, 5120
    s_add_u32 m0, s44, s63
    s_nop 0
    global_load_lds_dwordx4 v20, s[52:53] offset:0
    global_load_lds_dwordx4 v21, s[52:53] offset:1024
    global_load_lds_dwordx4 v22, s[52:53] offset:2048
    global_load_lds_dwordx4 v23, s[52:53] offset:3072
    s_add_u32 m0, m0, 4096
    s_nop 0
    global_load_lds_dwordx4 v24, s[52:53] offset:0
    s_add_u32 s44, s51, 1
    s_and_b32 s45, s44, 3
    s_min_u32 s45, s45, s50
    s_lshl_b32 s45, s45, 2
    s_cmp_ge_u32 s44, 4
    s_cselect_b32 s46, s49, s48
    s_add_u32 s45, s45, s46
    s_mul_i32 s45, s45, 1280
    s_add_u32 s52, s22, s45
    s_addc_u32 s53, s23, 0
    s_sub_u32 s52, s52, 256
    s_subb_u32 s53, s53, 0
    s_mul_i32 s44, s44, 5120
    s_add_u32 m0, s44, s63
    s_nop 0
    global_load_lds_dwordx4 v20, s[52:53] offset:0
    global_load_lds_dwordx4 v21, s[52:53] offset:1024
    global_load_lds_dwordx4 v22, s[52:53] offset:2048
    global_load_lds_dwordx4 v23, s[52:53] offset:3072
    s_add_u32 m0, m0, 4096
    s_nop 0
    global_load_lds_dwordx4 v24, s[52:53] offset:0
    s_cmp_lt_u32 s62, 36
    s_cselect_b32 s44, 36, 16
    s_add_u32 s62, s62, s44
    s_cmp_lt_u32 s59, 16
    s_cselect_b32 s62, s62, 64
    s_add_u32 s63, s63, 40960
    s_cmp_lt_u32 s62, 56
    s_cbranch_scc1 L_raw2_59
    s_cmp_eq_u32 s61, 0xff
    s_cbranch_scc1 L_rawdone_61
    s_and_b32 s44, s61, 15
    s_mul_i32 s44, s44, 216
    s_lshr_b32 s45, s61, 4
    s_lshl_b32 s45, s45, 2
    s_add_u32 s45, s45, s34
    s_mul_i32 s45, s45, 110592
    s_add_u32 s45, s45, s44
    s_mul_i32 s46, s34, 7168
    v_add_u32 v2, 0, v1
    v_mul_u32_u24 v3, 4682, v2
    v_lshrrev_b32 v3, 16, v3
    v_mul_u32_u24 v4, 14, v3
    v_sub_u32_e64 v2, v2, v4
    v_mul_u32_u24 v3, 3456, v3
    v_lshl_add_u32 v2, v2, 4, v3
    s_add_u32 m0, s46, 81920
    s_nop 0
    buffer_load_dwordx4 v2, s[80:83], s45 offen lds
    v_add_u32 v2, 64, v1
    v_mul_u32_u24 v3, 4682, v2
    v_lshrrev_b32 v3, 16, v3
    v_mul_u32_u24 v4, 14, v3
    v_sub_u32_e64 v2, v2, v4
    v_mul_u32_u24 v3, 3456, v3
    v_lshl_add_u32 v2, v2, 4, v3
    s_add_u32 m0, s46, 82944
    s_nop 0
    buffer_load_dwordx4 v2, s[80:83], s45 offen lds
    v_add_u32 v2, 128, v1
    v_mul_u32_u24 v3, 4682, v2
    v_lshrrev_b32 v3, 16, v3
    v_mul_u32_u24 v4, 14, v3
    v_sub_u32 v2, v2, v4
    v_mul_u32_u24 v3, 3456, v3
    v_lshl_add_u32 v2, v2, 4, v3
    s_add_u32 m0, s46, 83968
    s_nop 0
    buffer_load_dwordx4 v2, s[80:83], s45 offen lds
    v_add_u32 v2, 192, v1
    v_mul_u32_u24 v3, 4682, v2
    v_lshrrev_b32 v3, 16, v3
    v_mul_u32_u24 v4, 14, v3
    v_sub_u32 v2, v2, v4
    v_mul_u32_u24 v3, 3456, v3
    v_lshl_add_u32 v2, v2, 4, v3
    s_add_u32 m0, s46, 84992
    s_nop 0
    buffer_load_dwordx4 v2, s[80:83], s45 offen lds
    v_add_u32 v2, 256, v1
    v_mul_u32_u24 v3, 4682, v2
    v_lshrrev_b32 v3, 16, v3
    v_mul_u32_u24 v4, 14, v3
    v_sub_u32 v2, v2, v4
    v_mul_u32_u24 v3, 3456, v3
    v_lshl_add_u32 v2, v2, 4, v3
    s_add_u32 m0, s46, 86016
    s_nop 0
    buffer_load_dwordx4 v2, s[80:83], s45 offen lds
    v_add_u32 v2, 320, v1
    v_mul_u32_u24 v3, 4682, v2
    v_lshrrev_b32 v3, 16, v3
    v_mul_u32_u24 v4, 14, v3
    v_sub_u32 v2, v2, v4
    v_mul_u32_u24 v3, 3456, v3
    v_lshl_add_u32 v2, v2, 4, v3
    s_add_u32 m0, s46, 87040
    s_nop 0
    buffer_load_dwordx4 v2, s[80:83], s45 offen lds
    v_add_u32 v2, 384, v1
    v_mul_u32_u24 v3, 4682, v2
    v_lshrrev_b32 v3, 16, v3
    v_mul_u32_u24 v4, 14, v3
    v_sub_u32 v2, v2, v4
    v_mul_u32_u24 v3, 3456, v3
    v_lshl_add_u32 v2, v2, 4, v3
    s_add_u32 m0, s46, 88064
    s_nop 0
    buffer_load_dwordx4 v2, s[80:83], s45 offen lds
L_rawdone_61:
    s_waitcnt lgkmcnt(0)
    s_mul_i32 s37, s37, 0x9E3779B1
    s_add_u32 s37, s37, 0x7F4A7C15
    s_add_u32 s60, s37, 20
    v_lshl_add_u32 v2, v14, 2, v13
    v_mul_u32_u24 v10, 1280, v2
    v_lshlrev_b32 v3, 2, v13
    v_lshrrev_b32 v4, 1, v12
    v_and_b32 v11, 1, v12
    v_lshlrev_b32 v11, 3, v11
    s_mov_b32 s62, s59
    s_mov_b32 s63, 0
    s_waitcnt vmcnt(10)
    s_cmp_lt_u32 s59, 16
    s_cbranch_scc1 L_w2one_62
    s_waitcnt vmcnt(7)
L_w2one_62:
    s_barrier
L_w2task_63:
    v_add_u32 v2, s63, v10
    v_add_u32 v5, v11, v2
    s_and_b32 s47, s62, 3
    s_lshr_b32 s46, s62, 2
    s_mul_i32 s45, s47, 12
    s_add_u32 s45, s45, s46
    s_lshl_b32 s58, s47, 1
    s_add_u32 s58, s58, s46
    s_add_u32 s58, s58, 36
    s_cmp_lt_u32 s46, 12
    s_cselect_b32 s58, s45, s58
    s_mov_b32 s48, s47
    s_mul_i32 s45, s47, 14
    s_add_u32 s45, s45, s46
    s_mul_i32 s45, s45, 5120
    s_mul_i32 s46, s34, 573696
    s_add_u32 s45, s45, s46
    s_add_u32 s45, s45, 8314880
    v_lshl_add_u32 v6, v1, 4, s45
    v_add_u32 v7, 286848, v6
    s_lshl_b32 s44, s34, 4
    s_lshl_b32 s49, s34, 2
    s_and_b32 s48, s48, 2
    s_lshl_b32 s48, s48, 1
    s_xor_b32 s45, s48, 0
    s_add_u32 s45, s45, s44
    s_add_u32 s45, s45, 0
    v_add_u32 v8, s45, v12
    v_xor_b32 v8, v8, v3
    v_lshl_add_u32 v8, v8, 4, v2
    ds_read_b64_tr_b16 v[28:29], v8 offset:0
    ds_read_b64_tr_b16 v[30:31], v8 offset:20480
    ds_read_b64_tr_b16 v[32:33], v8 offset:8
    ds_read_b64_tr_b16 v[34:35], v8 offset:20488
    s_xor_b32 s45, s48, 4
    s_add_u32 s45, s45, s44
    s_add_u32 s45, s45, 0
    v_add_u32 v8, s45, v12
    v_xor_b32_e64 v8, v8, v3
    v_lshl_add_u32 v8, v8, 4, v2
    ds_read_b64_tr_b16 v[36:37], v8 offset:0
    ds_read_b64_tr_b16 v[38:39], v8 offset:20480
    ds_read_b64_tr_b16 v[40:41], v8 offset:8
    ds_read_b64_tr_b16 v[42:43], v8 offset:20488
    s_add_u32 s45, s49, 64
    v_add_u32 v8, s45, v4
    v_xor_b32_e64 v8, v8, v3
    v_lshl_add_u32 v8, v8, 4, v5
    ds_read_b64_tr_b16 v[44:45], v8 offset:0
    ds_read_b64_tr_b16 v[46:47], v8 offset:20480
    s_xor_b32 s45, s48, 0
    s_add_u32 s45, s45, s44
    s_add_u32 s45, s45, 8
    v_add_u32 v8, s45, v12
    v_xor_b32_e64 v8, v8, v3
    v_lshl_add_u32 v8, v8, 4, v2
    ds_read_b64_tr_b16 v[48:49], v8 offset:0
    ds_read_b64_tr_b16 v[50:51], v8 offset:20480
    ds_read_b64_tr_b16 v[52:53], v8 offset:8
    ds_read_b64_tr_b16 v[54:55], v8 offset:20488
    s_xor_b32 s45, s48, 4
    s_add_u32 s45, s45, s44
    s_add_u32 s45, s45, 8
    v_add_u32 v8, s45, v12
    v_xor_b32_e64 v8, v8, v3
    v_lshl_add_u32 v8, v8, 4, v2
    ds_read_b64_tr_b16 v[56:57], v8 offset:0
    ds_read_b64_tr_b16 v[58:59], v8 offset:20480
    ds_read_b64_tr_b16 v[60:61], v8 offset:8
    ds_read_b64_tr_b16 v[62:63], v8 offset:20488
    s_add_u32 s45, s49, 66
    v_add_u32 v8, s45, v4
    v_xor_b32 v8, v8, v3
    v_lshl_add_u32 v8, v8, 4, v5
    ds_read_b64_tr_b16 v[64:65], v8 offset:0
    ds_read_b64_tr_b16 v[66:67], v8 offset:20480
    s_waitcnt lgkmcnt(0)
    s_cmp_lt_u32 s58, 48
    s_cbranch_scc1 L_w2plain_64
    s_mov_b32 exec_lo, 0
    s_mov_b32 exec_hi, 0xffff0000
    v_mov_b32 v28, 0
    v_mov_b32 v29, 0
    v_mov_b32 v30, 0
    v_mov_b32 v31, 0
    v_mov_b32 v32, 0
    v_mov_b32 v33, 0
    v_mov_b32 v34, 0
    v_mov_b32 v35, 0
    v_mov_b32 v36, 0
    v_mov_b32 v37, 0
    v_mov_b32 v38, 0
    v_mov_b32 v39, 0
    v_mov_b32 v40, 0
    v_mov_b32 v41, 0
    v_mov_b32 v42, 0
    v_mov_b32 v43, 0
    v_mov_b32 v44, 0
    v_mov_b32 v45, 0
    v_mov_b32 v46, 0
    v_mov_b32 v47, 0
    v_mov_b32 v48, 0
    v_mov_b32 v49, 0
    v_mov_b32 v50, 0
    v_mov_b32 v51, 0
    v_mov_b32 v52, 0
    v_mov_b32 v53, 0
    v_mov_b32 v54, 0
    v_mov_b32 v55, 0
    v_mov_b32 v56, 0
    v_mov_b32 v57, 0
    v_mov_b32 v58, 0
    v_mov_b32 v59, 0
    v_mov_b32 v60, 0
    v_mov_b32 v61, 0
    v_mov_b32 v62, 0
    v_mov_b32 v63, 0
    v_mov_b32 v64, 0
    v_mov_b32 v65, 0
    v_mov_b32 v66, 0
    v_mov_b32_e64 v67, 0
    s_mov_b64 exec, -1
L_w2plain_64:
    global_store_dwordx4 v6, v[28:31], s[32:33] offset:-2048 sc1
    global_store_dwordx4 v6, v[32:35], s[32:33] offset:-1024 sc1
    global_store_dwordx4 v6, v[36:39], s[32:33] offset:0 sc1
    global_store_dwordx4 v6, v[40:43], s[32:33] offset:1024 sc1
    global_store_dwordx4 v6, v[44:47], s[32:33] offset:2048 sc1
    global_store_dwordx4 v7, v[48:51], s[32:33] offset:-2048 sc1
    global_store_dwordx4 v7, v[52:55], s[32:33] offset:-1024 sc1
    global_store_dwordx4 v7, v[56:59], s[32:33] offset:0 sc1
    global_store_dwordx4 v7, v[60:63], s[32:33] offset:1024 sc1
    global_store_dwordx4 v7, v[64:67], s[32:33] offset:2048 sc1
    s_waitcnt vmcnt(10)
    s_barrier
    s_cmp_eq_u32 s62, s59
    s_cbranch_scc1 L_noprev_65
    s_cmp_lg_u32 s34, 0
    s_cbranch_scc1 L_skipw_66
    s_lshl_b32 s44, s87, 2
    s_add_u32 s44, s44, 131072
    v_mov_b32 v8, s37
    v_mul_u32_u24 v2, 256, v1
    v_add_u32_e64 v2, s44, v2
    s_mov_b64 exec, 0xff
    global_store_dword v2, v8, s[32:33] sc1
    s_mov_b64 exec, -1
L_skipw_66:
L_noprev_65:
    s_mov_b32 s87, s62
    s_cmp_lt_u32 s62, 36
    s_cselect_b32 s44, 36, 16
    s_add_u32 s62, s62, s44
    s_cmp_lt_u32 s59, 16
    s_cselect_b32 s62, s62, 64
    s_add_u32 s63, s63, 40960
    s_cmp_lt_u32 s62, 56
    s_cbranch_scc1 L_w2task_63
    s_waitcnt vmcnt(0)
    s_barrier
    s_cmp_lg_u32 s34, 0
    s_cbranch_scc1 L_skipw_67
    s_lshl_b32 s44, s87, 2
    s_add_u32 s44, s44, 131072
    v_mov_b32_e64 v8, s37
    v_mul_u32_u24 v2, 256, v1
    v_add_u32_e64 v2, s44, v2
    s_mov_b64 exec, 0xff
    global_store_dword v2, v8, s[32:33] sc1
    s_mov_b64 exec, -1
L_skipw_67:
L_aux_j_58:
    s_cmp_eq_u32 s61, 0xff
    s_cbranch_scc1 L_no_w1_68
    s_lshr_b32 s49, s61, 4
    s_and_b32 s50, s61, 15
    s_lshl_b32 s44, s49, 7
    s_lshl_b32 s45, s34, 5
    s_add_u32 s44, s44, s45
    v_lshrrev_b32 v15, 2, v1
    v_and_b32_e64 v7, 3, v1
    v_mul_u32_u24 v7, 30720, v7
    v_add_u32 v7, 311296, v7
    s_add_u32 s45, s44, 2560
    v_add_u32 v2, s45, v15
    v_and_b32 v6, 7, v2
    v_lshlrev_b32_e64 v6, 6, v6
    v_and_or_b32 v6, v2, 56, v6
    v_lshrrev_b32_e64 v2, 6, v2
    v_lshl_add_u32 v2, v2, 9, v6
    v_add_u32_e64 v2, v2, v7
    s_add_u32 s45, s44, 2576
    v_add_u32 v3, s45, v15
    v_and_b32 v6, 7, v3
    v_lshlrev_b32_e64 v6, 6, v6
    v_and_or_b32 v6, v3, 56, v6
    v_lshrrev_b32_e64 v3, 6, v3
    v_lshl_add_u32 v3, v3, 9, v6
    v_add_u32_e64 v3, v3, v7
    s_add_u32 s45, s44, 1920
    v_add_u32 v4, s45, v15
    v_and_b32 v6, 7, v4
    v_lshlrev_b32_e64 v6, 6, v6
    v_and_or_b32 v6, v4, 56, v6
    v_lshrrev_b32_e64 v4, 6, v4
    v_lshl_add_u32 v4, v4, 9, v6
    v_add_u32_e64 v4, v4, v7
    s_add_u32 s45, s44, 1936
    v_add_u32 v5, s45, v15
    v_and_b32 v6, 7, v5
    v_lshlrev_b32_e64 v6, 6, v6
    v_and_or_b32 v6, v5, 56, v6
    v_lshrrev_b32_e64 v5, 6, v5
    v_lshl_add_u32 v5, v5, 9, v6
    v_add_u32_e64 v5, v5, v7
    s_mul_i32 s44, s34, 7168
    s_add_u32 s44, s44, 81920
    v_lshl_add_u32 v8, v14, 3, v13
    v_mul_u32_u24 v8, 224, v8
    v_lshl_add_u32 v8, v12, 3, v8
    v_add_u32_e64 v8, s44, v8
    s_mul_i32 s44, s34, 192
    s_add_u32 s44, s44, 110592
    v_lshl_add_u32 v16, v15, 2, s44
    v_lshl_add_u32 v17, v15, 1, s44
    v_lshl_add_u32 v18, v14, 5, s44
    v_lshl_add_u32 v19, v14, 4, s44
    v_mov_b32 v32, s56
    v_mov_b32 v33, s56
    v_mov_b32 v34, s56
    v_mov_b32 v35, s56
    s_mul_i32 s44, s50, 143488
    s_lshl_b32 s45, s49, 2
    s_add_u32 s45, s45, s34
    s_mul_i32 s45, s45, 7168
    s_add_u32 s44, s44, s45
    s_add_u32 s44, s44, 6020096
    v_lshl_add_u32 v9, v1, 4, s44
    s_waitcnt vmcnt(0)
    global_load_dwordx2 v[20:21], v2, s[32:33] sc1
    global_load_dwordx2 v[22:23], v3, s[32:33] sc1
    global_load_dwordx2 v[24:25], v4, s[32:33] sc1
    global_load_dwordx2 v[26:27], v5, s[32:33] sc1
    ds_read_b64_tr_b16 v[36:37], v8 offset:0
    ds_read_b64_tr_b16 v[38:39], v8 offset:896
    ds_read_b64_tr_b16 v[40:41], v8 offset:32
    ds_read_b64_tr_b16 v[42:43], v8 offset:928
    ds_read_b64_tr_b16 v[44:45], v8 offset:64
    ds_read_b64_tr_b16 v[46:47], v8 offset:960
    ds_read_b64_tr_b16 v[48:49], v8 offset:96
    ds_read_b64_tr_b16 v[50:51], v8 offset:992
    ds_read_b64_tr_b16 v[52:53], v8 offset:128
    ds_read_b64_tr_b16 v[54:55], v8 offset:1024
    ds_read_b64_tr_b16 v[56:57], v8 offset:160
    ds_read_b64_tr_b16 v[58:59], v8 offset:1056
    ds_read_b64_tr_b16 v[60:61], v8 offset:192
    ds_read_b64_tr_b16 v[62:63], v8 offset:1088
    s_waitcnt lgkmcnt(12)
    v_lshlrev_b32 v120, 16, v36
    v_and_b32 v121, 0xffff0000, v36
    v_lshlrev_b32_e64 v122, 16, v37
    v_and_b32 v123, 0xffff0000, v37
    v_lshlrev_b32_e64 v124, 16, v38
    v_and_b32 v125, 0xffff0000, v38
    v_lshlrev_b32_e64 v126, 16, v39
    v_and_b32 v127, 0xffff0000, v39
    s_waitcnt lgkmcnt(10)
    v_lshlrev_b32 v128, 16, v40
    v_and_b32 v129, 0xffff0000, v40
    v_lshlrev_b32_e64 v130, 16, v41
    v_and_b32 v131, 0xffff0000, v41
    v_lshlrev_b32_e64 v132, 16, v42
    v_and_b32 v133, 0xffff0000, v42
    v_lshlrev_b32_e64 v134, 16, v43
    v_and_b32 v135, 0xffff0000, v43
    s_waitcnt lgkmcnt(8)
    v_lshlrev_b32 v136, 16, v44
    v_and_b32 v137, 0xffff0000, v44
    v_lshlrev_b32_e64 v138, 16, v45
    v_and_b32 v139, 0xffff0000, v45
    v_lshlrev_b32_e64 v140, 16, v46
    v_and_b32 v141, 0xffff0000, v46
    v_lshlrev_b32_e64 v142, 16, v47
    v_and_b32 v143, 0xffff0000, v47
    s_waitcnt lgkmcnt(6)
    v_lshlrev_b32 v144, 16, v48
    v_and_b32 v145, 0xffff0000, v48
    v_lshlrev_b32_e64 v146, 16, v49
    v_and_b32 v147, 0xffff0000, v49
    v_lshlrev_b32_e64 v148, 16, v50
    v_and_b32 v149, 0xffff0000, v50
    v_lshlrev_b32_e64 v150, 16, v51
    v_and_b32 v151, 0xffff0000, v51
    s_waitcnt lgkmcnt(4)
    v_lshlrev_b32 v152, 16, v52
    v_and_b32 v153, 0xffff0000, v52
    v_lshlrev_b32_e64 v154, 16, v53
    v_and_b32 v155, 0xffff0000, v53
    v_lshlrev_b32_e64 v156, 16, v54
    v_and_b32 v157, 0xffff0000, v54
    v_lshlrev_b32_e64 v158, 16, v55
    v_and_b32 v159, 0xffff0000, v55
    s_waitcnt lgkmcnt(2)
    v_lshlrev_b32 v160, 16, v56
    v_and_b32 v161, 0xffff0000, v56
    v_lshlrev_b32_e64 v162, 16, v57
    v_and_b32 v163, 0xffff0000, v57
    v_lshlrev_b32_e64 v164, 16, v58
    v_and_b32 v165, 0xffff0000, v58
    v_lshlrev_b32_e64 v166, 16, v59
    v_and_b32 v167, 0xffff0000, v59
    s_waitcnt lgkmcnt(0)
    v_lshlrev_b32 v168, 16, v60
    v_and_b32 v169, 0xffff0000, v60
    v_lshlrev_b32_e64 v170, 16, v61
    v_and_b32 v171, 0xffff0000, v61
    v_lshlrev_b32_e64 v172, 16, v62
    v_and_b32 v173, 0xffff0000, v62
    v_lshlrev_b32_e64 v174, 16, v63
    v_and_b32 v175, 0xffff0000, v63
    s_waitcnt vmcnt(0)
    v_xor_b32 v10, s37, v21
    v_bitop3_b32 v10, v10, v23, s37 bitop3:0xf6
    v_bitop3_b32 v10, v10, v25, s37 bitop3:0xf6
    v_bitop3_b32 v10, v10, v27, s37 bitop3:0xf6
    v_cmp_ne_u32 vcc, 0, v10
    s_nop 1
    s_cbranch_vccnz L_fm_retry_69
L_fm_back_70:
    s_nop 0
    v_add_f32_dpp v20, v20, v20 quad_perm:[1,0,3,2] row_mask:0xf bank_mask:0xf
    v_add_f32_dpp v22, v22, v22 quad_perm:[1,0,3,2] row_mask:0xf bank_mask:0xf
    v_add_f32_dpp v24, v24, v24 quad_perm:[1,0,3,2] row_mask:0xf bank_mask:0xf
    v_add_f32_dpp v26, v26, v26 quad_perm:[1,0,3,2] row_mask:0xf bank_mask:0xf
    v_add_f32_dpp v20, v20, v20 quad_perm:[2,3,0,1] row_mask:0xf bank_mask:0xf
    v_add_f32_dpp v22, v22, v22 quad_perm:[2,3,0,1] row_mask:0xf bank_mask:0xf
    v_add_f32_dpp v24, v24, v24 quad_perm:[2,3,0,1] row_mask:0xf bank_mask:0xf
    v_add_f32_dpp v26, v26, v26 quad_perm:[2,3,0,1] row_mask:0xf bank_mask:0xf
    v_cvt_pk_bf16_f32 v6, v20, v22
    v_lshlrev_b32_e64 v20, 16, v6
    v_and_b32 v22, 0xffff0000, v6
    v_cvt_pk_bf16_f32 v24, v24, v26
    v_add_f32 v20, 1.0, v20
    v_add_f32 v22, 1.0, v22
    v_lshrrev_b32_e64 v26, 16, v24
    v_cvt_pk_bf16_f32 v6, v20, v22
    v_lshlrev_b32_e64 v20, 16, v6
    v_and_b32 v22, 0xffff0000, v6
    ds_write_b32 v16, v20
    ds_write_b32 v16, v22 offset:64
    ds_write_b16 v17, v24 offset:128
    ds_write_b16 v17, v26 offset:160
    v_and_b32 v3, 15, v1
    v_cmp_lt_u32 vcc, 11, v3
    ds_read_b128 v[20:23], v18
    ds_read_b128 v[24:27], v18 offset:16
    ds_read_b128 v[28:31], v19 offset:128
    s_waitcnt lgkmcnt(1)
    s_nop 0
    v_pk_mul_f32 v[120:121], v[120:121], v[20:21]
    v_pk_mul_f32 v[122:123], v[122:123], v[22:23]
    v_pk_mul_f32 v[124:125], v[124:125], v[24:25]
    v_pk_mul_f32 v[126:127], v[126:127], v[26:27]
    v_cvt_pk_bf16_f32 v176, v120, v121
    v_cvt_pk_bf16_f32 v177, v122, v123
    v_cvt_pk_bf16_f32 v178, v124, v125
    v_cvt_pk_bf16_f32 v179, v126, v127
    global_store_dwordx4 v9, v[176:179], s[32:33] offset:-3072 sc1
    v_pk_mul_f32 v[128:129], v[128:129], v[20:21]
    v_pk_mul_f32 v[130:131], v[130:131], v[22:23]
    v_pk_mul_f32 v[132:133], v[132:133], v[24:25]
    v_pk_mul_f32 v[134:135], v[134:135], v[26:27]
    v_cvt_pk_bf16_f32 v180, v128, v129
    v_cvt_pk_bf16_f32 v181, v130, v131
    v_cvt_pk_bf16_f32 v182, v132, v133
    v_cvt_pk_bf16_f32 v183, v134, v135
    global_store_dwordx4 v9, v[180:183], s[32:33] offset:-2048 sc1
    v_pk_mul_f32 v[136:137], v[136:137], v[20:21]
    v_pk_mul_f32 v[138:139], v[138:139], v[22:23]
    v_pk_mul_f32 v[140:141], v[140:141], v[24:25]
    v_pk_mul_f32 v[142:143], v[142:143], v[26:27]
    v_cvt_pk_bf16_f32 v184, v136, v137
    v_cvt_pk_bf16_f32 v185, v138, v139
    v_cvt_pk_bf16_f32 v186, v140, v141
    v_cvt_pk_bf16_f32 v187, v142, v143
    global_store_dwordx4 v9, v[184:187], s[32:33] offset:-1024 sc1
    v_pk_mul_f32 v[144:145], v[144:145], v[20:21]
    v_pk_mul_f32 v[146:147], v[146:147], v[22:23]
    v_pk_mul_f32 v[148:149], v[148:149], v[24:25]
    v_pk_mul_f32 v[150:151], v[150:151], v[26:27]
    v_cvt_pk_bf16_f32 v188, v144, v145
    v_cvt_pk_bf16_f32 v189, v146, v147
    v_cvt_pk_bf16_f32 v190, v148, v149
    v_cvt_pk_bf16_f32 v191, v150, v151
    global_store_dwordx4 v9, v[188:191], s[32:33] offset:0 sc1
    v_pk_mul_f32 v[152:153], v[152:153], v[20:21]
    v_pk_mul_f32 v[154:155], v[154:155], v[22:23]
    v_pk_mul_f32 v[156:157], v[156:157], v[24:25]
    v_pk_mul_f32 v[158:159], v[158:159], v[26:27]
    v_cvt_pk_bf16_f32 v192, v152, v153
    v_cvt_pk_bf16_f32 v193, v154, v155
    v_cvt_pk_bf16_f32 v194, v156, v157
    v_cvt_pk_bf16_f32 v195, v158, v159
    global_store_dwordx4 v9, v[192:195], s[32:33] offset:1024 sc1
    v_pk_mul_f32 v[160:161], v[160:161], v[20:21]
    v_pk_mul_f32 v[162:163], v[162:163], v[22:23]
    v_pk_mul_f32 v[164:165], v[164:165], v[24:25]
    v_pk_mul_f32 v[166:167], v[166:167], v[26:27]
    v_cvt_pk_bf16_f32 v196, v160, v161
    v_cvt_pk_bf16_f32 v197, v162, v163
    v_cvt_pk_bf16_f32 v198, v164, v165
    v_cvt_pk_bf16_f32 v199, v166, v167
    global_store_dwordx4 v9, v[196:199], s[32:33] offset:2048 sc1
    v_pk_mul_f32 v[168:169], v[168:169], v[20:21]
    v_pk_mul_f32 v[170:171], v[170:171], v[22:23]
    v_pk_mul_f32 v[172:173], v[172:173], v[24:25]
    v_pk_mul_f32 v[174:175], v[174:175], v[26:27]
    v_cvt_pk_bf16_f32 v200, v168, v169
    v_cndmask_b32 v200, v200, v32, vcc
    v_cvt_pk_bf16_f32 v201, v170, v171
    v_cndmask_b32 v201, v201, v32, vcc
    v_cvt_pk_bf16_f32 v202, v172, v173
    v_cndmask_b32 v202, v202, v32, vcc
    v_cvt_pk_bf16_f32 v203, v174, v175
    v_cndmask_b32 v203, v203, v32, vcc
    global_store_dwordx4 v9, v[200:203], s[32:33] offset:3072 sc1
    s_waitcnt lgkmcnt(0)
    v_mfma_f32_16x16x32_bf16 v[92:95], v[36:39], v[28:31], 0
    v_mfma_f32_16x16x32_bf16 v[96:99], v[40:43], v[28:31], 0
    v_mfma_f32_16x16x32_bf16 v[100:103], v[44:47], v[28:31], 0
    v_mfma_f32_16x16x32_bf16 v[104:107], v[48:51], v[28:31], 0
    v_mfma_f32_16x16x32_bf16 v[108:111], v[52:55], v[28:31], 0
    v_mfma_f32_16x16x32_bf16 v[112:115], v[56:59], v[28:31], 0
    v_mfma_f32_16x16x32_bf16 v[116:119], v[60:63], v[28:31], 0
    v_mfma_f32_16x16x32_bf16 v[64:67], v[176:179], v[32:35], 0
    v_mfma_f32_16x16x32_bf16 v[68:71], v[180:183], v[32:35], 0
    v_mfma_f32_16x16x32_bf16 v[72:75], v[184:187], v[32:35], 0
    v_mfma_f32_16x16x32_bf16 v[76:79], v[188:191], v[32:35], 0
    v_mfma_f32_16x16x32_bf16 v[80:83], v[192:195], v[32:35], 0
    v_mfma_f32_16x16x32_bf16 v[84:87], v[196:199], v[32:35], 0
    v_mfma_f32_16x16x32_bf16 v[88:91], v[200:203], v[32:35], 0
    s_mul_i32 s44, s34, 1024
    s_add_u32 s44, s44, 111360
    v_lshl_add_u32 v2, v13, 2, v14
    v_lshl_add_u32 v2, v2, 4, s44
    s_lshl_b32 s44, s50, 7
    s_lshl_b32 s45, s49, 4
    s_add_u32 s44, s44, s45
    s_lshl_b32 s45, s34, 2
    s_add_u32 s44, s44, s45
    s_add_u32 s44, s44, 147456
    v_mov_b32 v8, s44
    v_mov_b32 v9, s37
    v_mov_b32_dpp v92, v96 quad_perm:[0,1,2,3] row_mask:0xf bank_mask:0x2
    v_mov_b32_dpp v93, v97 quad_perm:[0,1,2,3] row_mask:0xf bank_mask:0x2
    v_mov_b32_dpp v94, v98 quad_perm:[0,1,2,3] row_mask:0xf bank_mask:0x2
    v_mov_b32_dpp v95, v99 quad_perm:[0,1,2,3] row_mask:0xf bank_mask:0x2
    v_mov_b32_dpp v92, v100 quad_perm:[0,1,2,3] row_mask:0xf bank_mask:0x4
    v_mov_b32_dpp v93, v101 quad_perm:[0,1,2,3] row_mask:0xf bank_mask:0x4
    v_mov_b32_dpp v94, v102 quad_perm:[0,1,2,3] row_mask:0xf bank_mask:0x4
    v_mov_b32_dpp v95, v103 quad_perm:[0,1,2,3] row_mask:0xf bank_mask:0x4
    v_mov_b32_dpp v92, v104 quad_perm:[0,1,2,3] row_mask:0xf bank_mask:0x8
    v_mov_b32_dpp v93, v105 quad_perm:[0,1,2,3] row_mask:0xf bank_mask:0x8
    v_mov_b32_dpp v94, v106 quad_perm:[0,1,2,3] row_mask:0xf bank_mask:0x8
    v_mov_b32_dpp v95, v107 quad_perm:[0,1,2,3] row_mask:0xf bank_mask:0x8
    v_mov_b32_dpp v108, v112 quad_perm:[0,1,2,3] row_mask:0xf bank_mask:0x2
    v_mov_b32_dpp v109, v113 quad_perm:[0,1,2,3] row_mask:0xf bank_mask:0x2
    v_mov_b32_dpp v110, v114 quad_perm:[0,1,2,3] row_mask:0xf bank_mask:0x2
    v_mov_b32_dpp v111, v115 quad_perm:[0,1,2,3] row_mask:0xf bank_mask:0x2
    v_mov_b32_dpp v108, v116 quad_perm:[0,1,2,3] row_mask:0xf bank_mask:0x4
    v_mov_b32_dpp v109, v117 quad_perm:[0,1,2,3] row_mask:0xf bank_mask:0x4
    v_mov_b32_dpp v110, v118 quad_perm:[0,1,2,3] row_mask:0xf bank_mask:0x4
    v_mov_b32_dpp v111, v119 quad_perm:[0,1,2,3] row_mask:0xf bank_mask:0x4
    v_mov_b32_dpp v108, v64 quad_perm:[0,1,2,3] row_mask:0xf bank_mask:0x8
    v_mov_b32_dpp v109, v65 quad_perm:[0,1,2,3] row_mask:0xf bank_mask:0x8
    v_mov_b32_dpp v110, v66 quad_perm:[0,1,2,3] row_mask:0xf bank_mask:0x8
    v_mov_b32_dpp v111, v67 quad_perm:[0,1,2,3] row_mask:0xf bank_mask:0x8
    v_mov_b32_dpp v68, v72 quad_perm:[0,1,2,3] row_mask:0xf bank_mask:0x2
    v_mov_b32_dpp v69, v73 quad_perm:[0,1,2,3] row_mask:0xf bank_mask:0x2
    v_mov_b32_dpp v70, v74 quad_perm:[0,1,2,3] row_mask:0xf bank_mask:0x2
    v_mov_b32_dpp v71, v75 quad_perm:[0,1,2,3] row_mask:0xf bank_mask:0x2
    v_mov_b32_dpp v68, v76 quad_perm:[0,1,2,3] row_mask:0xf bank_mask:0x4
    v_mov_b32_dpp v69, v77 quad_perm:[0,1,2,3] row_mask:0xf bank_mask:0x4
    v_mov_b32_dpp v70, v78 quad_perm:[0,1,2,3] row_mask:0xf bank_mask:0x4
    v_mov_b32_dpp v71, v79 quad_perm:[0,1,2,3] row_mask:0xf bank_mask:0x4
    v_mov_b32_dpp v68, v80 quad_perm:[0,1,2,3] row_mask:0xf bank_mask:0x8
    v_mov_b32_dpp v69, v81 quad_perm:[0,1,2,3] row_mask:0xf bank_mask:0x8
    v_mov_b32_dpp v70, v82 quad_perm:[0,1,2,3] row_mask:0xf bank_mask:0x8
    v_mov_b32_dpp v71, v83 quad_perm:[0,1,2,3] row_mask:0xf bank_mask:0x8
    v_mov_b32_dpp v84, v88 quad_perm:[0,1,2,3] row_mask:0xf bank_mask:0x2
    v_mov_b32_dpp v85, v89 quad_perm:[0,1,2,3] row_mask:0xf bank_mask:0x2
    v_mov_b32_dpp v86, v90 quad_perm:[0,1,2,3] row_mask:0xf bank_mask:0x2
    v_mov_b32_dpp v87, v91 quad_perm:[0,1,2,3] row_mask:0xf bank_mask:0x2
    ds_write_b128 v2, v[92:95] offset:0
    ds_write_b128 v2, v[108:111] offset:256
    ds_write_b128 v2, v[68:71] offset:512
    ds_write_b128 v2, v[84:87] offset:768
    v_min_u32 v2, 223, v0
    v_lshlrev_b32_e64 v3, 2, v2
    v_add_u32 v3, 111360, v3
    s_mul_i32 s44, s50, 5
    s_add_u32 s44, s44, s49
    s_mul_i32 s44, s44, 1792
    s_add_u32 s44, s44, 524288
    v_lshl_add_u32 v2, v2, 3, s44
    s_waitcnt lgkmcnt(0)
    s_barrier
    ds_read_b32 v4, v3 offset:0
    ds_read_b32 v5, v3 offset:1024
    ds_read_b32 v6, v3 offset:2048
    ds_read_b32 v7, v3 offset:3072
    s_waitcnt lgkmcnt(0)
    v_add_f32 v4, v4, v5
    v_add_f32 v6, v6, v7
    v_add_f32 v4, v4, v6
    v_mov_b32_e64 v5, s37
    global_store_dwordx2 v2, v[4:5], s[32:33] sc1
    s_waitcnt vmcnt(1)
    s_mov_b64 exec, 0x1
    global_store_dword v8, v9, s[32:33] sc1
    s_mov_b64 exec, -1
    s_waitcnt lgkmcnt(0)
    s_barrier
L_no_w1_68:
    s_lshl_b32 s44, s39, 2
    s_add_u32 s46, s44, s34
    s_mul_i32 s44, s46, 57472
    s_add_u32 s44, s44, 10607616
    s_mul_i32 s45, s40, 3072
    s_add_u32 s6, s45, s44
    s_lshl_b32 s45, s40, 9
    s_add_u32 s45, s45, s44
    s_add_u32 s7, s45, 49152
    s_lshl_b32 s46, s46, 7
    s_lshl_b32 s45, s40, 2
    s_add_u32 s46, s46, s45
    s_add_u32 s8, s46, 155648
    s_lshl_b32 s44, s43, 1
    s_add_u32 s42, s44, s42
    s_lshl_b32 s44, s42, 8
    s_lshl_b32 s45, s34, 4
    s_add_u32 s44, s44, s45
    s_add_u32 s9, s44, 155648
    s_and_b32 s45, s34, 1
    s_lshl_b32 s44, s42, 1
    s_add_u32 s44, s44, s45
    s_xor_b32 s46, s44, 1
    s_mul_i32 s44, s44, 57472
    s_mul_i32 s45, s34, 12288
    s_add_u32 s45, s45, s44
    s_add_u32 s10, s45, 10611712
    s_lshl_b32 s45, s34, 11
    s_add_u32 s45, s45, s44
    s_add_u32 s12, s45, 10656768
    s_mul_i32 s46, s46, 57472
    s_mul_i32 s45, s34, 12288
    s_add_u32 s45, s45, s46
    s_add_u32 s11, s45, 10611712
    s_lshl_b32 s45, s34, 11
    s_add_u32 s45, s45, s46
    s_add_u32 s13, s45, 10656768
    s_mul_i32 s44, s41, 286848
    s_mul_i32 s45, s34, 71680
    s_add_u32 s44, s44, s45
    s_add_u32 s44, s44, 8316928
    v_lshl_add_u32 v230, v1, 4, s44
    s_mul_i32 s44, s40, 143488
    s_lshl_b32 s45, s34, 12
    s_add_u32 s44, s44, s45
    s_add_u32 s44, s44, 6017024
    v_lshl_add_u32 v228, v1, 4, s44
    s_add_u32 s58, s45, 0
    s_lshl_b32 s45, s35, 8
    s_lshl_b32 s44, s34, 2
    s_add_u32 s45, s45, s44
    s_add_u32 s45, s45, 131072
    v_min_u32 v2, 8, v1
    v_lshl_add_u32 v2, v2, 4, s45
    v_min_u32_e64 v4, 13, v1
    v_lshl_add_u32 v4, v4, 4, s45
    s_lshl_b32 s44, s40, 7
    s_add_u32 s44, s44, 147456
    v_min_u32 v3, 19, v1
    v_lshl_add_u32 v3, v3, 2, s44
L_fw2a_71:
    global_load_dword v5, v2, s[32:33] sc1
    s_waitcnt vmcnt(0)
    v_cmp_ne_u32 vcc, s37, v5
    s_nop 1
    s_cbranch_vccz L_fw2a_ok_72
    s_sub_u32 s86, s86, 1
    s_cbranch_scc1 L_end
    s_sleep 3
    s_branch L_fw2a_71
L_fw2a_ok_72:
    global_load_dwordx4 a[0:3], v230, s[32:33] offset:-4096 sc1
    global_load_dwordx4 a[4:7], v230, s[32:33] offset:-3072 sc1
    global_load_dwordx4 a[8:11], v230, s[32:33] offset:-2048 sc1
    global_load_dwordx4 a[12:15], v230, s[32:33] offset:-1024 sc1
    global_load_dwordx4 a[16:19], v230, s[32:33] offset:0 sc1
    global_load_dwordx4 a[20:23], v230, s[32:33] offset:1024 sc1
    global_load_dwordx4 a[24:27], v230, s[32:33] offset:2048 sc1
    global_load_dwordx4 a[28:31], v230, s[32:33] offset:3072 sc1
    v_add_u32 v230, 8192, v230
    global_load_dwordx4 a[32:35], v230, s[32:33] offset:-4096 sc1
    global_load_dwordx4 a[36:39], v230, s[32:33] offset:-3072 sc1
    global_load_dwordx4 a[40:43], v230, s[32:33] offset:-2048 sc1
    global_load_dwordx4 a[44:47], v230, s[32:33] offset:-1024 sc1
    global_load_dwordx4 a[48:51], v230, s[32:33] offset:0 sc1
    global_load_dwordx4 a[52:55], v230, s[32:33] offset:1024 sc1
    global_load_dwordx4 a[56:59], v230, s[32:33] offset:2048 sc1
    global_load_dwordx4 a[60:63], v230, s[32:33] offset:3072 sc1
    v_add_u32 v230, 8192, v230
    global_load_dwordx4 a[64:67], v230, s[32:33] offset:-4096 sc1
    global_load_dwordx4 a[68:71], v230, s[32:33] offset:-3072 sc1
    global_load_dwordx4 a[72:75], v230, s[32:33] offset:-2048 sc1
    global_load_dwordx4 a[76:79], v230, s[32:33] offset:-1024 sc1
    global_load_dwordx4 a[80:83], v230, s[32:33] offset:0 sc1
    global_load_dwordx4 a[84:87], v230, s[32:33] offset:1024 sc1
    global_load_dwordx4 a[88:91], v230, s[32:33] offset:2048 sc1
    global_load_dwordx4 a[92:95], v230, s[32:33] offset:3072 sc1
    v_add_u32 v230, 8192, v230
    global_load_dwordx4 a[96:99], v230, s[32:33] offset:-4096 sc1
    global_load_dwordx4 a[100:103], v230, s[32:33] offset:-3072 sc1
    global_load_dwordx4 a[104:107], v230, s[32:33] offset:-2048 sc1
    global_load_dwordx4 a[108:111], v230, s[32:33] offset:-1024 sc1
    global_load_dwordx4 a[112:115], v230, s[32:33] offset:0 sc1
    global_load_dwordx4 a[116:119], v230, s[32:33] offset:1024 sc1
    global_load_dwordx4 a[120:123], v230, s[32:33] offset:2048 sc1
    global_load_dwordx4 a[124:127], v230, s[32:33] offset:3072 sc1
    v_add_u32 v230, 8192, v230
    global_load_dwordx4 a[128:131], v230, s[32:33] offset:-4096 sc1
    global_load_dwordx4 a[132:135], v230, s[32:33] offset:-3072 sc1
    global_load_dwordx4 a[136:139], v230, s[32:33] offset:-2048 sc1
    global_load_dwordx4 a[140:143], v230, s[32:33] offset:-1024 sc1
    global_load_dwordx4 a[144:147], v230, s[32:33] offset:0 sc1
    s_mul_i32 s44, s40, 8960
    s_add_u32 s44, s44, 527872
    v_min_u32 v44, 223, v0
    v_lshl_add_u32 v44, v44, 3, s44
    s_lshl_b32 s44, s41, 6
    s_add_u32 s44, s44, 3200
    s_lshl_b32 s45, s41, 4
    s_add_u32 s45, s45, 3712
    v_and_b32_e64 v12, 3, v1
    v_mul_u32_u24 v12, 30720, v12
    v_add_u32 v12, 311296, v12
    v_lshrrev_b32 v10, 2, v0
    v_min_u32 v11, 15, v10
    v_add_u32 v10, s44, v10
    v_and_b32 v13, 7, v10
    v_lshlrev_b32_e64 v13, 6, v13
    v_and_or_b32 v13, v10, 56, v13
    v_lshrrev_b32_e64 v10, 6, v10
    v_lshl_add_u32 v10, v10, 9, v13
    v_add_u32 v10, v10, v12
    v_add_u32 v11, s45, v11
    v_and_b32 v13, 7, v11
    v_lshlrev_b32 v13, 6, v13
    v_and_or_b32 v13, v11, 56, v13
    v_lshrrev_b32_e64 v11, 6, v11
    v_lshl_add_u32 v11, v11, 9, v13
    v_add_u32_e64 v11, v11, v12
L_fw1a_73:
    global_load_dword v5, v3, s[32:33] sc1
    s_waitcnt vmcnt(0)
    v_cmp_ne_u32 vcc, s37, v5
    s_nop 1
    s_cbranch_vccz L_fw1a_ok_74
    s_sub_u32 s86, s86, 1
    s_cbranch_scc1 L_end
    s_sleep 3
    s_branch L_fw1a_73
L_fw1a_ok_74:
    s_mov_b32 m0, s58
    s_nop 0
    global_load_lds_dwordx4 v228, s[32:33] offset:0 sc1
    global_load_lds_dwordx4 v228, s[32:33] offset:1024 sc1
    global_load_lds_dwordx4 v228, s[32:33] offset:2048 sc1
    global_load_lds_dwordx4 v228, s[32:33] offset:3072 sc1
    s_add_u32 s58, s58, 16384
    v_add_u32 v228, 16384, v228
    s_mov_b32 m0, s58
    s_nop 0
    global_load_lds_dwordx4 v228, s[32:33] offset:0 sc1
    global_load_lds_dwordx4 v228, s[32:33] offset:1024 sc1
    global_load_lds_dwordx4 v228, s[32:33] offset:2048 sc1
    global_load_lds_dwordx4 v228, s[32:33] offset:3072 sc1
    s_add_u32 s58, s58, 16384
    v_add_u32 v228, 16384, v228
    s_mov_b32 m0, s58
    s_nop 0
    global_load_lds_dwordx4 v228, s[32:33] offset:0 sc1
    global_load_lds_dwordx4 v228, s[32:33] offset:1024 sc1
    global_load_lds_dwordx4 v228, s[32:33] offset:2048 sc1
    global_load_lds_dwordx4 v228, s[32:33] offset:3072 sc1
    s_add_u32 s58, s58, 16384
    v_add_u32 v228, 16384, v228
    s_mov_b32 m0, s58
    s_nop 0
    global_load_lds_dwordx4 v228, s[32:33] offset:0 sc1
    global_load_lds_dwordx4 v228, s[32:33] offset:1024 sc1
    global_load_lds_dwordx4 v228, s[32:33] offset:2048 sc1
    global_load_lds_dwordx4 v228, s[32:33] offset:3072 sc1
    s_add_u32 s58, s58, 16384
    v_add_u32 v228, 16384, v228
    s_mov_b32 m0, s58
    s_nop 0
    global_load_lds_dwordx4 v228, s[32:33] offset:0 sc1
    global_load_lds_dwordx4 v228, s[32:33] offset:1024 sc1
    global_load_lds_dwordx4 v228, s[32:33] offset:2048 sc1
    global_load_lds_dwordx4 v228, s[32:33] offset:3072 sc1
    s_add_u32 s58, s58, 16384
    v_add_u32 v228, 16384, v228
    s_mov_b32 m0, s58
    s_nop 0
    global_load_lds_dwordx4 v228, s[32:33] offset:0 sc1
    global_load_lds_dwordx4 v228, s[32:33] offset:1024 sc1
    global_load_lds_dwordx4 v228, s[32:33] offset:2048 sc1
    global_load_lds_dwordx4 v228, s[32:33] offset:3072 sc1
    s_add_u32 s58, s58, 16384
    v_add_u32 v228, 16384, v228
    global_load_dwordx2 v[196:197], v44, s[32:33] offset:-3584 sc1
    global_load_dwordx2 v[198:199], v44, s[32:33] offset:-1792 sc1
    global_load_dwordx2 v[200:201], v44, s[32:33] offset:0 sc1
    global_load_dwordx2 v[202:203], v44, s[32:33] offset:1792 sc1
    global_load_dwordx2 v[204:205], v44, s[32:33] offset:3584 sc1
    global_load_dwordx2 v[206:207], v10, s[32:33] sc1
    global_load_dwordx2 v[208:209], v11, s[32:33] sc1
    s_waitcnt vmcnt(0)
    v_xor_b32 v12, s37, v197
    v_bitop3_b32 v12, v12, v199, s37 bitop3:0xf6
    v_bitop3_b32 v12, v12, v201, s37 bitop3:0xf6
    v_bitop3_b32 v12, v12, v203, s37 bitop3:0xf6
    v_bitop3_b32 v12, v12, v205, s37 bitop3:0xf6
    v_bitop3_b32 v12, v12, v207, s37 bitop3:0xf6
    v_bitop3_b32 v12, v12, v209, s37 bitop3:0xf6
    v_cmp_ne_u32 vcc, 0, v12
    s_nop 1
    s_cbranch_vccnz L_small_retry_75
L_small_back_76:
    v_add_f32_dpp v206, v206, v206 quad_perm:[1,0,3,2] row_mask:0xf bank_mask:0xf
    v_add_f32_dpp v208, v208, v208 quad_perm:[1,0,3,2] row_mask:0xf bank_mask:0xf
    s_nop 0
    v_add_f32_dpp v206, v206, v206 quad_perm:[2,3,0,1] row_mask:0xf bank_mask:0xf
    v_add_f32_dpp v208, v208, v208 quad_perm:[2,3,0,1] row_mask:0xf bank_mask:0xf
    v_add_f32 v196, v196, v198
    v_add_f32 v200, v200, v202
    v_add_f32 v196, v196, v204
    v_add_f32 v196, v196, v200
    v_cvt_pk_bf16_f32 v206, v206, v208
    v_and_b32 v208, 0xffff0000, v206
    v_lshlrev_b32_e64 v206, 16, v206
    v_mul_f32 v208, 0xbf317218, v208
    v_mul_f32 v206, 0xbf317218, v206
    v_mul_f32 v196, 0xbfb8aa3b, v196
    v_and_b32 v12, 0xfc, v0
    v_add_u32 v12, 163520, v12
    v_add_u32 v13, 256, v12
    v_min_u32 v13, 163836, v13
    v_min_u32 v14, 223, v0
    v_lshlrev_b32_e64 v14, 2, v14
    v_add_u32 v14, 162624, v14
    ds_write_b32 v12, v206
    ds_write_b32 v13, v208
    ds_write_b32 v14, v196
    s_waitcnt lgkmcnt(0)
    v_mov_b32_e64 v45, v4
    s_lshl_b32 s45, s35, 12
    s_add_u32 s45, s45, 65536
    v_and_b32_e64 v46, 31, v1
    v_lshl_add_u32 v46, v46, 7, s45
    s_lshl_b32 s44, s39, 9
    s_lshl_b32 s45, s34, 7
    s_add_u32 s44, s44, s45
    s_add_u32 s44, s44, 3375104
    v_lshrrev_b32 v192, 3, v1
    v_mul_u32_u24 v192, 16512, v192
    v_add_u32 v192, s44, v192
    v_and_b32 v47, 7, v1
    v_lshl_add_u32 v192, v47, 4, v192
    v_lshlrev_b32_e64 v193, 4, v1
    v_add_u32 v194, 64512, v193
    v_add_u32 v195, 129024, v193
    s_branch L_g1_0_poll
L_hin_again_77:
    s_sleep 3
L_hin_retry_14:
    s_sub_u32 s86, s86, 1
    s_cbranch_scc1 L_end
    global_load_dwordx4 v[232:235], v28, s[32:33] offset:0 sc1
    global_load_dwordx4 v[236:239], v28, s[32:33] offset:1024 sc1
    global_load_dwordx4 v[240:243], v29, s[32:33] offset:0 sc1
    global_load_dwordx4 v[244:247], v29, s[32:33] offset:1024 sc1
    global_load_dword v252, v31, s[32:33] sc1
    s_waitcnt vmcnt(0)
    v_xor_b32 v6, s37, v233
    v_bitop3_b32 v6, v6, v235, s37 bitop3:0xf6
    v_bitop3_b32 v6, v6, v237, s37 bitop3:0xf6
    v_bitop3_b32 v6, v6, v239, s37 bitop3:0xf6
    v_bitop3_b32 v6, v6, v241, s37 bitop3:0xf6
    v_bitop3_b32 v6, v6, v243, s37 bitop3:0xf6
    v_bitop3_b32 v6, v6, v245, s37 bitop3:0xf6
    v_bitop3_b32 v6, v6, v247, s37 bitop3:0xf6
    v_bitop3_b32 v6, v6, v252, s37 bitop3:0xf6
    v_cmp_ne_u32 vcc, 0, v6
    s_nop 1
    s_cbranch_vccnz L_hin_again_77
    s_branch L_hin_back_15
L_fmc_again_78:
    s_sleep 3
L_fmc_retry_16:
    s_sub_u32 s86, s86, 1
    s_cbranch_scc1 L_end
    global_load_dwordx2 v[248:249], v30, s[32:33] sc1
    s_waitcnt vmcnt(0)
    v_cmp_ne_u32 vcc, s37, v249
    s_nop 1
    s_cbranch_vccnz L_fmc_again_78
    s_branch L_fmc_back_17
L_fw0_again_79:
    s_sleep 3
L_fw0_retry_18:
    s_sub_u32 s86, s86, 1
    s_cbranch_scc1 L_end
    global_load_dword v41, v38, s[32:33] sc1
    s_waitcnt vmcnt(0)
    v_cmp_ne_u32 vcc, s37, v41
    s_nop 1
    s_cbranch_vccnz L_fw0_again_79
    s_branch L_fw0_back_19
L_fw1_again_80:
    s_sleep 3
L_fw1_retry_20:
    s_sub_u32 s86, s86, 1
    s_cbranch_scc1 L_end
    global_load_dword v41, v39, s[32:33] sc1
    s_waitcnt vmcnt(0)
    v_cmp_ne_u32 vcc, s37, v41
    s_nop 1
    s_cbranch_vccnz L_fw1_again_80
    s_branch L_fw1_back_21
L_small_again_81:
    s_sleep 3
L_small_retry_22:
    s_sub_u32 s86, s86, 1
    s_cbranch_scc1 L_end
    global_load_dwordx2 v[196:197], v44, s[32:33] offset:-3584 sc1
    global_load_dwordx2 v[198:199], v44, s[32:33] offset:-1792 sc1
    global_load_dwordx2 v[200:201], v44, s[32:33] offset:0 sc1
    global_load_dwordx2 v[202:203], v44, s[32:33] offset:1792 sc1
    global_load_dwordx2 v[204:205], v44, s[32:33] offset:3584 sc1
    global_load_dwordx2 v[206:207], v10, s[32:33] sc1
    global_load_dwordx2 v[208:209], v11, s[32:33] sc1
    s_waitcnt vmcnt(0)
    v_xor_b32_e64 v12, s37, v197
    v_bitop3_b32 v12, v12, v199, s37 bitop3:0xf6
    v_bitop3_b32 v12, v12, v201, s37 bitop3:0xf6
    v_bitop3_b32 v12, v12, v203, s37 bitop3:0xf6
    v_bitop3_b32 v12, v12, v205, s37 bitop3:0xf6
    v_bitop3_b32 v12, v12, v207, s37 bitop3:0xf6
    v_bitop3_b32 v12, v12, v209, s37 bitop3:0xf6
    v_cmp_ne_u32 vcc, 0, v12
    s_nop 1
    s_cbranch_vccnz L_small_again_81
    s_branch L_small_back_23
L_L_g1_0_slow_25:
    global_load_dword v47, v46, s[32:33] sc1
    s_waitcnt vmcnt(0)
    s_mov_b64 exec, 0xff
    global_atomic_add v190, v191, s[32:33] sc1
    s_mov_b64 exec, -1
    s_branch L_L_g1_0_got_82
L_L_g1_0_again_83:
    s_sleep 3
L_g1_0_poll:
    s_sub_u32 s86, s86, 1
    s_cbranch_scc1 L_end
    global_load_dword v47, v46, s[32:33] sc1
    s_waitcnt vmcnt(0)
L_L_g1_0_got_82:
    s_mov_b32 s87, 1
    v_cmp_ne_u32 vcc, s60, v47
    s_nop 1
    s_cbranch_vccnz L_L_g1_0_again_83
    s_nop 0
    global_load_dwordx4 v[48:51], v192, s[32:33] sc1
    v_add_u32 v192, 132096, v192
    global_load_dwordx4 v[52:55], v192, s[32:33] sc1
    v_add_u32 v192, 132096, v192
    global_load_dwordx4 v[56:59], v192, s[32:33] sc1
    v_add_u32 v192, 132096, v192
    global_load_dwordx4 v[60:63], v192, s[32:33] sc1
    v_add_u32 v192, 132096, v192
    global_load_dwordx4 v[64:67], v192, s[32:33] sc1
    v_add_u32 v192, 132096, v192
    global_load_dwordx4 v[68:71], v192, s[32:33] sc1
    v_add_u32 v192, 132096, v192
    global_load_dwordx4 v[72:75], v192, s[32:33] sc1
    v_add_u32 v192, 132096, v192
    global_load_dwordx4 v[76:79], v192, s[32:33] sc1
    v_add_u32 v192, 132096, v192
    global_load_dword v47, v46, s[32:33] sc1
    global_load_dword v47, v46, s[32:33] sc1
    s_branch L_L_g1_0_join_26
L_fw2all_again_84:
    s_sleep 3
L_fw2all_retry_28:
    s_sub_u32 s86, s86, 1
    s_cbranch_scc1 L_end
    global_load_dword v44, v45, s[32:33] sc1
    s_waitcnt vmcnt(0)
    v_cmp_ne_u32 vcc, s37, v44
    s_nop 1
    s_cbranch_vccnz L_fw2all_again_84
    s_branch L_fw2all_back_29
L_L_g1_1_slow_35:
    global_load_dword v47, v46, s[32:33] sc1
    s_waitcnt vmcnt(0)
    s_mov_b64 exec, 0x1
    global_store_dword v226, v227, s[32:33] sc1
    s_mov_b64 exec, -1
    s_branch L_L_g1_1_got_85
L_L_g1_1_again_86:
    s_sleep 3
L_g1_1_poll:
    s_sub_u32 s86, s86, 1
    s_cbranch_scc1 L_end
    global_load_dword v47, v46, s[32:33] sc1
    s_waitcnt vmcnt(0)
L_L_g1_1_got_85:
    s_mov_b32 s87, 1
    v_cmp_ne_u32 vcc, s60, v47
    s_nop 1
    s_cbranch_vccnz L_L_g1_1_again_86
    s_nop 0
    global_load_dwordx4 v[48:51], v192, s[32:33] sc1
    v_add_u32 v192, 132096, v192
    global_load_dwordx4 v[52:55], v192, s[32:33] sc1
    v_add_u32 v192, 132096, v192
    global_load_dwordx4 v[56:59], v192, s[32:33] sc1
    v_add_u32 v192, 132096, v192
    global_load_dwordx4 v[60:63], v192, s[32:33] sc1
    v_add_u32 v192, 132096, v192
    global_load_dwordx4 v[64:67], v192, s[32:33] sc1
    v_add_u32 v192, 132096, v192
    global_load_dwordx4 v[68:71], v192, s[32:33] sc1
    v_add_u32 v192, 132096, v192
    global_load_dwordx4 v[72:75], v192, s[32:33] sc1
    v_add_u32 v192, 132096, v192
    global_load_dwordx4 v[76:79], v192, s[32:33] sc1
    v_add_u32 v192, 132096, v192
    global_load_dwordx4 v[80:83], v192, s[32:33] sc1
    v_add_u32 v192, 132096, v192
    s_waitcnt vmcnt(0)
    s_branch L_L_g1_1_join_36
L_L_g2_0_slow_43:
    global_load_dword v219, v218, s[32:33] sc1
    s_waitcnt vmcnt(0)
    s_mov_b64 exec, 0x1
    global_store_dword v226, v227, s[32:33] sc1
    s_mov_b64 exec, -1
    s_branch L_L_g2_0_got_87
L_L_g2_0_again_88:
    s_sleep 3
L_g2_0_poll:
    s_sub_u32 s86, s86, 1
    s_cbranch_scc1 L_end
    global_load_dword v219, v218, s[32:33] sc1
    s_waitcnt vmcnt(0)
L_L_g2_0_got_87:
    s_mov_b32 s87, 1
    v_cmp_ne_u32 vcc, s37, v219
    s_nop 1
    s_cbranch_vccnz L_L_g2_0_again_88
    global_load_dwordx4 v[48:51], v214, s[32:33] offset:-4096 sc1
    global_load_dwordx4 v[52:55], v214, s[32:33] offset:-3072 sc1
    global_load_dwordx4 v[56:59], v214, s[32:33] offset:-2048 sc1
    global_load_dwordx4 v[60:63], v214, s[32:33] offset:-1024 sc1
    global_load_dwordx4 v[64:67], v214, s[32:33] offset:0 sc1
    global_load_dwordx4 v[68:71], v214, s[32:33] offset:1024 sc1
    global_load_dwordx4 v[72:75], v214, s[32:33] offset:2048 sc1
    global_load_dwordx4 v[76:79], v214, s[32:33] offset:3072 sc1
    global_load_dwordx4 v[80:83], v215, s[32:33] offset:-4096 sc1
    global_load_dwordx4 v[84:87], v215, s[32:33] offset:-3072 sc1
    global_load_dwordx4 v[88:91], v215, s[32:33] offset:-2048 sc1
    global_load_dwordx4 v[92:95], v215, s[32:33] offset:-1024 sc1
    global_load_dwordx2 v[96:97], v217, s[32:33] offset:0 sc1
    global_load_dwordx2 v[98:99], v217, s[32:33] offset:512 sc1
    global_load_dwordx2 v[100:101], v217, s[32:33] offset:1024 sc1
    global_load_dwordx2 v[102:103], v217, s[32:33] offset:1536 sc1
    s_waitcnt vmcnt(0)
    s_branch L_L_g2_0_join_44
L_L_g2_1_slow_50:
    s_branch L_g2_1_poll
L_L_g2_1_again_90:
    s_sleep 3
L_g2_1_poll:
    s_sub_u32 s86, s86, 1
    s_cbranch_scc1 L_end
    global_load_dword v219, v218, s[32:33] sc1
    s_waitcnt vmcnt(0)
L_L_g2_1_got_89:
    s_mov_b32 s87, 1
    v_cmp_ne_u32 vcc, s37, v219
    s_nop 1
    s_cbranch_vccnz L_L_g2_1_again_90
    global_load_dwordx4 v[48:51], v214, s[32:33] offset:-4096 sc1
    global_load_dwordx4 v[52:55], v214, s[32:33] offset:-3072 sc1
    global_load_dwordx4 v[56:59], v214, s[32:33] offset:-2048 sc1
    global_load_dwordx4 v[60:63], v214, s[32:33] offset:-1024 sc1
    global_load_dwordx4 v[64:67], v214, s[32:33] offset:0 sc1
    global_load_dwordx4 v[68:71], v214, s[32:33] offset:1024 sc1
    global_load_dwordx4 v[72:75], v214, s[32:33] offset:2048 sc1
    global_load_dwordx4 v[76:79], v214, s[32:33] offset:3072 sc1
    s_branch L_L_g2_1_join_51
L_ep_again_91:
    s_sleep 3
L_ep_retry_55:
    s_sub_u32 s86, s86, 1
    s_cbranch_scc1 L_end
    global_load_dwordx4 v[48:51], v220, s[32:33] offset:0 sc1
    global_load_dwordx4 v[52:55], v220, s[32:33] offset:16 sc1
    global_load_dwordx4 v[56:59], v220, s[32:33] offset:32 sc1
    global_load_dwordx4 v[60:63], v220, s[32:33] offset:48 sc1
    s_waitcnt vmcnt(0)
    v_xor_b32_e64 v224, s37, v48
    v_bitop3_b32 v224, v224, v49, s37 bitop3:0xf6
    v_bitop3_b32 v224, v224, v50, s37 bitop3:0xf6
    v_bitop3_b32 v224, v224, v51, s37 bitop3:0xf6
    v_bitop3_b32 v224, v224, v52, s37 bitop3:0xf6
    v_bitop3_b32 v224, v224, v53, s37 bitop3:0xf6
    v_bitop3_b32 v224, v224, v54, s37 bitop3:0xf6
    v_bitop3_b32 v224, v224, v55, s37 bitop3:0xf6
    v_bitop3_b32 v224, v224, v56, s37 bitop3:0xf6
    v_bitop3_b32 v224, v224, v57, s37 bitop3:0xf6
    v_bitop3_b32 v224, v224, v58, s37 bitop3:0xf6
    v_bitop3_b32 v224, v224, v59, s37 bitop3:0xf6
    v_bitop3_b32 v224, v224, v60, s37 bitop3:0xf6
    v_bitop3_b32 v224, v224, v61, s37 bitop3:0xf6
    v_bitop3_b32 v224, v224, v62, s37 bitop3:0xf6
    v_bitop3_b32 v224, v224, v63, s37 bitop3:0xf6
    v_cmp_ne_u32 vcc, 0, v224
    s_nop 1
    s_cbranch_vccnz L_ep_again_91
    s_branch L_ep_back_56
L_fm_again_92:
    s_sleep 3
L_fm_retry_69:
    s_sub_u32 s86, s86, 1
    s_cbranch_scc1 L_end
    global_load_dwordx2 v[20:21], v2, s[32:33] sc1
    global_load_dwordx2 v[22:23], v3, s[32:33] sc1
    global_load_dwordx2 v[24:25], v4, s[32:33] sc1
    global_load_dwordx2 v[26:27], v5, s[32:33] sc1
    s_waitcnt vmcnt(0)
    v_xor_b32_e64 v10, s37, v21
    v_bitop3_b32 v10, v10, v23, s37 bitop3:0xf6
    v_bitop3_b32 v10, v10, v25, s37 bitop3:0xf6
    v_bitop3_b32 v10, v10, v27, s37 bitop3:0xf6
    v_cmp_ne_u32 vcc, 0, v10
    s_nop 1
    s_cbranch_vccnz L_fm_again_92
    s_branch L_fm_back_70
L_small_again_93:
    s_sleep 3
L_small_retry_75:
    s_sub_u32 s86, s86, 1
    s_cbranch_scc1 L_end
    global_load_dwordx2 v[196:197], v44, s[32:33] offset:-3584 sc1
    global_load_dwordx2 v[198:199], v44, s[32:33] offset:-1792 sc1
    global_load_dwordx2 v[200:201], v44, s[32:33] offset:0 sc1
    global_load_dwordx2 v[202:203], v44, s[32:33] offset:1792 sc1
    global_load_dwordx2 v[204:205], v44, s[32:33] offset:3584 sc1
    global_load_dwordx2 v[206:207], v10, s[32:33] sc1
    global_load_dwordx2 v[208:209], v11, s[32:33] sc1
    s_waitcnt vmcnt(0)
    v_xor_b32_e64 v12, s37, v197
    v_bitop3_b32 v12, v12, v199, s37 bitop3:0xf6
    v_bitop3_b32 v12, v12, v201, s37 bitop3:0xf6
    v_bitop3_b32 v12, v12, v203, s37 bitop3:0xf6
    v_bitop3_b32 v12, v12, v205, s37 bitop3:0xf6
    v_bitop3_b32 v12, v12, v207, s37 bitop3:0xf6
    v_bitop3_b32 v12, v12, v209, s37 bitop3:0xf6
    v_cmp_ne_u32 vcc, 0, v12
    s_nop 1
    s_cbranch_vccnz L_small_again_93
    s_branch L_small_back_76
.section .rodata,"a"
.p2align 6
.amdhsa_kernel adaLN_cond__ssm_conv_s4d__dense_activation_silu__prompt_kernel
  .amdhsa_next_free_vgpr 512
  .amdhsa_next_free_sgpr 96
  .amdhsa_accum_offset 256
  .amdhsa_group_segment_fixed_size 0
  .amdhsa_kernarg_size 120
  .amdhsa_user_sgpr_count 2
  .amdhsa_user_sgpr_kernarg_segment_ptr 1
  .amdhsa_system_sgpr_workgroup_id_x 1
.end_amdhsa_kernel
```
